```python
import torch

def _softmax(x, axis=-1):
    return torch.softmax(x, dim=axis)
def _gelu(x):
    return torch.nn.functional.gelu(x, approximate="tanh")
def _silu(x):
    return torch.nn.functional.silu(x)
def _sigmoid(x):
    return torch.sigmoid(x)
def _layernorm(x, axis=-1, eps=1e-5):
    m = x.mean(dim=axis, keepdim=True)
    v = x.var(dim=axis, keepdim=True, unbiased=False)
    return (x - m) / torch.sqrt(v + eps)
def _scatter_add(tgt, idx, src, axis=0):
    return tgt.clone().index_add_(axis, idx, src)
def _segment_sum(src, seg, n):
    out = torch.zeros((n,) + src.shape[1:], dtype=src.dtype)
    return out.index_add_(0, seg, src)
def _pad(x, pw):
    flat = tuple(v for pair in reversed(pw) for v in pair)
    return torch.nn.functional.pad(x, flat)

kernel_name = 'concat_heads__ssm_conv_h3__sliding_block__prompt'

def setup_inputs():

    _w = (lambda a: (lambda t: t.to(torch.bfloat16) if t.is_floating_point() else t)(torch.as_tensor(a)))
    def _A_setup():
        B, S, D = 1, 2048, 640
        ks = 4
        return {
            "q": _w((lambda *s: torch.randn(*s, dtype=torch.bfloat16) * 0.05)(B, S, D)),
            "k": _w((lambda *s: torch.randn(*s, dtype=torch.bfloat16) * 0.8)(B, S, D)),
            "v": _w((lambda *s: torch.randn(*s, dtype=torch.bfloat16) * 0.8)(B, S, D)),
            "shift_k": _w((lambda *s: torch.randn(*s, dtype=torch.bfloat16) * 0.8)(D, ks) * 0.5),
            "ssm_k": _w((lambda *s: torch.randn(*s, dtype=torch.bfloat16) * 3.2)(D, S) * (1.0 / S ** 0.5)),
            "ssm_D": _w((lambda *s: torch.randn(*s, dtype=torch.bfloat16) * 0.8)(D)),
        }
    _A_in = _A_setup()

    def _B_setup():
        B, S, D = 1, 2048, 640
        return {
            "x": _w((lambda *s: torch.randn(*s, dtype=torch.bfloat16) * 0.2)(B, S, D)),
            "wqkv": _w((lambda *s: torch.randn(*s, dtype=torch.bfloat16) * 0.2)(D, 3 * D)),
            "wo": _w((lambda *s: torch.randn(*s, dtype=torch.bfloat16) * 0.05)(D, D)),
        }
    _B_in = _B_setup()

    return {
        "A_q": _A_in["q"],
        "A_k": _A_in["k"],
        "A_v": _A_in["v"],
        "A_shift_k": _A_in["shift_k"],
        "A_ssm_k": _A_in["ssm_k"],
        "A_ssm_D": _A_in["ssm_D"],
        "B_x": _B_in["x"],
        "B_wqkv": _B_in["wqkv"],
        "B_wo": _B_in["wo"],
    }

def reference(A_q, A_k, A_v, A_shift_k, A_ssm_k, A_ssm_D, B_x, B_wqkv, B_wo):
    def _A_ref(q, k, v, shift_k, ssm_k, ssm_D):
        B, S, D = q.shape
        ks = shift_k.shape[-1]
        k_pad = _pad(k, ((0, 0), (ks - 1, 0), (0, 0)))
        k_shift = torch.zeros_like(k)
        for t in range(ks):
            k_shift = k_shift + k_pad[:, t:t + S, :] * shift_k[:, ks - 1 - t][None, None, :]
        kv = k_shift * v
        L = 2 * S
        kv_pad = _pad(kv, ((0, 0), (0, S), (0, 0)))
        kf_pad = _pad(ssm_k, ((0, 0), (0, S)))
        kv_f = (lambda x, axes=(-2,-1): torch.fft.rfft2(x.float(), dim=axes))(kv_pad[:, None, :, :], axes=(1, 2))
        kf_f = (lambda x, axes=(-2,-1): torch.fft.rfft2(x.float(), dim=axes))(kf_pad[:, None, :], axes=(1, 2))
        kf_f = (lambda x, *d: x.permute(*d))(kf_f, 1, 2, 0)
        y_f = kv_f * kf_f[None, :, :, :]
        y = (lambda x, s, axes=(-2,-1): torch.fft.irfft2(x, s=s, dim=axes).to(torch.bfloat16))(y_f, (1, L), axes=(1, 2))[:, 0, :S, :]
        y = y + kv * ssm_D[None, None, :]
        return q * y

    def _B_ref(x, wqkv, wo):
        B, S, D = x.shape
        H = 32; Dh = D // H; W = 256
        qkv = (lambda x, *d: x.permute(*d))((x @ wqkv).reshape(B, S, 3, H, Dh), 2, 0, 3, 1, 4)
        q, k, v = qkv[0], qkv[1], qkv[2]
        scores = torch.einsum("bhqd,bhkd->bhqk", q, k) * (Dh ** -0.5)
        idx = torch.arange(S)
        mask = (idx[:, None] - idx[None, :] >= 0) & (idx[:, None] - idx[None, :] < W)
        scores = torch.where(mask[None, None], scores, -1e9)
        p = _softmax(scores, axis=-1)
        o = torch.einsum("bhqk,bhkd->bhqd", p, v)
        return (lambda x, *d: x.permute(*d))(o, 0, 2, 1, 3).reshape(B, S, D) @ wo

    a = _A_ref(A_q, A_k, A_v, A_shift_k, A_ssm_k, A_ssm_D)
    b = _B_ref(B_x, B_wqkv, B_wo)
    return torch.concatenate([a, b], axis=-1)
```

```asm
; @launch kernel=k1_kernel grid=(256,1,1) block=(256,1,1) lds=122880
; @launch kernel=k2_kernel grid=(1152,1,1) block=(256,1,1) lds=39552
; @launch kernel=k3_kernel grid=(240,1,1) block=(256,1,1) lds=61440
.amdgcn_target "amdgcn-amd-amdhsa--gfx950"
.text
.globl k1_kernel
.p2align 8
.type k1_kernel,@function
k1_kernel:
    s_cmp_ge_u32 s2, 160
    s_cbranch_scc1 .aux_2
    s_load_dwordx4 s[4:7], s[0:1], 48
    s_load_dwordx2 s[8:9], s[0:1], 88
    s_and_b32 s12, s2, 3
    s_bfe_u32 s13, s2, 0x10002
    s_lshr_b32 s14, s2, 3
    s_lshl_b32 s10, s12, 2
    s_and_b32 s15, s14, 3
    s_add_u32 s10, s10, s15
    s_mul_i32 s11, s13, 5
    s_lshr_b32 s15, s14, 2
    s_add_u32 s11, s11, s15
    v_lshrrev_b32 v1, 6, v0
    v_and_b32 v2, 63, v0
    s_nop 0
    v_readfirstlane_b32 s12, v1
    v_lshrrev_b32 v3, 3, v2
    v_mul_u32_u24 v3, 1280, v3
    v_lshrrev_b32 v4, 4, v2
    v_and_b32 v5, 7, v2
    v_xor_b32 v6, v5, v4
    v_xor_b32 v7, 4, v6
    s_mul_i32 s14, s12, 40960
    v_add_u32 v3, s14, v3
    v_lshl_add_u32 v6, v6, 4, v3
    v_lshl_add_u32 v7, v7, 4, v3
    s_mul_i32 s14, s12, 384
    v_add_u32 v8, s14, v2
    v_mul_u32_u24 v9, 0xaab, v8
    v_lshrrev_b32 v9, 16, v9
    v_mul_u32_u24 v10, 24, v9
    v_sub_u32 v10, v8, v10
    v_bfe_u32 v11, v9, 1, 1
    v_lshlrev_b32 v11, 2, v11
    v_xor_b32 v10, v10, v11
    v_mul_u32_u24 v9, 3840, v9
    v_lshl_add_u32 v16, v10, 4, v9
    v_add_u32 v8, s14, v2
    v_add_u32 v8, 64, v8
    v_mul_u32_u24 v9, 0xaab, v8
    v_lshrrev_b32 v9, 16, v9
    v_mul_u32_u24 v10, 24, v9
    v_sub_u32 v10, v8, v10
    v_bfe_u32 v11, v9, 1, 1
    v_lshlrev_b32 v11, 2, v11
    v_xor_b32 v10, v10, v11
    v_mul_u32_u24 v9, 3840, v9
    v_lshl_add_u32 v17, v10, 4, v9
    v_add_u32 v8, s14, v2
    v_add_u32 v8, 128, v8
    v_mul_u32_u24 v9, 0xaab, v8
    v_lshrrev_b32 v9, 16, v9
    v_mul_u32_u24 v10, 24, v9
    v_sub_u32 v10, v8, v10
    v_bfe_u32 v11, v9, 1, 1
    v_lshlrev_b32 v11, 2, v11
    v_xor_b32 v10, v10, v11
    v_mul_u32_u24 v9, 3840, v9
    v_lshl_add_u32 v18, v10, 4, v9
    v_add_u32 v8, s14, v2
    v_add_u32 v8, 192, v8
    v_mul_u32_u24 v9, 0xaab, v8
    v_lshrrev_b32 v9, 16, v9
    v_mul_u32_u24 v10, 24, v9
    v_sub_u32 v10, v8, v10
    v_bfe_u32 v11, v9, 1, 1
    v_lshlrev_b32 v11, 2, v11
    v_xor_b32 v10, v10, v11
    v_mul_u32_u24 v9, 3840, v9
    v_lshl_add_u32 v19, v10, 4, v9
    v_add_u32 v8, s14, v2
    v_add_u32 v8, 256, v8
    v_mul_u32_u24 v9, 0xaab, v8
    v_lshrrev_b32 v9, 16, v9
    v_mul_u32_u24 v10, 24, v9
    v_sub_u32 v10, v8, v10
    v_bfe_u32 v11, v9, 1, 1
    v_lshlrev_b32 v11, 2, v11
    v_xor_b32 v10, v10, v11
    v_mul_u32_u24 v9, 3840, v9
    v_lshl_add_u32 v20, v10, 4, v9
    v_add_u32 v8, s14, v2
    v_add_u32 v8, 320, v8
    v_mul_u32_u24 v9, 0xaab, v8
    v_lshrrev_b32 v9, 16, v9
    v_mul_u32_u24 v10, 24, v9
    v_sub_u32 v10, v8, v10
    v_bfe_u32 v11, v9, 1, 1
    v_lshlrev_b32 v11, 2, v11
    v_xor_b32 v10, v10, v11
    v_mul_u32_u24 v9, 3840, v9
    v_lshl_add_u32 v21, v10, 4, v9
    s_waitcnt lgkmcnt(0)
    s_mov_b32 s20, s4
    s_mov_b32 s21, s5
    s_mov_b32 s22, 0x280000
    s_mov_b32 s23, 0x00020000
    s_mov_b32 s24, s6
    s_mov_b32 s25, s7
    s_mov_b32 s26, 0x258000
    s_mov_b32 s27, 0x00020000
    s_mul_i32 s28, s10, 163840
    s_mul_i32 s30, s11, 384
    s_lshl_b32 s32, s12, 12
    s_mul_i32 s33, s12, 6144
    s_and_b32 s34, s10, 3
    s_mul_i32 s34, s34, 5
    s_lshr_b32 s34, s34, 1
    s_mul_i32 s35, s11, 3
    s_add_u32 s34, s34, s35
    s_lshr_b32 s35, s10, 2
    s_add_u32 s34, s34, s35
    s_mul_hi_u32 s35, s34, 0x1999999a
    s_mul_i32 s35, s35, 10
    s_sub_u32 s34, s34, s35
    s_lshl_b32 s35, s34, 7
    s_add_u32 s28, s28, s35
    s_mul_i32 s35, s34, 245760
    s_add_u32 s30, s30, s35
    s_mov_b32 s37, 245760
    s_movk_i32 s38, 128
    s_add_u32 m0, s32, 0
    s_nop 0
    buffer_load_dwordx4 v6, s[20:23], s28 offen  lds
    s_add_u32 m0, s32, 1024
    s_add_u32 s29, s28, 10240
    buffer_load_dwordx4 v7, s[20:23], s29 offen  lds
    s_add_u32 m0, s32, 2048
    s_add_u32 s29, s28, 20480
    buffer_load_dwordx4 v6, s[20:23], s29 offen  lds
    s_add_u32 m0, s32, 3072
    s_add_u32 s29, s28, 30720
    buffer_load_dwordx4 v7, s[20:23], s29 offen  lds
    s_add_u32 m0, s33, 16384
    s_nop 0
    buffer_load_dwordx4 v16, s[24:27], s30 offen  lds
    s_add_u32 m0, s33, 17408
    s_nop 0
    buffer_load_dwordx4 v17, s[24:27], s30 offen  lds
    s_add_u32 m0, s33, 18432
    s_nop 0
    buffer_load_dwordx4 v18, s[24:27], s30 offen  lds
    s_add_u32 m0, s33, 19456
    s_nop 0
    buffer_load_dwordx4 v19, s[24:27], s30 offen  lds
    s_add_u32 m0, s33, 20480
    s_nop 0
    buffer_load_dwordx4 v20, s[24:27], s30 offen  lds
    s_add_u32 m0, s33, 21504
    s_nop 0
    buffer_load_dwordx4 v21, s[24:27], s30 offen  lds
    s_add_u32 s34, s34, 1
    s_cmp_eq_u32 s34, 10
    s_cselect_b32 s35, 0xfffffb80, s38
    s_cselect_b32 s36, 0xffde4000, s37
    s_cselect_b32 s34, 0, s34
    s_add_u32 s28, s28, s35
    s_add_u32 s30, s30, s36
    s_add_u32 m0, s32, 40960
    s_nop 0
    buffer_load_dwordx4 v6, s[20:23], s28 offen  lds
    s_add_u32 m0, s32, 41984
    s_add_u32 s29, s28, 10240
    buffer_load_dwordx4 v7, s[20:23], s29 offen  lds
    s_add_u32 m0, s32, 43008
    s_add_u32 s29, s28, 20480
    buffer_load_dwordx4 v6, s[20:23], s29 offen  lds
    s_add_u32 m0, s32, 44032
    s_add_u32 s29, s28, 30720
    buffer_load_dwordx4 v7, s[20:23], s29 offen  lds
    s_add_u32 m0, s33, 57344
    s_nop 0
    buffer_load_dwordx4 v16, s[24:27], s30 offen  lds
    s_add_u32 m0, s33, 58368
    s_nop 0
    buffer_load_dwordx4 v17, s[24:27], s30 offen  lds
    s_add_u32 m0, s33, 59392
    s_nop 0
    buffer_load_dwordx4 v18, s[24:27], s30 offen  lds
    s_add_u32 m0, s33, 60416
    s_nop 0
    buffer_load_dwordx4 v19, s[24:27], s30 offen  lds
    s_add_u32 m0, s33, 61440
    s_nop 0
    buffer_load_dwordx4 v20, s[24:27], s30 offen  lds
    s_add_u32 m0, s33, 62464
    s_nop 0
    buffer_load_dwordx4 v21, s[24:27], s30 offen  lds
    s_add_u32 s34, s34, 1
    s_cmp_eq_u32 s34, 10
    s_cselect_b32 s35, 0xfffffb80, s38
    s_cselect_b32 s36, 0xffde4000, s37
    s_cselect_b32 s34, 0, s34
    s_add_u32 s28, s28, s35
    s_add_u32 s30, s30, s36
    s_lshr_b32 s15, s12, 1
    s_and_b32 s16, s12, 1
    v_and_b32 v8, 31, v2
    v_lshrrev_b32 v9, 5, v2
    v_bfe_u32 v10, v8, 1, 3
    v_xor_b32 v10, v9, v10
    s_lshl_b32 s17, s15, 13
    v_lshl_add_u32 v11, v8, 7, s17
    v_xor_b32 v12, 0, v10
    v_lshl_add_u32 v22, v12, 4, v11
    v_xor_b32 v12, 2, v10
    v_lshl_add_u32 v23, v12, 4, v11
    v_xor_b32 v12, 4, v10
    v_lshl_add_u32 v24, v12, 4, v11
    v_xor_b32 v12, 6, v10
    v_lshl_add_u32 v25, v12, 4, v11
    v_bfe_u32 v13, v2, 2, 2
    v_lshl_add_u32 v14, v9, 3, v13
    v_mul_u32_u24 v14, 384, v14
    v_and_b32 v15, 1, v4
    v_lshl_add_u32 v14, v15, 5, v14
    v_and_b32 v15, 3, v2
    v_lshl_add_u32 v14, v15, 3, v14
    v_add_u32 v14, 16384, v14
    v_lshrrev_b32 v13, 1, v13
    s_mul_i32 s17, s16, 3
    s_add_u32 s18, s17, 0
    v_xor_b32 v15, s18, v13
    v_lshl_add_u32 v26, v15, 6, v14
    s_add_u32 s18, s17, 1
    v_xor_b32 v15, s18, v13
    v_lshl_add_u32 v27, v15, 6, v14
    s_add_u32 s18, s17, 2
    v_xor_b32 v15, s18, v13
    v_lshl_add_u32 v28, v15, 6, v14
    v_add_u32 v29, 40960, v22
    v_add_u32 v30, 40960, v23
    v_add_u32 v31, 40960, v24
    v_add_u32 v32, 40960, v25
    v_add_u32 v33, 40960, v26
    v_add_u32 v34, 40960, v27
    v_add_u32 v35, 40960, v28
    v_add_u32 v36, 81920, v22
    v_add_u32 v37, 81920, v23
    v_add_u32 v38, 81920, v24
    v_add_u32 v39, 81920, v25
    v_add_u32 v40, 81920, v26
    v_add_u32 v41, 81920, v27
    v_add_u32 v42, 81920, v28
    s_mul_i32 s39, s11, 6
    s_add_u32 s39, s39, s17
    s_cmp_ge_u32 s39, 40
    s_cbranch_scc1 .g1v_3
    s_cmp_eq_u32 s39, 39
    s_cbranch_scc1 .g1m_4
    s_waitcnt vmcnt(10) lgkmcnt(0)
    s_barrier
    ds_read_b64_tr_b16 v[156:157], v26 offset:0
    ds_read_b64_tr_b16 v[158:159], v26 offset:1536
    ds_read_b128 v[148:151], v22 offset:0
    ds_read_b64_tr_b16 v[160:161], v27 offset:0
    ds_read_b64_tr_b16 v[162:163], v27 offset:1536
    ds_read_b128 v[152:155], v22 offset:4096
    ds_read_b64_tr_b16 v[164:165], v28 offset:0
    ds_read_b64_tr_b16 v[166:167], v28 offset:1536
    s_add_u32 m0, s32, 81920
    s_nop 0
    buffer_load_dwordx4 v6, s[20:23], s28 offen  lds
    s_add_u32 m0, s32, 82944
    s_add_u32 s29, s28, 10240
    buffer_load_dwordx4 v7, s[20:23], s29 offen  lds
    s_add_u32 m0, s32, 83968
    s_add_u32 s29, s28, 20480
    buffer_load_dwordx4 v6, s[20:23], s29 offen  lds
    s_waitcnt lgkmcnt(0)
    v_mfma_f32_32x32x16_bf16 v[52:67], v[156:159], v[148:151], 0
    ds_read_b64_tr_b16 v[176:177], v26 offset:6144
    ds_read_b64_tr_b16 v[178:179], v26 offset:7680
    s_add_u32 m0, s32, 84992
    s_add_u32 s29, s28, 30720
    buffer_load_dwordx4 v7, s[20:23], s29 offen  lds
    v_mfma_f32_32x32x16_bf16 v[100:115], v[156:159], v[152:155], 0
    ds_read_b128 v[168:171], v23 offset:0
    ds_read_b64_tr_b16 v[180:181], v27 offset:6144
    v_mfma_f32_32x32x16_bf16 v[68:83], v[160:163], v[148:151], 0
    ds_read_b64_tr_b16 v[182:183], v27 offset:7680
    ds_read_b128 v[172:175], v23 offset:4096
    s_add_u32 m0, s33, 98304
    s_nop 0
    buffer_load_dwordx4 v16, s[24:27], s30 offen  lds
    v_mfma_f32_32x32x16_bf16 v[116:131], v[160:163], v[152:155], 0
    ds_read_b64_tr_b16 v[184:185], v28 offset:6144
    ds_read_b64_tr_b16 v[186:187], v28 offset:7680
    v_mfma_f32_32x32x16_bf16 v[84:99], v[164:167], v[148:151], 0
    s_add_u32 m0, s33, 99328
    s_nop 0
    buffer_load_dwordx4 v17, s[24:27], s30 offen  lds
    v_mfma_f32_32x32x16_bf16 v[132:147], v[164:167], v[152:155], 0
    s_waitcnt lgkmcnt(0)
    v_mfma_f32_32x32x16_bf16 v[52:67], v[176:179], v[168:171], v[52:67]
    ds_read_b64_tr_b16 v[156:157], v26 offset:12288
    ds_read_b64_tr_b16 v[158:159], v26 offset:13824
    v_mfma_f32_32x32x16_bf16 v[100:115], v[176:179], v[172:175], v[100:115]
    ds_read_b128 v[148:151], v24 offset:0
    ds_read_b64_tr_b16 v[160:161], v27 offset:12288
    s_add_u32 m0, s33, 100352
    s_nop 0
    buffer_load_dwordx4 v18, s[24:27], s30 offen  lds
    v_mfma_f32_32x32x16_bf16 v[68:83], v[180:183], v[168:171], v[68:83]
    ds_read_b64_tr_b16 v[162:163], v27 offset:13824
    ds_read_b128 v[152:155], v24 offset:4096
    v_mfma_f32_32x32x16_bf16 v[116:131], v[180:183], v[172:175], v[116:131]
    ds_read_b64_tr_b16 v[164:165], v28 offset:12288
    ds_read_b64_tr_b16 v[166:167], v28 offset:13824
    v_mfma_f32_32x32x16_bf16 v[84:99], v[184:187], v[168:171], v[84:99]
    s_add_u32 m0, s33, 101376
    s_nop 0
    buffer_load_dwordx4 v19, s[24:27], s30 offen  lds
    v_mfma_f32_32x32x16_bf16 v[132:147], v[184:187], v[172:175], v[132:147]
    s_waitcnt lgkmcnt(0)
    v_mfma_f32_32x32x16_bf16 v[52:67], v[156:159], v[148:151], v[52:67]
    ds_read_b64_tr_b16 v[176:177], v26 offset:18432
    ds_read_b64_tr_b16 v[178:179], v26 offset:19968
    v_mfma_f32_32x32x16_bf16 v[100:115], v[156:159], v[152:155], v[100:115]
    ds_read_b128 v[168:171], v25 offset:0
    ds_read_b64_tr_b16 v[180:181], v27 offset:18432
    s_add_u32 m0, s33, 102400
    s_nop 0
    buffer_load_dwordx4 v20, s[24:27], s30 offen  lds
    v_mfma_f32_32x32x16_bf16 v[68:83], v[160:163], v[148:151], v[68:83]
    ds_read_b64_tr_b16 v[182:183], v27 offset:19968
    ds_read_b128 v[172:175], v25 offset:4096
    v_mfma_f32_32x32x16_bf16 v[116:131], v[160:163], v[152:155], v[116:131]
    ds_read_b64_tr_b16 v[184:185], v28 offset:18432
    ds_read_b64_tr_b16 v[186:187], v28 offset:19968
    v_mfma_f32_32x32x16_bf16 v[84:99], v[164:167], v[148:151], v[84:99]
    s_add_u32 m0, s33, 103424
    s_nop 0
    buffer_load_dwordx4 v21, s[24:27], s30 offen  lds
    s_add_u32 s34, s34, 1
    s_cmp_eq_u32 s34, 10
    s_cselect_b32 s35, 0xfffffb80, s38
    s_cselect_b32 s36, 0xffde4000, s37
    s_cselect_b32 s34, 0, s34
    s_add_u32 s28, s28, s35
    s_add_u32 s30, s30, s36
    v_mfma_f32_32x32x16_bf16 v[132:147], v[164:167], v[152:155], v[132:147]
    s_waitcnt vmcnt(10) lgkmcnt(0)
    s_barrier
    v_mfma_f32_32x32x16_bf16 v[52:67], v[176:179], v[168:171], v[52:67]
    ds_read_b64_tr_b16 v[156:157], v33 offset:0
    ds_read_b64_tr_b16 v[158:159], v33 offset:1536
    s_add_u32 m0, s32, 0
    s_nop 0
    buffer_load_dwordx4 v6, s[20:23], s28 offen  lds
    v_mfma_f32_32x32x16_bf16 v[100:115], v[176:179], v[172:175], v[100:115]
    ds_read_b128 v[148:151], v29 offset:0
    ds_read_b64_tr_b16 v[160:161], v34 offset:0
    v_mfma_f32_32x32x16_bf16 v[68:83], v[180:183], v[168:171], v[68:83]
    ds_read_b64_tr_b16 v[162:163], v34 offset:1536
    ds_read_b128 v[152:155], v29 offset:4096
    s_add_u32 m0, s32, 1024
    s_add_u32 s29, s28, 10240
    buffer_load_dwordx4 v7, s[20:23], s29 offen  lds
    v_mfma_f32_32x32x16_bf16 v[116:131], v[180:183], v[172:175], v[116:131]
    ds_read_b64_tr_b16 v[164:165], v35 offset:0
    ds_read_b64_tr_b16 v[166:167], v35 offset:1536
    v_mfma_f32_32x32x16_bf16 v[84:99], v[184:187], v[168:171], v[84:99]
    s_add_u32 m0, s32, 2048
    s_add_u32 s29, s28, 20480
    buffer_load_dwordx4 v6, s[20:23], s29 offen  lds
    v_mfma_f32_32x32x16_bf16 v[132:147], v[184:187], v[172:175], v[132:147]
    s_waitcnt lgkmcnt(0)
    v_mfma_f32_32x32x16_bf16 v[52:67], v[156:159], v[148:151], v[52:67]
    ds_read_b64_tr_b16 v[176:177], v33 offset:6144
    ds_read_b64_tr_b16 v[178:179], v33 offset:7680
    s_add_u32 m0, s32, 3072
    s_add_u32 s29, s28, 30720
    buffer_load_dwordx4 v7, s[20:23], s29 offen  lds
    v_mfma_f32_32x32x16_bf16 v[100:115], v[156:159], v[152:155], v[100:115]
    ds_read_b128 v[168:171], v30 offset:0
    ds_read_b64_tr_b16 v[180:181], v34 offset:6144
    v_mfma_f32_32x32x16_bf16 v[68:83], v[160:163], v[148:151], v[68:83]
    ds_read_b64_tr_b16 v[182:183], v34 offset:7680
    ds_read_b128 v[172:175], v30 offset:4096
    s_add_u32 m0, s33, 16384
    s_nop 0
    buffer_load_dwordx4 v16, s[24:27], s30 offen  lds
    v_mfma_f32_32x32x16_bf16 v[116:131], v[160:163], v[152:155], v[116:131]
    ds_read_b64_tr_b16 v[184:185], v35 offset:6144
    ds_read_b64_tr_b16 v[186:187], v35 offset:7680
    v_mfma_f32_32x32x16_bf16 v[84:99], v[164:167], v[148:151], v[84:99]
    s_add_u32 m0, s33, 17408
    s_nop 0
    buffer_load_dwordx4 v17, s[24:27], s30 offen  lds
    v_mfma_f32_32x32x16_bf16 v[132:147], v[164:167], v[152:155], v[132:147]
    s_waitcnt lgkmcnt(0)
    v_mfma_f32_32x32x16_bf16 v[52:67], v[176:179], v[168:171], v[52:67]
    ds_read_b64_tr_b16 v[156:157], v33 offset:12288
    ds_read_b64_tr_b16 v[158:159], v33 offset:13824
    v_mfma_f32_32x32x16_bf16 v[100:115], v[176:179], v[172:175], v[100:115]
    ds_read_b128 v[148:151], v31 offset:0
    ds_read_b64_tr_b16 v[160:161], v34 offset:12288
    s_add_u32 m0, s33, 18432
    s_nop 0
    buffer_load_dwordx4 v18, s[24:27], s30 offen  lds
    v_mfma_f32_32x32x16_bf16 v[68:83], v[180:183], v[168:171], v[68:83]
    ds_read_b64_tr_b16 v[162:163], v34 offset:13824
    ds_read_b128 v[152:155], v31 offset:4096
    v_mfma_f32_32x32x16_bf16 v[116:131], v[180:183], v[172:175], v[116:131]
    ds_read_b64_tr_b16 v[164:165], v35 offset:12288
    ds_read_b64_tr_b16 v[166:167], v35 offset:13824
    v_mfma_f32_32x32x16_bf16 v[84:99], v[184:187], v[168:171], v[84:99]
    s_add_u32 m0, s33, 19456
    s_nop 0
    buffer_load_dwordx4 v19, s[24:27], s30 offen  lds
    v_mfma_f32_32x32x16_bf16 v[132:147], v[184:187], v[172:175], v[132:147]
    s_waitcnt lgkmcnt(0)
    v_mfma_f32_32x32x16_bf16 v[52:67], v[156:159], v[148:151], v[52:67]
    ds_read_b64_tr_b16 v[176:177], v33 offset:18432
    ds_read_b64_tr_b16 v[178:179], v33 offset:19968
    v_mfma_f32_32x32x16_bf16 v[100:115], v[156:159], v[152:155], v[100:115]
    ds_read_b128 v[168:171], v32 offset:0
    ds_read_b64_tr_b16 v[180:181], v34 offset:18432
    s_add_u32 m0, s33, 20480
    s_nop 0
    buffer_load_dwordx4 v20, s[24:27], s30 offen  lds
    v_mfma_f32_32x32x16_bf16 v[68:83], v[160:163], v[148:151], v[68:83]
    ds_read_b64_tr_b16 v[182:183], v34 offset:19968
    ds_read_b128 v[172:175], v32 offset:4096
    v_mfma_f32_32x32x16_bf16 v[116:131], v[160:163], v[152:155], v[116:131]
    ds_read_b64_tr_b16 v[184:185], v35 offset:18432
    ds_read_b64_tr_b16 v[186:187], v35 offset:19968
    v_mfma_f32_32x32x16_bf16 v[84:99], v[164:167], v[148:151], v[84:99]
    s_add_u32 m0, s33, 21504
    s_nop 0
    buffer_load_dwordx4 v21, s[24:27], s30 offen  lds
    s_add_u32 s34, s34, 1
    s_cmp_eq_u32 s34, 10
    s_cselect_b32 s35, 0xfffffb80, s38
    s_cselect_b32 s36, 0xffde4000, s37
    s_cselect_b32 s34, 0, s34
    s_add_u32 s28, s28, s35
    s_add_u32 s30, s30, s36
    v_mfma_f32_32x32x16_bf16 v[132:147], v[164:167], v[152:155], v[132:147]
    s_waitcnt vmcnt(10) lgkmcnt(0)
    s_barrier
    v_mfma_f32_32x32x16_bf16 v[52:67], v[176:179], v[168:171], v[52:67]
    ds_read_b64_tr_b16 v[156:157], v40 offset:0
    ds_read_b64_tr_b16 v[158:159], v40 offset:1536
    s_add_u32 m0, s32, 40960
    s_nop 0
    buffer_load_dwordx4 v6, s[20:23], s28 offen  lds
    v_mfma_f32_32x32x16_bf16 v[100:115], v[176:179], v[172:175], v[100:115]
    ds_read_b128 v[148:151], v36 offset:0
    ds_read_b64_tr_b16 v[160:161], v41 offset:0
    v_mfma_f32_32x32x16_bf16 v[68:83], v[180:183], v[168:171], v[68:83]
    ds_read_b64_tr_b16 v[162:163], v41 offset:1536
    ds_read_b128 v[152:155], v36 offset:4096
    s_add_u32 m0, s32, 41984
    s_add_u32 s29, s28, 10240
    buffer_load_dwordx4 v7, s[20:23], s29 offen  lds
    v_mfma_f32_32x32x16_bf16 v[116:131], v[180:183], v[172:175], v[116:131]
    ds_read_b64_tr_b16 v[164:165], v42 offset:0
    ds_read_b64_tr_b16 v[166:167], v42 offset:1536
    v_mfma_f32_32x32x16_bf16 v[84:99], v[184:187], v[168:171], v[84:99]
    s_add_u32 m0, s32, 43008
    s_add_u32 s29, s28, 20480
    buffer_load_dwordx4 v6, s[20:23], s29 offen  lds
    v_mfma_f32_32x32x16_bf16 v[132:147], v[184:187], v[172:175], v[132:147]
    s_waitcnt lgkmcnt(0)
    v_mfma_f32_32x32x16_bf16 v[52:67], v[156:159], v[148:151], v[52:67]
    ds_read_b64_tr_b16 v[176:177], v40 offset:6144
    ds_read_b64_tr_b16 v[178:179], v40 offset:7680
    s_add_u32 m0, s32, 44032
    s_add_u32 s29, s28, 30720
    buffer_load_dwordx4 v7, s[20:23], s29 offen  lds
    v_mfma_f32_32x32x16_bf16 v[100:115], v[156:159], v[152:155], v[100:115]
    ds_read_b128 v[168:171], v37 offset:0
    ds_read_b64_tr_b16 v[180:181], v41 offset:6144
    v_mfma_f32_32x32x16_bf16 v[68:83], v[160:163], v[148:151], v[68:83]
    ds_read_b64_tr_b16 v[182:183], v41 offset:7680
    ds_read_b128 v[172:175], v37 offset:4096
    s_add_u32 m0, s33, 57344
    s_nop 0
    buffer_load_dwordx4 v16, s[24:27], s30 offen  lds
    v_mfma_f32_32x32x16_bf16 v[116:131], v[160:163], v[152:155], v[116:131]
    ds_read_b64_tr_b16 v[184:185], v42 offset:6144
    ds_read_b64_tr_b16 v[186:187], v42 offset:7680
    v_mfma_f32_32x32x16_bf16 v[84:99], v[164:167], v[148:151], v[84:99]
    s_add_u32 m0, s33, 58368
    s_nop 0
    buffer_load_dwordx4 v17, s[24:27], s30 offen  lds
    v_mfma_f32_32x32x16_bf16 v[132:147], v[164:167], v[152:155], v[132:147]
    s_waitcnt lgkmcnt(0)
    v_mfma_f32_32x32x16_bf16 v[52:67], v[176:179], v[168:171], v[52:67]
    ds_read_b64_tr_b16 v[156:157], v40 offset:12288
    ds_read_b64_tr_b16 v[158:159], v40 offset:13824
    v_mfma_f32_32x32x16_bf16 v[100:115], v[176:179], v[172:175], v[100:115]
    ds_read_b128 v[148:151], v38 offset:0
    ds_read_b64_tr_b16 v[160:161], v41 offset:12288
    s_add_u32 m0, s33, 59392
    s_nop 0
    buffer_load_dwordx4 v18, s[24:27], s30 offen  lds
    v_mfma_f32_32x32x16_bf16 v[68:83], v[180:183], v[168:171], v[68:83]
    ds_read_b64_tr_b16 v[162:163], v41 offset:13824
    ds_read_b128 v[152:155], v38 offset:4096
    v_mfma_f32_32x32x16_bf16 v[116:131], v[180:183], v[172:175], v[116:131]
    ds_read_b64_tr_b16 v[164:165], v42 offset:12288
    ds_read_b64_tr_b16 v[166:167], v42 offset:13824
    v_mfma_f32_32x32x16_bf16 v[84:99], v[184:187], v[168:171], v[84:99]
    s_add_u32 m0, s33, 60416
    s_nop 0
    buffer_load_dwordx4 v19, s[24:27], s30 offen  lds
    v_mfma_f32_32x32x16_bf16 v[132:147], v[184:187], v[172:175], v[132:147]
    s_waitcnt lgkmcnt(0)
    v_mfma_f32_32x32x16_bf16 v[52:67], v[156:159], v[148:151], v[52:67]
    ds_read_b64_tr_b16 v[176:177], v40 offset:18432
    ds_read_b64_tr_b16 v[178:179], v40 offset:19968
    v_mfma_f32_32x32x16_bf16 v[100:115], v[156:159], v[152:155], v[100:115]
    ds_read_b128 v[168:171], v39 offset:0
    ds_read_b64_tr_b16 v[180:181], v41 offset:18432
    s_add_u32 m0, s33, 61440
    s_nop 0
    buffer_load_dwordx4 v20, s[24:27], s30 offen  lds
    v_mfma_f32_32x32x16_bf16 v[68:83], v[160:163], v[148:151], v[68:83]
    ds_read_b64_tr_b16 v[182:183], v41 offset:19968
    ds_read_b128 v[172:175], v39 offset:4096
    v_mfma_f32_32x32x16_bf16 v[116:131], v[160:163], v[152:155], v[116:131]
    ds_read_b64_tr_b16 v[184:185], v42 offset:18432
    ds_read_b64_tr_b16 v[186:187], v42 offset:19968
    v_mfma_f32_32x32x16_bf16 v[84:99], v[164:167], v[148:151], v[84:99]
    s_add_u32 m0, s33, 62464
    s_nop 0
    buffer_load_dwordx4 v21, s[24:27], s30 offen  lds
    s_add_u32 s34, s34, 1
    s_cmp_eq_u32 s34, 10
    s_cselect_b32 s35, 0xfffffb80, s38
    s_cselect_b32 s36, 0xffde4000, s37
    s_cselect_b32 s34, 0, s34
    s_add_u32 s28, s28, s35
    s_add_u32 s30, s30, s36
    v_mfma_f32_32x32x16_bf16 v[132:147], v[164:167], v[152:155], v[132:147]
    s_waitcnt vmcnt(10) lgkmcnt(0)
    s_barrier
    v_mfma_f32_32x32x16_bf16 v[52:67], v[176:179], v[168:171], v[52:67]
    ds_read_b64_tr_b16 v[156:157], v26 offset:0
    ds_read_b64_tr_b16 v[158:159], v26 offset:1536
    s_add_u32 m0, s32, 81920
    s_nop 0
    buffer_load_dwordx4 v6, s[20:23], s28 offen  lds
    v_mfma_f32_32x32x16_bf16 v[100:115], v[176:179], v[172:175], v[100:115]
    ds_read_b128 v[148:151], v22 offset:0
    ds_read_b64_tr_b16 v[160:161], v27 offset:0
    v_mfma_f32_32x32x16_bf16 v[68:83], v[180:183], v[168:171], v[68:83]
    ds_read_b64_tr_b16 v[162:163], v27 offset:1536
    ds_read_b128 v[152:155], v22 offset:4096
    s_add_u32 m0, s32, 82944
    s_add_u32 s29, s28, 10240
    buffer_load_dwordx4 v7, s[20:23], s29 offen  lds
    v_mfma_f32_32x32x16_bf16 v[116:131], v[180:183], v[172:175], v[116:131]
    ds_read_b64_tr_b16 v[164:165], v28 offset:0
    ds_read_b64_tr_b16 v[166:167], v28 offset:1536
    v_mfma_f32_32x32x16_bf16 v[84:99], v[184:187], v[168:171], v[84:99]
    s_add_u32 m0, s32, 83968
    s_add_u32 s29, s28, 20480
    buffer_load_dwordx4 v6, s[20:23], s29 offen  lds
    v_mfma_f32_32x32x16_bf16 v[132:147], v[184:187], v[172:175], v[132:147]
    s_waitcnt lgkmcnt(0)
    v_mfma_f32_32x32x16_bf16 v[52:67], v[156:159], v[148:151], v[52:67]
    ds_read_b64_tr_b16 v[176:177], v26 offset:6144
    ds_read_b64_tr_b16 v[178:179], v26 offset:7680
    s_add_u32 m0, s32, 84992
    s_add_u32 s29, s28, 30720
    buffer_load_dwordx4 v7, s[20:23], s29 offen  lds
    v_mfma_f32_32x32x16_bf16 v[100:115], v[156:159], v[152:155], v[100:115]
    ds_read_b128 v[168:171], v23 offset:0
    ds_read_b64_tr_b16 v[180:181], v27 offset:6144
    v_mfma_f32_32x32x16_bf16 v[68:83], v[160:163], v[148:151], v[68:83]
    ds_read_b64_tr_b16 v[182:183], v27 offset:7680
    ds_read_b128 v[172:175], v23 offset:4096
    s_add_u32 m0, s33, 98304
    s_nop 0
    buffer_load_dwordx4 v16, s[24:27], s30 offen  lds
    v_mfma_f32_32x32x16_bf16 v[116:131], v[160:163], v[152:155], v[116:131]
    ds_read_b64_tr_b16 v[184:185], v28 offset:6144
    ds_read_b64_tr_b16 v[186:187], v28 offset:7680
    v_mfma_f32_32x32x16_bf16 v[84:99], v[164:167], v[148:151], v[84:99]
    s_add_u32 m0, s33, 99328
    s_nop 0
    buffer_load_dwordx4 v17, s[24:27], s30 offen  lds
    v_mfma_f32_32x32x16_bf16 v[132:147], v[164:167], v[152:155], v[132:147]
    s_waitcnt lgkmcnt(0)
    v_mfma_f32_32x32x16_bf16 v[52:67], v[176:179], v[168:171], v[52:67]
    ds_read_b64_tr_b16 v[156:157], v26 offset:12288
    ds_read_b64_tr_b16 v[158:159], v26 offset:13824
    v_mfma_f32_32x32x16_bf16 v[100:115], v[176:179], v[172:175], v[100:115]
    ds_read_b128 v[148:151], v24 offset:0
    ds_read_b64_tr_b16 v[160:161], v27 offset:12288
    s_add_u32 m0, s33, 100352
    s_nop 0
    buffer_load_dwordx4 v18, s[24:27], s30 offen  lds
    v_mfma_f32_32x32x16_bf16 v[68:83], v[180:183], v[168:171], v[68:83]
    ds_read_b64_tr_b16 v[162:163], v27 offset:13824
    ds_read_b128 v[152:155], v24 offset:4096
    v_mfma_f32_32x32x16_bf16 v[116:131], v[180:183], v[172:175], v[116:131]
    ds_read_b64_tr_b16 v[164:165], v28 offset:12288
    ds_read_b64_tr_b16 v[166:167], v28 offset:13824
    v_mfma_f32_32x32x16_bf16 v[84:99], v[184:187], v[168:171], v[84:99]
    s_add_u32 m0, s33, 101376
    s_nop 0
    buffer_load_dwordx4 v19, s[24:27], s30 offen  lds
    v_mfma_f32_32x32x16_bf16 v[132:147], v[184:187], v[172:175], v[132:147]
    s_waitcnt lgkmcnt(0)
    v_mfma_f32_32x32x16_bf16 v[52:67], v[156:159], v[148:151], v[52:67]
    ds_read_b64_tr_b16 v[176:177], v26 offset:18432
    ds_read_b64_tr_b16 v[178:179], v26 offset:19968
    v_mfma_f32_32x32x16_bf16 v[100:115], v[156:159], v[152:155], v[100:115]
    ds_read_b128 v[168:171], v25 offset:0
    ds_read_b64_tr_b16 v[180:181], v27 offset:18432
    s_add_u32 m0, s33, 102400
    s_nop 0
    buffer_load_dwordx4 v20, s[24:27], s30 offen  lds
    v_mfma_f32_32x32x16_bf16 v[68:83], v[160:163], v[148:151], v[68:83]
    ds_read_b64_tr_b16 v[182:183], v27 offset:19968
    ds_read_b128 v[172:175], v25 offset:4096
    v_mfma_f32_32x32x16_bf16 v[116:131], v[160:163], v[152:155], v[116:131]
    ds_read_b64_tr_b16 v[184:185], v28 offset:18432
    ds_read_b64_tr_b16 v[186:187], v28 offset:19968
    v_mfma_f32_32x32x16_bf16 v[84:99], v[164:167], v[148:151], v[84:99]
    s_add_u32 m0, s33, 103424
    s_nop 0
    buffer_load_dwordx4 v21, s[24:27], s30 offen  lds
    s_add_u32 s34, s34, 1
    s_cmp_eq_u32 s34, 10
    s_cselect_b32 s35, 0xfffffb80, s38
    s_cselect_b32 s36, 0xffde4000, s37
    s_cselect_b32 s34, 0, s34
    s_add_u32 s28, s28, s35
    s_add_u32 s30, s30, s36
    v_mfma_f32_32x32x16_bf16 v[132:147], v[164:167], v[152:155], v[132:147]
    s_waitcnt vmcnt(10) lgkmcnt(0)
    s_barrier
    v_mfma_f32_32x32x16_bf16 v[52:67], v[176:179], v[168:171], v[52:67]
    ds_read_b64_tr_b16 v[156:157], v33 offset:0
    ds_read_b64_tr_b16 v[158:159], v33 offset:1536
    s_add_u32 m0, s32, 0
    s_nop 0
    buffer_load_dwordx4 v6, s[20:23], s28 offen  lds
    v_mfma_f32_32x32x16_bf16 v[100:115], v[176:179], v[172:175], v[100:115]
    ds_read_b128 v[148:151], v29 offset:0
    ds_read_b64_tr_b16 v[160:161], v34 offset:0
    v_mfma_f32_32x32x16_bf16 v[68:83], v[180:183], v[168:171], v[68:83]
    ds_read_b64_tr_b16 v[162:163], v34 offset:1536
    ds_read_b128 v[152:155], v29 offset:4096
    s_add_u32 m0, s32, 1024
    s_add_u32 s29, s28, 10240
    buffer_load_dwordx4 v7, s[20:23], s29 offen  lds
    v_mfma_f32_32x32x16_bf16 v[116:131], v[180:183], v[172:175], v[116:131]
    ds_read_b64_tr_b16 v[164:165], v35 offset:0
    ds_read_b64_tr_b16 v[166:167], v35 offset:1536
    v_mfma_f32_32x32x16_bf16 v[84:99], v[184:187], v[168:171], v[84:99]
    s_add_u32 m0, s32, 2048
    s_add_u32 s29, s28, 20480
    buffer_load_dwordx4 v6, s[20:23], s29 offen  lds
    v_mfma_f32_32x32x16_bf16 v[132:147], v[184:187], v[172:175], v[132:147]
    s_waitcnt lgkmcnt(0)
    v_mfma_f32_32x32x16_bf16 v[52:67], v[156:159], v[148:151], v[52:67]
    ds_read_b64_tr_b16 v[176:177], v33 offset:6144
    ds_read_b64_tr_b16 v[178:179], v33 offset:7680
    s_add_u32 m0, s32, 3072
    s_add_u32 s29, s28, 30720
    buffer_load_dwordx4 v7, s[20:23], s29 offen  lds
    v_mfma_f32_32x32x16_bf16 v[100:115], v[156:159], v[152:155], v[100:115]
    ds_read_b128 v[168:171], v30 offset:0
    ds_read_b64_tr_b16 v[180:181], v34 offset:6144
    v_mfma_f32_32x32x16_bf16 v[68:83], v[160:163], v[148:151], v[68:83]
    ds_read_b64_tr_b16 v[182:183], v34 offset:7680
    ds_read_b128 v[172:175], v30 offset:4096
    s_add_u32 m0, s33, 16384
    s_nop 0
    buffer_load_dwordx4 v16, s[24:27], s30 offen  lds
    v_mfma_f32_32x32x16_bf16 v[116:131], v[160:163], v[152:155], v[116:131]
    ds_read_b64_tr_b16 v[184:185], v35 offset:6144
    ds_read_b64_tr_b16 v[186:187], v35 offset:7680
    v_mfma_f32_32x32x16_bf16 v[84:99], v[164:167], v[148:151], v[84:99]
    s_add_u32 m0, s33, 17408
    s_nop 0
    buffer_load_dwordx4 v17, s[24:27], s30 offen  lds
    v_mfma_f32_32x32x16_bf16 v[132:147], v[164:167], v[152:155], v[132:147]
    s_waitcnt lgkmcnt(0)
    v_mfma_f32_32x32x16_bf16 v[52:67], v[176:179], v[168:171], v[52:67]
    ds_read_b64_tr_b16 v[156:157], v33 offset:12288
    ds_read_b64_tr_b16 v[158:159], v33 offset:13824
    v_mfma_f32_32x32x16_bf16 v[100:115], v[176:179], v[172:175], v[100:115]
    ds_read_b128 v[148:151], v31 offset:0
    ds_read_b64_tr_b16 v[160:161], v34 offset:12288
    s_add_u32 m0, s33, 18432
    s_nop 0
    buffer_load_dwordx4 v18, s[24:27], s30 offen  lds
    v_mfma_f32_32x32x16_bf16 v[68:83], v[180:183], v[168:171], v[68:83]
    ds_read_b64_tr_b16 v[162:163], v34 offset:13824
    ds_read_b128 v[152:155], v31 offset:4096
    v_mfma_f32_32x32x16_bf16 v[116:131], v[180:183], v[172:175], v[116:131]
    ds_read_b64_tr_b16 v[164:165], v35 offset:12288
    ds_read_b64_tr_b16 v[166:167], v35 offset:13824
    v_mfma_f32_32x32x16_bf16 v[84:99], v[184:187], v[168:171], v[84:99]
    s_add_u32 m0, s33, 19456
    s_nop 0
    buffer_load_dwordx4 v19, s[24:27], s30 offen  lds
    v_mfma_f32_32x32x16_bf16 v[132:147], v[184:187], v[172:175], v[132:147]
    s_waitcnt lgkmcnt(0)
    v_mfma_f32_32x32x16_bf16 v[52:67], v[156:159], v[148:151], v[52:67]
    ds_read_b64_tr_b16 v[176:177], v33 offset:18432
    ds_read_b64_tr_b16 v[178:179], v33 offset:19968
    v_mfma_f32_32x32x16_bf16 v[100:115], v[156:159], v[152:155], v[100:115]
    ds_read_b128 v[168:171], v32 offset:0
    ds_read_b64_tr_b16 v[180:181], v34 offset:18432
    s_add_u32 m0, s33, 20480
    s_nop 0
    buffer_load_dwordx4 v20, s[24:27], s30 offen  lds
    v_mfma_f32_32x32x16_bf16 v[68:83], v[160:163], v[148:151], v[68:83]
    ds_read_b64_tr_b16 v[182:183], v34 offset:19968
    ds_read_b128 v[172:175], v32 offset:4096
    v_mfma_f32_32x32x16_bf16 v[116:131], v[160:163], v[152:155], v[116:131]
    ds_read_b64_tr_b16 v[184:185], v35 offset:18432
    ds_read_b64_tr_b16 v[186:187], v35 offset:19968
    v_mfma_f32_32x32x16_bf16 v[84:99], v[164:167], v[148:151], v[84:99]
    s_add_u32 m0, s33, 21504
    s_nop 0
    buffer_load_dwordx4 v21, s[24:27], s30 offen  lds
    s_add_u32 s34, s34, 1
    s_cmp_eq_u32 s34, 10
    s_cselect_b32 s35, 0xfffffb80, s38
    s_cselect_b32 s36, 0xffde4000, s37
    s_cselect_b32 s34, 0, s34
    s_add_u32 s28, s28, s35
    s_add_u32 s30, s30, s36
    v_mfma_f32_32x32x16_bf16 v[132:147], v[164:167], v[152:155], v[132:147]
    s_waitcnt vmcnt(10) lgkmcnt(0)
    s_barrier
    v_mfma_f32_32x32x16_bf16 v[52:67], v[176:179], v[168:171], v[52:67]
    ds_read_b64_tr_b16 v[156:157], v40 offset:0
    ds_read_b64_tr_b16 v[158:159], v40 offset:1536
    s_add_u32 m0, s32, 40960
    s_nop 0
    buffer_load_dwordx4 v6, s[20:23], s28 offen  lds
    v_mfma_f32_32x32x16_bf16 v[100:115], v[176:179], v[172:175], v[100:115]
    ds_read_b128 v[148:151], v36 offset:0
    ds_read_b64_tr_b16 v[160:161], v41 offset:0
    v_mfma_f32_32x32x16_bf16 v[68:83], v[180:183], v[168:171], v[68:83]
    ds_read_b64_tr_b16 v[162:163], v41 offset:1536
    ds_read_b128 v[152:155], v36 offset:4096
    s_add_u32 m0, s32, 41984
    s_add_u32 s29, s28, 10240
    buffer_load_dwordx4 v7, s[20:23], s29 offen  lds
    v_mfma_f32_32x32x16_bf16 v[116:131], v[180:183], v[172:175], v[116:131]
    ds_read_b64_tr_b16 v[164:165], v42 offset:0
    ds_read_b64_tr_b16 v[166:167], v42 offset:1536
    v_mfma_f32_32x32x16_bf16 v[84:99], v[184:187], v[168:171], v[84:99]
    s_add_u32 m0, s32, 43008
    s_add_u32 s29, s28, 20480
    buffer_load_dwordx4 v6, s[20:23], s29 offen  lds
    v_mfma_f32_32x32x16_bf16 v[132:147], v[184:187], v[172:175], v[132:147]
    s_waitcnt lgkmcnt(0)
    v_mfma_f32_32x32x16_bf16 v[52:67], v[156:159], v[148:151], v[52:67]
    ds_read_b64_tr_b16 v[176:177], v40 offset:6144
    ds_read_b64_tr_b16 v[178:179], v40 offset:7680
    s_add_u32 m0, s32, 44032
    s_add_u32 s29, s28, 30720
    buffer_load_dwordx4 v7, s[20:23], s29 offen  lds
    v_mfma_f32_32x32x16_bf16 v[100:115], v[156:159], v[152:155], v[100:115]
    ds_read_b128 v[168:171], v37 offset:0
    ds_read_b64_tr_b16 v[180:181], v41 offset:6144
    v_mfma_f32_32x32x16_bf16 v[68:83], v[160:163], v[148:151], v[68:83]
    ds_read_b64_tr_b16 v[182:183], v41 offset:7680
    ds_read_b128 v[172:175], v37 offset:4096
    s_add_u32 m0, s33, 57344
    s_nop 0
    buffer_load_dwordx4 v16, s[24:27], s30 offen  lds
    v_mfma_f32_32x32x16_bf16 v[116:131], v[160:163], v[152:155], v[116:131]
    ds_read_b64_tr_b16 v[184:185], v42 offset:6144
    ds_read_b64_tr_b16 v[186:187], v42 offset:7680
    v_mfma_f32_32x32x16_bf16 v[84:99], v[164:167], v[148:151], v[84:99]
    s_add_u32 m0, s33, 58368
    s_nop 0
    buffer_load_dwordx4 v17, s[24:27], s30 offen  lds
    v_mfma_f32_32x32x16_bf16 v[132:147], v[164:167], v[152:155], v[132:147]
    s_waitcnt lgkmcnt(0)
    v_mfma_f32_32x32x16_bf16 v[52:67], v[176:179], v[168:171], v[52:67]
    ds_read_b64_tr_b16 v[156:157], v40 offset:12288
    ds_read_b64_tr_b16 v[158:159], v40 offset:13824
    v_mfma_f32_32x32x16_bf16 v[100:115], v[176:179], v[172:175], v[100:115]
    ds_read_b128 v[148:151], v38 offset:0
    ds_read_b64_tr_b16 v[160:161], v41 offset:12288
    s_add_u32 m0, s33, 59392
    s_nop 0
    buffer_load_dwordx4 v18, s[24:27], s30 offen  lds
    v_mfma_f32_32x32x16_bf16 v[68:83], v[180:183], v[168:171], v[68:83]
    ds_read_b64_tr_b16 v[162:163], v41 offset:13824
    ds_read_b128 v[152:155], v38 offset:4096
    v_mfma_f32_32x32x16_bf16 v[116:131], v[180:183], v[172:175], v[116:131]
    ds_read_b64_tr_b16 v[164:165], v42 offset:12288
    ds_read_b64_tr_b16 v[166:167], v42 offset:13824
    v_mfma_f32_32x32x16_bf16 v[84:99], v[184:187], v[168:171], v[84:99]
    s_add_u32 m0, s33, 60416
    s_nop 0
    buffer_load_dwordx4 v19, s[24:27], s30 offen  lds
    v_mfma_f32_32x32x16_bf16 v[132:147], v[184:187], v[172:175], v[132:147]
    s_waitcnt lgkmcnt(0)
    v_mfma_f32_32x32x16_bf16 v[52:67], v[156:159], v[148:151], v[52:67]
    ds_read_b64_tr_b16 v[176:177], v40 offset:18432
    ds_read_b64_tr_b16 v[178:179], v40 offset:19968
    v_mfma_f32_32x32x16_bf16 v[100:115], v[156:159], v[152:155], v[100:115]
    ds_read_b128 v[168:171], v39 offset:0
    ds_read_b64_tr_b16 v[180:181], v41 offset:18432
    s_add_u32 m0, s33, 61440
    s_nop 0
    buffer_load_dwordx4 v20, s[24:27], s30 offen  lds
    v_mfma_f32_32x32x16_bf16 v[68:83], v[160:163], v[148:151], v[68:83]
    ds_read_b64_tr_b16 v[182:183], v41 offset:19968
    ds_read_b128 v[172:175], v39 offset:4096
    v_mfma_f32_32x32x16_bf16 v[116:131], v[160:163], v[152:155], v[116:131]
    ds_read_b64_tr_b16 v[184:185], v42 offset:18432
    ds_read_b64_tr_b16 v[186:187], v42 offset:19968
    v_mfma_f32_32x32x16_bf16 v[84:99], v[164:167], v[148:151], v[84:99]
    s_add_u32 m0, s33, 62464
    s_nop 0
    buffer_load_dwordx4 v21, s[24:27], s30 offen  lds
    s_add_u32 s34, s34, 1
    s_cmp_eq_u32 s34, 10
    s_cselect_b32 s35, 0xfffffb80, s38
    s_cselect_b32 s36, 0xffde4000, s37
    s_cselect_b32 s34, 0, s34
    s_add_u32 s28, s28, s35
    s_add_u32 s30, s30, s36
    v_mfma_f32_32x32x16_bf16 v[132:147], v[164:167], v[152:155], v[132:147]
    s_waitcnt vmcnt(10) lgkmcnt(0)
    s_barrier
    v_mfma_f32_32x32x16_bf16 v[52:67], v[176:179], v[168:171], v[52:67]
    ds_read_b64_tr_b16 v[156:157], v26 offset:0
    ds_read_b64_tr_b16 v[158:159], v26 offset:1536
    s_add_u32 m0, s32, 81920
    s_nop 0
    buffer_load_dwordx4 v6, s[20:23], s28 offen  lds
    v_mfma_f32_32x32x16_bf16 v[100:115], v[176:179], v[172:175], v[100:115]
    ds_read_b128 v[148:151], v22 offset:0
    ds_read_b64_tr_b16 v[160:161], v27 offset:0
    v_mfma_f32_32x32x16_bf16 v[68:83], v[180:183], v[168:171], v[68:83]
    ds_read_b64_tr_b16 v[162:163], v27 offset:1536
    ds_read_b128 v[152:155], v22 offset:4096
    s_add_u32 m0, s32, 82944
    s_add_u32 s29, s28, 10240
    buffer_load_dwordx4 v7, s[20:23], s29 offen  lds
    v_mfma_f32_32x32x16_bf16 v[116:131], v[180:183], v[172:175], v[116:131]
    ds_read_b64_tr_b16 v[164:165], v28 offset:0
    ds_read_b64_tr_b16 v[166:167], v28 offset:1536
    v_mfma_f32_32x32x16_bf16 v[84:99], v[184:187], v[168:171], v[84:99]
    s_add_u32 m0, s32, 83968
    s_add_u32 s29, s28, 20480
    buffer_load_dwordx4 v6, s[20:23], s29 offen  lds
    v_mfma_f32_32x32x16_bf16 v[132:147], v[184:187], v[172:175], v[132:147]
    s_waitcnt lgkmcnt(0)
    v_mfma_f32_32x32x16_bf16 v[52:67], v[156:159], v[148:151], v[52:67]
    ds_read_b64_tr_b16 v[176:177], v26 offset:6144
    ds_read_b64_tr_b16 v[178:179], v26 offset:7680
    s_add_u32 m0, s32, 84992
    s_add_u32 s29, s28, 30720
    buffer_load_dwordx4 v7, s[20:23], s29 offen  lds
    v_mfma_f32_32x32x16_bf16 v[100:115], v[156:159], v[152:155], v[100:115]
    ds_read_b128 v[168:171], v23 offset:0
    ds_read_b64_tr_b16 v[180:181], v27 offset:6144
    v_mfma_f32_32x32x16_bf16 v[68:83], v[160:163], v[148:151], v[68:83]
    ds_read_b64_tr_b16 v[182:183], v27 offset:7680
    ds_read_b128 v[172:175], v23 offset:4096
    s_add_u32 m0, s33, 98304
    s_nop 0
    buffer_load_dwordx4 v16, s[24:27], s30 offen  lds
    v_mfma_f32_32x32x16_bf16 v[116:131], v[160:163], v[152:155], v[116:131]
    ds_read_b64_tr_b16 v[184:185], v28 offset:6144
    ds_read_b64_tr_b16 v[186:187], v28 offset:7680
    v_mfma_f32_32x32x16_bf16 v[84:99], v[164:167], v[148:151], v[84:99]
    s_add_u32 m0, s33, 99328
    s_nop 0
    buffer_load_dwordx4 v17, s[24:27], s30 offen  lds
    v_mfma_f32_32x32x16_bf16 v[132:147], v[164:167], v[152:155], v[132:147]
    s_waitcnt lgkmcnt(0)
    v_mfma_f32_32x32x16_bf16 v[52:67], v[176:179], v[168:171], v[52:67]
    ds_read_b64_tr_b16 v[156:157], v26 offset:12288
    ds_read_b64_tr_b16 v[158:159], v26 offset:13824
    v_mfma_f32_32x32x16_bf16 v[100:115], v[176:179], v[172:175], v[100:115]
    ds_read_b128 v[148:151], v24 offset:0
    ds_read_b64_tr_b16 v[160:161], v27 offset:12288
    s_add_u32 m0, s33, 100352
    s_nop 0
    buffer_load_dwordx4 v18, s[24:27], s30 offen  lds
    v_mfma_f32_32x32x16_bf16 v[68:83], v[180:183], v[168:171], v[68:83]
    ds_read_b64_tr_b16 v[162:163], v27 offset:13824
    ds_read_b128 v[152:155], v24 offset:4096
    v_mfma_f32_32x32x16_bf16 v[116:131], v[180:183], v[172:175], v[116:131]
    ds_read_b64_tr_b16 v[164:165], v28 offset:12288
    ds_read_b64_tr_b16 v[166:167], v28 offset:13824
    v_mfma_f32_32x32x16_bf16 v[84:99], v[184:187], v[168:171], v[84:99]
    s_add_u32 m0, s33, 101376
    s_nop 0
    buffer_load_dwordx4 v19, s[24:27], s30 offen  lds
    v_mfma_f32_32x32x16_bf16 v[132:147], v[184:187], v[172:175], v[132:147]
    s_waitcnt lgkmcnt(0)
    v_mfma_f32_32x32x16_bf16 v[52:67], v[156:159], v[148:151], v[52:67]
    ds_read_b64_tr_b16 v[176:177], v26 offset:18432
    ds_read_b64_tr_b16 v[178:179], v26 offset:19968
    v_mfma_f32_32x32x16_bf16 v[100:115], v[156:159], v[152:155], v[100:115]
    ds_read_b128 v[168:171], v25 offset:0
    ds_read_b64_tr_b16 v[180:181], v27 offset:18432
    s_add_u32 m0, s33, 102400
    s_nop 0
    buffer_load_dwordx4 v20, s[24:27], s30 offen  lds
    v_mfma_f32_32x32x16_bf16 v[68:83], v[160:163], v[148:151], v[68:83]
    ds_read_b64_tr_b16 v[182:183], v27 offset:19968
    ds_read_b128 v[172:175], v25 offset:4096
    v_mfma_f32_32x32x16_bf16 v[116:131], v[160:163], v[152:155], v[116:131]
    ds_read_b64_tr_b16 v[184:185], v28 offset:18432
    ds_read_b64_tr_b16 v[186:187], v28 offset:19968
    v_mfma_f32_32x32x16_bf16 v[84:99], v[164:167], v[148:151], v[84:99]
    s_add_u32 m0, s33, 103424
    s_nop 0
    buffer_load_dwordx4 v21, s[24:27], s30 offen  lds
    s_add_u32 s34, s34, 1
    s_cmp_eq_u32 s34, 10
    s_cselect_b32 s35, 0xfffffb80, s38
    s_cselect_b32 s36, 0xffde4000, s37
    s_cselect_b32 s34, 0, s34
    s_add_u32 s28, s28, s35
    s_add_u32 s30, s30, s36
    v_mfma_f32_32x32x16_bf16 v[132:147], v[164:167], v[152:155], v[132:147]
    s_waitcnt vmcnt(10) lgkmcnt(0)
    s_barrier
    v_mfma_f32_32x32x16_bf16 v[52:67], v[176:179], v[168:171], v[52:67]
    ds_read_b64_tr_b16 v[156:157], v33 offset:0
    ds_read_b64_tr_b16 v[158:159], v33 offset:1536
    s_add_u32 m0, s32, 0
    s_nop 0
    buffer_load_dwordx4 v6, s[20:23], s28 offen  lds
    v_mfma_f32_32x32x16_bf16 v[100:115], v[176:179], v[172:175], v[100:115]
    ds_read_b128 v[148:151], v29 offset:0
    ds_read_b64_tr_b16 v[160:161], v34 offset:0
    v_mfma_f32_32x32x16_bf16 v[68:83], v[180:183], v[168:171], v[68:83]
    ds_read_b64_tr_b16 v[162:163], v34 offset:1536
    ds_read_b128 v[152:155], v29 offset:4096
    s_add_u32 m0, s32, 1024
    s_add_u32 s29, s28, 10240
    buffer_load_dwordx4 v7, s[20:23], s29 offen  lds
    v_mfma_f32_32x32x16_bf16 v[116:131], v[180:183], v[172:175], v[116:131]
    ds_read_b64_tr_b16 v[164:165], v35 offset:0
    ds_read_b64_tr_b16 v[166:167], v35 offset:1536
    v_mfma_f32_32x32x16_bf16 v[84:99], v[184:187], v[168:171], v[84:99]
    s_add_u32 m0, s32, 2048
    s_add_u32 s29, s28, 20480
    buffer_load_dwordx4 v6, s[20:23], s29 offen  lds
    v_mfma_f32_32x32x16_bf16 v[132:147], v[184:187], v[172:175], v[132:147]
    s_waitcnt lgkmcnt(0)
    v_mfma_f32_32x32x16_bf16 v[52:67], v[156:159], v[148:151], v[52:67]
    ds_read_b64_tr_b16 v[176:177], v33 offset:6144
    ds_read_b64_tr_b16 v[178:179], v33 offset:7680
    s_add_u32 m0, s32, 3072
    s_add_u32 s29, s28, 30720
    buffer_load_dwordx4 v7, s[20:23], s29 offen  lds
    v_mfma_f32_32x32x16_bf16 v[100:115], v[156:159], v[152:155], v[100:115]
    ds_read_b128 v[168:171], v30 offset:0
    ds_read_b64_tr_b16 v[180:181], v34 offset:6144
    v_mfma_f32_32x32x16_bf16 v[68:83], v[160:163], v[148:151], v[68:83]
    ds_read_b64_tr_b16 v[182:183], v34 offset:7680
    ds_read_b128 v[172:175], v30 offset:4096
    s_add_u32 m0, s33, 16384
    s_nop 0
    buffer_load_dwordx4 v16, s[24:27], s30 offen  lds
    v_mfma_f32_32x32x16_bf16 v[116:131], v[160:163], v[152:155], v[116:131]
    ds_read_b64_tr_b16 v[184:185], v35 offset:6144
    ds_read_b64_tr_b16 v[186:187], v35 offset:7680
    v_mfma_f32_32x32x16_bf16 v[84:99], v[164:167], v[148:151], v[84:99]
    s_add_u32 m0, s33, 17408
    s_nop 0
    buffer_load_dwordx4 v17, s[24:27], s30 offen  lds
    v_mfma_f32_32x32x16_bf16 v[132:147], v[164:167], v[152:155], v[132:147]
    s_waitcnt lgkmcnt(0)
    v_mfma_f32_32x32x16_bf16 v[52:67], v[176:179], v[168:171], v[52:67]
    ds_read_b64_tr_b16 v[156:157], v33 offset:12288
    ds_read_b64_tr_b16 v[158:159], v33 offset:13824
    v_mfma_f32_32x32x16_bf16 v[100:115], v[176:179], v[172:175], v[100:115]
    ds_read_b128 v[148:151], v31 offset:0
    ds_read_b64_tr_b16 v[160:161], v34 offset:12288
    s_add_u32 m0, s33, 18432
    s_nop 0
    buffer_load_dwordx4 v18, s[24:27], s30 offen  lds
    v_mfma_f32_32x32x16_bf16 v[68:83], v[180:183], v[168:171], v[68:83]
    ds_read_b64_tr_b16 v[162:163], v34 offset:13824
    ds_read_b128 v[152:155], v31 offset:4096
    v_mfma_f32_32x32x16_bf16 v[116:131], v[180:183], v[172:175], v[116:131]
    ds_read_b64_tr_b16 v[164:165], v35 offset:12288
    ds_read_b64_tr_b16 v[166:167], v35 offset:13824
    v_mfma_f32_32x32x16_bf16 v[84:99], v[184:187], v[168:171], v[84:99]
    s_add_u32 m0, s33, 19456
    s_nop 0
    buffer_load_dwordx4 v19, s[24:27], s30 offen  lds
    v_mfma_f32_32x32x16_bf16 v[132:147], v[184:187], v[172:175], v[132:147]
    s_waitcnt lgkmcnt(0)
    v_mfma_f32_32x32x16_bf16 v[52:67], v[156:159], v[148:151], v[52:67]
    ds_read_b64_tr_b16 v[176:177], v33 offset:18432
    ds_read_b64_tr_b16 v[178:179], v33 offset:19968
    v_mfma_f32_32x32x16_bf16 v[100:115], v[156:159], v[152:155], v[100:115]
    ds_read_b128 v[168:171], v32 offset:0
    ds_read_b64_tr_b16 v[180:181], v34 offset:18432
    s_add_u32 m0, s33, 20480
    s_nop 0
    buffer_load_dwordx4 v20, s[24:27], s30 offen  lds
    v_mfma_f32_32x32x16_bf16 v[68:83], v[160:163], v[148:151], v[68:83]
    ds_read_b64_tr_b16 v[182:183], v34 offset:19968
    ds_read_b128 v[172:175], v32 offset:4096
    v_mfma_f32_32x32x16_bf16 v[116:131], v[160:163], v[152:155], v[116:131]
    ds_read_b64_tr_b16 v[184:185], v35 offset:18432
    ds_read_b64_tr_b16 v[186:187], v35 offset:19968
    v_mfma_f32_32x32x16_bf16 v[84:99], v[164:167], v[148:151], v[84:99]
    s_add_u32 m0, s33, 21504
    s_nop 0
    buffer_load_dwordx4 v21, s[24:27], s30 offen  lds
    s_add_u32 s34, s34, 1
    s_cmp_eq_u32 s34, 10
    s_cselect_b32 s35, 0xfffffb80, s38
    s_cselect_b32 s36, 0xffde4000, s37
    s_cselect_b32 s34, 0, s34
    s_add_u32 s28, s28, s35
    s_add_u32 s30, s30, s36
    v_mfma_f32_32x32x16_bf16 v[132:147], v[164:167], v[152:155], v[132:147]
    s_waitcnt vmcnt(10) lgkmcnt(0)
    s_barrier
    v_mfma_f32_32x32x16_bf16 v[52:67], v[176:179], v[168:171], v[52:67]
    ds_read_b64_tr_b16 v[156:157], v40 offset:0
    ds_read_b64_tr_b16 v[158:159], v40 offset:1536
    v_mfma_f32_32x32x16_bf16 v[100:115], v[176:179], v[172:175], v[100:115]
    ds_read_b128 v[148:151], v36 offset:0
    ds_read_b64_tr_b16 v[160:161], v41 offset:0
    v_mfma_f32_32x32x16_bf16 v[68:83], v[180:183], v[168:171], v[68:83]
    ds_read_b64_tr_b16 v[162:163], v41 offset:1536
    ds_read_b128 v[152:155], v36 offset:4096
    v_mfma_f32_32x32x16_bf16 v[116:131], v[180:183], v[172:175], v[116:131]
    ds_read_b64_tr_b16 v[164:165], v42 offset:0
    ds_read_b64_tr_b16 v[166:167], v42 offset:1536
    v_mfma_f32_32x32x16_bf16 v[84:99], v[184:187], v[168:171], v[84:99]
    v_mfma_f32_32x32x16_bf16 v[132:147], v[184:187], v[172:175], v[132:147]
    s_waitcnt lgkmcnt(0)
    v_mfma_f32_32x32x16_bf16 v[52:67], v[156:159], v[148:151], v[52:67]
    ds_read_b64_tr_b16 v[176:177], v40 offset:6144
    ds_read_b64_tr_b16 v[178:179], v40 offset:7680
    v_mfma_f32_32x32x16_bf16 v[100:115], v[156:159], v[152:155], v[100:115]
    ds_read_b128 v[168:171], v37 offset:0
    ds_read_b64_tr_b16 v[180:181], v41 offset:6144
    v_mfma_f32_32x32x16_bf16 v[68:83], v[160:163], v[148:151], v[68:83]
    ds_read_b64_tr_b16 v[182:183], v41 offset:7680
    ds_read_b128 v[172:175], v37 offset:4096
    v_mfma_f32_32x32x16_bf16 v[116:131], v[160:163], v[152:155], v[116:131]
    ds_read_b64_tr_b16 v[184:185], v42 offset:6144
    ds_read_b64_tr_b16 v[186:187], v42 offset:7680
    v_mfma_f32_32x32x16_bf16 v[84:99], v[164:167], v[148:151], v[84:99]
    v_mfma_f32_32x32x16_bf16 v[132:147], v[164:167], v[152:155], v[132:147]
    s_waitcnt lgkmcnt(0)
    v_mfma_f32_32x32x16_bf16 v[52:67], v[176:179], v[168:171], v[52:67]
    ds_read_b64_tr_b16 v[156:157], v40 offset:12288
    ds_read_b64_tr_b16 v[158:159], v40 offset:13824
    v_mfma_f32_32x32x16_bf16 v[100:115], v[176:179], v[172:175], v[100:115]
    ds_read_b128 v[148:151], v38 offset:0
    ds_read_b64_tr_b16 v[160:161], v41 offset:12288
    v_mfma_f32_32x32x16_bf16 v[68:83], v[180:183], v[168:171], v[68:83]
    ds_read_b64_tr_b16 v[162:163], v41 offset:13824
    ds_read_b128 v[152:155], v38 offset:4096
    v_mfma_f32_32x32x16_bf16 v[116:131], v[180:183], v[172:175], v[116:131]
    ds_read_b64_tr_b16 v[164:165], v42 offset:12288
    ds_read_b64_tr_b16 v[166:167], v42 offset:13824
    v_mfma_f32_32x32x16_bf16 v[84:99], v[184:187], v[168:171], v[84:99]
    v_mfma_f32_32x32x16_bf16 v[132:147], v[184:187], v[172:175], v[132:147]
    s_waitcnt lgkmcnt(0)
    v_mfma_f32_32x32x16_bf16 v[52:67], v[156:159], v[148:151], v[52:67]
    ds_read_b64_tr_b16 v[176:177], v40 offset:18432
    ds_read_b64_tr_b16 v[178:179], v40 offset:19968
    v_mfma_f32_32x32x16_bf16 v[100:115], v[156:159], v[152:155], v[100:115]
    ds_read_b128 v[168:171], v39 offset:0
    ds_read_b64_tr_b16 v[180:181], v41 offset:18432
    v_mfma_f32_32x32x16_bf16 v[68:83], v[160:163], v[148:151], v[68:83]
    ds_read_b64_tr_b16 v[182:183], v41 offset:19968
    ds_read_b128 v[172:175], v39 offset:4096
    v_mfma_f32_32x32x16_bf16 v[116:131], v[160:163], v[152:155], v[116:131]
    ds_read_b64_tr_b16 v[184:185], v42 offset:18432
    ds_read_b64_tr_b16 v[186:187], v42 offset:19968
    v_mfma_f32_32x32x16_bf16 v[84:99], v[164:167], v[148:151], v[84:99]
    v_mfma_f32_32x32x16_bf16 v[132:147], v[164:167], v[152:155], v[132:147]
    s_waitcnt vmcnt(0) lgkmcnt(0)
    s_barrier
    v_mfma_f32_32x32x16_bf16 v[52:67], v[176:179], v[168:171], v[52:67]
    ds_read_b64_tr_b16 v[156:157], v26 offset:0
    ds_read_b64_tr_b16 v[158:159], v26 offset:1536
    v_mfma_f32_32x32x16_bf16 v[100:115], v[176:179], v[172:175], v[100:115]
    ds_read_b128 v[148:151], v22 offset:0
    ds_read_b64_tr_b16 v[160:161], v27 offset:0
    v_mfma_f32_32x32x16_bf16 v[68:83], v[180:183], v[168:171], v[68:83]
    ds_read_b64_tr_b16 v[162:163], v27 offset:1536
    ds_read_b128 v[152:155], v22 offset:4096
    v_mfma_f32_32x32x16_bf16 v[116:131], v[180:183], v[172:175], v[116:131]
    ds_read_b64_tr_b16 v[164:165], v28 offset:0
    ds_read_b64_tr_b16 v[166:167], v28 offset:1536
    v_mfma_f32_32x32x16_bf16 v[84:99], v[184:187], v[168:171], v[84:99]
    v_mfma_f32_32x32x16_bf16 v[132:147], v[184:187], v[172:175], v[132:147]
    s_waitcnt lgkmcnt(0)
    v_mfma_f32_32x32x16_bf16 v[52:67], v[156:159], v[148:151], v[52:67]
    ds_read_b64_tr_b16 v[176:177], v26 offset:6144
    ds_read_b64_tr_b16 v[178:179], v26 offset:7680
    v_mfma_f32_32x32x16_bf16 v[100:115], v[156:159], v[152:155], v[100:115]
    ds_read_b128 v[168:171], v23 offset:0
    ds_read_b64_tr_b16 v[180:181], v27 offset:6144
    v_mfma_f32_32x32x16_bf16 v[68:83], v[160:163], v[148:151], v[68:83]
    ds_read_b64_tr_b16 v[182:183], v27 offset:7680
    ds_read_b128 v[172:175], v23 offset:4096
    v_mfma_f32_32x32x16_bf16 v[116:131], v[160:163], v[152:155], v[116:131]
    ds_read_b64_tr_b16 v[184:185], v28 offset:6144
    ds_read_b64_tr_b16 v[186:187], v28 offset:7680
    v_mfma_f32_32x32x16_bf16 v[84:99], v[164:167], v[148:151], v[84:99]
    v_mfma_f32_32x32x16_bf16 v[132:147], v[164:167], v[152:155], v[132:147]
    s_waitcnt lgkmcnt(0)
    v_mfma_f32_32x32x16_bf16 v[52:67], v[176:179], v[168:171], v[52:67]
    ds_read_b64_tr_b16 v[156:157], v26 offset:12288
    ds_read_b64_tr_b16 v[158:159], v26 offset:13824
    v_mfma_f32_32x32x16_bf16 v[100:115], v[176:179], v[172:175], v[100:115]
    ds_read_b128 v[148:151], v24 offset:0
    ds_read_b64_tr_b16 v[160:161], v27 offset:12288
    v_mfma_f32_32x32x16_bf16 v[68:83], v[180:183], v[168:171], v[68:83]
    ds_read_b64_tr_b16 v[162:163], v27 offset:13824
    ds_read_b128 v[152:155], v24 offset:4096
    v_mfma_f32_32x32x16_bf16 v[116:131], v[180:183], v[172:175], v[116:131]
    ds_read_b64_tr_b16 v[164:165], v28 offset:12288
    ds_read_b64_tr_b16 v[166:167], v28 offset:13824
    v_mfma_f32_32x32x16_bf16 v[84:99], v[184:187], v[168:171], v[84:99]
    v_mfma_f32_32x32x16_bf16 v[132:147], v[184:187], v[172:175], v[132:147]
    s_waitcnt lgkmcnt(0)
    v_mfma_f32_32x32x16_bf16 v[52:67], v[156:159], v[148:151], v[52:67]
    ds_read_b64_tr_b16 v[176:177], v26 offset:18432
    ds_read_b64_tr_b16 v[178:179], v26 offset:19968
    v_mfma_f32_32x32x16_bf16 v[100:115], v[156:159], v[152:155], v[100:115]
    ds_read_b128 v[168:171], v25 offset:0
    ds_read_b64_tr_b16 v[180:181], v27 offset:18432
    v_mfma_f32_32x32x16_bf16 v[68:83], v[160:163], v[148:151], v[68:83]
    ds_read_b64_tr_b16 v[182:183], v27 offset:19968
    ds_read_b128 v[172:175], v25 offset:4096
    v_mfma_f32_32x32x16_bf16 v[116:131], v[160:163], v[152:155], v[116:131]
    ds_read_b64_tr_b16 v[184:185], v28 offset:18432
    ds_read_b64_tr_b16 v[186:187], v28 offset:19968
    v_mfma_f32_32x32x16_bf16 v[84:99], v[164:167], v[148:151], v[84:99]
    v_mfma_f32_32x32x16_bf16 v[132:147], v[164:167], v[152:155], v[132:147]
    s_waitcnt lgkmcnt(0)
    v_mfma_f32_32x32x16_bf16 v[52:67], v[176:179], v[168:171], v[52:67]
    v_mfma_f32_32x32x16_bf16 v[100:115], v[176:179], v[172:175], v[100:115]
    v_mfma_f32_32x32x16_bf16 v[68:83], v[180:183], v[168:171], v[68:83]
    v_mfma_f32_32x32x16_bf16 v[116:131], v[180:183], v[172:175], v[116:131]
    v_mfma_f32_32x32x16_bf16 v[84:99], v[184:187], v[168:171], v[84:99]
    v_mfma_f32_32x32x16_bf16 v[132:147], v[184:187], v[172:175], v[132:147]
    s_nop 15
    s_add_u32 s40, s8, 0x280000
    s_addc_u32 s41, s9, 0
    s_mov_b32 s42, 0x500000
    s_mov_b32 s43, 0x00020000
    v_lshlrev_b32 v21, 14, v9
    v_lshl_add_u32 v21, v8, 3, v21
    s_lshl_b32 s48, s15, 9
    v_add_u32 v21, s48, v21
    s_lshl_b32 s48, s39, 17
    s_lshl_b32 s49, s10, 10
    s_add_u32 s48, s48, s49
    s_add_u32 s49, s48, 0
    v_cvt_pk_bf16_f32 v148, v52, v53
    v_cvt_pk_bf16_f32 v149, v54, v55
    buffer_store_dwordx2 v[148:149], v21, s[40:43], s49 offen offset:0 sc1
    v_cvt_pk_bf16_f32 v152, v100, v101
    v_cvt_pk_bf16_f32 v153, v102, v103
    buffer_store_dwordx2 v[152:153], v21, s[40:43], s49 offen offset:256 sc1
    s_add_u32 s49, s48, 32768
    v_cvt_pk_bf16_f32 v156, v56, v57
    v_cvt_pk_bf16_f32 v157, v58, v59
    buffer_store_dwordx2 v[156:157], v21, s[40:43], s49 offen offset:0 sc1
    v_cvt_pk_bf16_f32 v160, v104, v105
    v_cvt_pk_bf16_f32 v161, v106, v107
    buffer_store_dwordx2 v[160:161], v21, s[40:43], s49 offen offset:256 sc1
    s_add_u32 s49, s48, 65536
    v_cvt_pk_bf16_f32 v164, v60, v61
    v_cvt_pk_bf16_f32 v165, v62, v63
    buffer_store_dwordx2 v[164:165], v21, s[40:43], s49 offen offset:0 sc1
    v_cvt_pk_bf16_f32 v168, v108, v109
    v_cvt_pk_bf16_f32 v169, v110, v111
    buffer_store_dwordx2 v[168:169], v21, s[40:43], s49 offen offset:256 sc1
    s_add_u32 s49, s48, 98304
    v_cvt_pk_bf16_f32 v172, v64, v65
    v_cvt_pk_bf16_f32 v173, v66, v67
    buffer_store_dwordx2 v[172:173], v21, s[40:43], s49 offen offset:0 sc1
    v_cvt_pk_bf16_f32 v176, v112, v113
    v_cvt_pk_bf16_f32 v177, v114, v115
    buffer_store_dwordx2 v[176:177], v21, s[40:43], s49 offen offset:256 sc1
    s_add_u32 s49, s48, 131072
    v_cvt_pk_bf16_f32 v148, v68, v69
    v_cvt_pk_bf16_f32 v149, v70, v71
    buffer_store_dwordx2 v[148:149], v21, s[40:43], s49 offen offset:0 sc1
    v_cvt_pk_bf16_f32 v152, v116, v117
    v_cvt_pk_bf16_f32 v153, v118, v119
    buffer_store_dwordx2 v[152:153], v21, s[40:43], s49 offen offset:256 sc1
    s_add_u32 s49, s48, 163840
    v_cvt_pk_bf16_f32 v156, v72, v73
    v_cvt_pk_bf16_f32 v157, v74, v75
    buffer_store_dwordx2 v[156:157], v21, s[40:43], s49 offen offset:0 sc1
    v_cvt_pk_bf16_f32 v160, v120, v121
    v_cvt_pk_bf16_f32 v161, v122, v123
    buffer_store_dwordx2 v[160:161], v21, s[40:43], s49 offen offset:256 sc1
    s_add_u32 s49, s48, 196608
    v_cvt_pk_bf16_f32 v164, v76, v77
    v_cvt_pk_bf16_f32 v165, v78, v79
    buffer_store_dwordx2 v[164:165], v21, s[40:43], s49 offen offset:0 sc1
    v_cvt_pk_bf16_f32 v168, v124, v125
    v_cvt_pk_bf16_f32 v169, v126, v127
    buffer_store_dwordx2 v[168:169], v21, s[40:43], s49 offen offset:256 sc1
    s_add_u32 s49, s48, 229376
    v_cvt_pk_bf16_f32 v172, v80, v81
    v_cvt_pk_bf16_f32 v173, v82, v83
    buffer_store_dwordx2 v[172:173], v21, s[40:43], s49 offen offset:0 sc1
    v_cvt_pk_bf16_f32 v176, v128, v129
    v_cvt_pk_bf16_f32 v177, v130, v131
    buffer_store_dwordx2 v[176:177], v21, s[40:43], s49 offen offset:256 sc1
    s_add_u32 s49, s48, 262144
    v_cvt_pk_bf16_f32 v148, v84, v85
    v_cvt_pk_bf16_f32 v149, v86, v87
    buffer_store_dwordx2 v[148:149], v21, s[40:43], s49 offen offset:0 sc1
    v_cvt_pk_bf16_f32 v152, v132, v133
    v_cvt_pk_bf16_f32 v153, v134, v135
    buffer_store_dwordx2 v[152:153], v21, s[40:43], s49 offen offset:256 sc1
    s_add_u32 s49, s48, 294912
    v_cvt_pk_bf16_f32 v156, v88, v89
    v_cvt_pk_bf16_f32 v157, v90, v91
    buffer_store_dwordx2 v[156:157], v21, s[40:43], s49 offen offset:0 sc1
    v_cvt_pk_bf16_f32 v160, v136, v137
    v_cvt_pk_bf16_f32 v161, v138, v139
    buffer_store_dwordx2 v[160:161], v21, s[40:43], s49 offen offset:256 sc1
    s_add_u32 s49, s48, 327680
    v_cvt_pk_bf16_f32 v164, v92, v93
    v_cvt_pk_bf16_f32 v165, v94, v95
    buffer_store_dwordx2 v[164:165], v21, s[40:43], s49 offen offset:0 sc1
    v_cvt_pk_bf16_f32 v168, v140, v141
    v_cvt_pk_bf16_f32 v169, v142, v143
    buffer_store_dwordx2 v[168:169], v21, s[40:43], s49 offen offset:256 sc1
    s_add_u32 s49, s48, 360448
    v_cvt_pk_bf16_f32 v172, v96, v97
    v_cvt_pk_bf16_f32 v173, v98, v99
    buffer_store_dwordx2 v[172:173], v21, s[40:43], s49 offen offset:0 sc1
    v_cvt_pk_bf16_f32 v176, v144, v145
    v_cvt_pk_bf16_f32 v177, v146, v147
    buffer_store_dwordx2 v[176:177], v21, s[40:43], s49 offen offset:256 sc1
    s_endpgm
.g1v_3:
    s_waitcnt vmcnt(10) lgkmcnt(0)
    s_barrier
    ds_read_b64_tr_b16 v[156:157], v26 offset:0
    ds_read_b64_tr_b16 v[158:159], v26 offset:1536
    ds_read_b128 v[148:151], v22 offset:0
    ds_read_b64_tr_b16 v[160:161], v27 offset:0
    ds_read_b64_tr_b16 v[162:163], v27 offset:1536
    ds_read_b128 v[152:155], v22 offset:4096
    ds_read_b64_tr_b16 v[164:165], v28 offset:0
    ds_read_b64_tr_b16 v[166:167], v28 offset:1536
    s_add_u32 m0, s32, 81920
    s_nop 0
    buffer_load_dwordx4 v6, s[20:23], s28 offen  lds
    s_add_u32 m0, s32, 82944
    s_add_u32 s29, s28, 10240
    buffer_load_dwordx4 v7, s[20:23], s29 offen  lds
    s_add_u32 m0, s32, 83968
    s_add_u32 s29, s28, 20480
    buffer_load_dwordx4 v6, s[20:23], s29 offen  lds
    s_waitcnt lgkmcnt(0)
    v_mfma_f32_32x32x16_bf16 v[52:67], v[148:151], v[156:159], 0
    ds_read_b64_tr_b16 v[176:177], v26 offset:6144
    ds_read_b64_tr_b16 v[178:179], v26 offset:7680
    s_add_u32 m0, s32, 84992
    s_add_u32 s29, s28, 30720
    buffer_load_dwordx4 v7, s[20:23], s29 offen  lds
    v_mfma_f32_32x32x16_bf16 v[100:115], v[152:155], v[156:159], 0
    ds_read_b128 v[168:171], v23 offset:0
    ds_read_b64_tr_b16 v[180:181], v27 offset:6144
    v_mfma_f32_32x32x16_bf16 v[68:83], v[148:151], v[160:163], 0
    ds_read_b64_tr_b16 v[182:183], v27 offset:7680
    ds_read_b128 v[172:175], v23 offset:4096
    s_add_u32 m0, s33, 98304
    s_nop 0
    buffer_load_dwordx4 v16, s[24:27], s30 offen  lds
    v_mfma_f32_32x32x16_bf16 v[116:131], v[152:155], v[160:163], 0
    ds_read_b64_tr_b16 v[184:185], v28 offset:6144
    ds_read_b64_tr_b16 v[186:187], v28 offset:7680
    v_mfma_f32_32x32x16_bf16 v[84:99], v[148:151], v[164:167], 0
    s_add_u32 m0, s33, 99328
    s_nop 0
    buffer_load_dwordx4 v17, s[24:27], s30 offen  lds
    v_mfma_f32_32x32x16_bf16 v[132:147], v[152:155], v[164:167], 0
    s_waitcnt lgkmcnt(0)
    v_mfma_f32_32x32x16_bf16 v[52:67], v[168:171], v[176:179], v[52:67]
    ds_read_b64_tr_b16 v[156:157], v26 offset:12288
    ds_read_b64_tr_b16 v[158:159], v26 offset:13824
    v_mfma_f32_32x32x16_bf16 v[100:115], v[172:175], v[176:179], v[100:115]
    ds_read_b128 v[148:151], v24 offset:0
    ds_read_b64_tr_b16 v[160:161], v27 offset:12288
    s_add_u32 m0, s33, 100352
    s_nop 0
    buffer_load_dwordx4 v18, s[24:27], s30 offen  lds
    v_mfma_f32_32x32x16_bf16 v[68:83], v[168:171], v[180:183], v[68:83]
    ds_read_b64_tr_b16 v[162:163], v27 offset:13824
    ds_read_b128 v[152:155], v24 offset:4096
    v_mfma_f32_32x32x16_bf16 v[116:131], v[172:175], v[180:183], v[116:131]
    ds_read_b64_tr_b16 v[164:165], v28 offset:12288
    ds_read_b64_tr_b16 v[166:167], v28 offset:13824
    v_mfma_f32_32x32x16_bf16 v[84:99], v[168:171], v[184:187], v[84:99]
    s_add_u32 m0, s33, 101376
    s_nop 0
    buffer_load_dwordx4 v19, s[24:27], s30 offen  lds
    v_mfma_f32_32x32x16_bf16 v[132:147], v[172:175], v[184:187], v[132:147]
    s_waitcnt lgkmcnt(0)
    v_mfma_f32_32x32x16_bf16 v[52:67], v[148:151], v[156:159], v[52:67]
    ds_read_b64_tr_b16 v[176:177], v26 offset:18432
    ds_read_b64_tr_b16 v[178:179], v26 offset:19968
    v_mfma_f32_32x32x16_bf16 v[100:115], v[152:155], v[156:159], v[100:115]
    ds_read_b128 v[168:171], v25 offset:0
    ds_read_b64_tr_b16 v[180:181], v27 offset:18432
    s_add_u32 m0, s33, 102400
    s_nop 0
    buffer_load_dwordx4 v20, s[24:27], s30 offen  lds
    v_mfma_f32_32x32x16_bf16 v[68:83], v[148:151], v[160:163], v[68:83]
    ds_read_b64_tr_b16 v[182:183], v27 offset:19968
    ds_read_b128 v[172:175], v25 offset:4096
    v_mfma_f32_32x32x16_bf16 v[116:131], v[152:155], v[160:163], v[116:131]
    ds_read_b64_tr_b16 v[184:185], v28 offset:18432
    ds_read_b64_tr_b16 v[186:187], v28 offset:19968
    v_mfma_f32_32x32x16_bf16 v[84:99], v[148:151], v[164:167], v[84:99]
    s_add_u32 m0, s33, 103424
    s_nop 0
    buffer_load_dwordx4 v21, s[24:27], s30 offen  lds
    s_add_u32 s34, s34, 1
    s_cmp_eq_u32 s34, 10
    s_cselect_b32 s35, 0xfffffb80, s38
    s_cselect_b32 s36, 0xffde4000, s37
    s_cselect_b32 s34, 0, s34
    s_add_u32 s28, s28, s35
    s_add_u32 s30, s30, s36
    v_mfma_f32_32x32x16_bf16 v[132:147], v[152:155], v[164:167], v[132:147]
    s_waitcnt vmcnt(10) lgkmcnt(0)
    s_barrier
    v_mfma_f32_32x32x16_bf16 v[52:67], v[168:171], v[176:179], v[52:67]
    ds_read_b64_tr_b16 v[156:157], v33 offset:0
    ds_read_b64_tr_b16 v[158:159], v33 offset:1536
    s_add_u32 m0, s32, 0
    s_nop 0
    buffer_load_dwordx4 v6, s[20:23], s28 offen  lds
    v_mfma_f32_32x32x16_bf16 v[100:115], v[172:175], v[176:179], v[100:115]
    ds_read_b128 v[148:151], v29 offset:0
    ds_read_b64_tr_b16 v[160:161], v34 offset:0
    v_mfma_f32_32x32x16_bf16 v[68:83], v[168:171], v[180:183], v[68:83]
    ds_read_b64_tr_b16 v[162:163], v34 offset:1536
    ds_read_b128 v[152:155], v29 offset:4096
    s_add_u32 m0, s32, 1024
    s_add_u32 s29, s28, 10240
    buffer_load_dwordx4 v7, s[20:23], s29 offen  lds
    v_mfma_f32_32x32x16_bf16 v[116:131], v[172:175], v[180:183], v[116:131]
    ds_read_b64_tr_b16 v[164:165], v35 offset:0
    ds_read_b64_tr_b16 v[166:167], v35 offset:1536
    v_mfma_f32_32x32x16_bf16 v[84:99], v[168:171], v[184:187], v[84:99]
    s_add_u32 m0, s32, 2048
    s_add_u32 s29, s28, 20480
    buffer_load_dwordx4 v6, s[20:23], s29 offen  lds
    v_mfma_f32_32x32x16_bf16 v[132:147], v[172:175], v[184:187], v[132:147]
    s_waitcnt lgkmcnt(0)
    v_mfma_f32_32x32x16_bf16 v[52:67], v[148:151], v[156:159], v[52:67]
    ds_read_b64_tr_b16 v[176:177], v33 offset:6144
    ds_read_b64_tr_b16 v[178:179], v33 offset:7680
    s_add_u32 m0, s32, 3072
    s_add_u32 s29, s28, 30720
    buffer_load_dwordx4 v7, s[20:23], s29 offen  lds
    v_mfma_f32_32x32x16_bf16 v[100:115], v[152:155], v[156:159], v[100:115]
    ds_read_b128 v[168:171], v30 offset:0
    ds_read_b64_tr_b16 v[180:181], v34 offset:6144
    v_mfma_f32_32x32x16_bf16 v[68:83], v[148:151], v[160:163], v[68:83]
    ds_read_b64_tr_b16 v[182:183], v34 offset:7680
    ds_read_b128 v[172:175], v30 offset:4096
    s_add_u32 m0, s33, 16384
    s_nop 0
    buffer_load_dwordx4 v16, s[24:27], s30 offen  lds
    v_mfma_f32_32x32x16_bf16 v[116:131], v[152:155], v[160:163], v[116:131]
    ds_read_b64_tr_b16 v[184:185], v35 offset:6144
    ds_read_b64_tr_b16 v[186:187], v35 offset:7680
    v_mfma_f32_32x32x16_bf16 v[84:99], v[148:151], v[164:167], v[84:99]
    s_add_u32 m0, s33, 17408
    s_nop 0
    buffer_load_dwordx4 v17, s[24:27], s30 offen  lds
    v_mfma_f32_32x32x16_bf16 v[132:147], v[152:155], v[164:167], v[132:147]
    s_waitcnt lgkmcnt(0)
    v_mfma_f32_32x32x16_bf16 v[52:67], v[168:171], v[176:179], v[52:67]
    ds_read_b64_tr_b16 v[156:157], v33 offset:12288
    ds_read_b64_tr_b16 v[158:159], v33 offset:13824
    v_mfma_f32_32x32x16_bf16 v[100:115], v[172:175], v[176:179], v[100:115]
    ds_read_b128 v[148:151], v31 offset:0
    ds_read_b64_tr_b16 v[160:161], v34 offset:12288
    s_add_u32 m0, s33, 18432
    s_nop 0
    buffer_load_dwordx4 v18, s[24:27], s30 offen  lds
    v_mfma_f32_32x32x16_bf16 v[68:83], v[168:171], v[180:183], v[68:83]
    ds_read_b64_tr_b16 v[162:163], v34 offset:13824
    ds_read_b128 v[152:155], v31 offset:4096
    v_mfma_f32_32x32x16_bf16 v[116:131], v[172:175], v[180:183], v[116:131]
    ds_read_b64_tr_b16 v[164:165], v35 offset:12288
    ds_read_b64_tr_b16 v[166:167], v35 offset:13824
    v_mfma_f32_32x32x16_bf16 v[84:99], v[168:171], v[184:187], v[84:99]
    s_add_u32 m0, s33, 19456
    s_nop 0
    buffer_load_dwordx4 v19, s[24:27], s30 offen  lds
    v_mfma_f32_32x32x16_bf16 v[132:147], v[172:175], v[184:187], v[132:147]
    s_waitcnt lgkmcnt(0)
    v_mfma_f32_32x32x16_bf16 v[52:67], v[148:151], v[156:159], v[52:67]
    ds_read_b64_tr_b16 v[176:177], v33 offset:18432
    ds_read_b64_tr_b16 v[178:179], v33 offset:19968
    v_mfma_f32_32x32x16_bf16 v[100:115], v[152:155], v[156:159], v[100:115]
    ds_read_b128 v[168:171], v32 offset:0
    ds_read_b64_tr_b16 v[180:181], v34 offset:18432
    s_add_u32 m0, s33, 20480
    s_nop 0
    buffer_load_dwordx4 v20, s[24:27], s30 offen  lds
    v_mfma_f32_32x32x16_bf16 v[68:83], v[148:151], v[160:163], v[68:83]
    ds_read_b64_tr_b16 v[182:183], v34 offset:19968
    ds_read_b128 v[172:175], v32 offset:4096
    v_mfma_f32_32x32x16_bf16 v[116:131], v[152:155], v[160:163], v[116:131]
    ds_read_b64_tr_b16 v[184:185], v35 offset:18432
    ds_read_b64_tr_b16 v[186:187], v35 offset:19968
    v_mfma_f32_32x32x16_bf16 v[84:99], v[148:151], v[164:167], v[84:99]
    s_add_u32 m0, s33, 21504
    s_nop 0
    buffer_load_dwordx4 v21, s[24:27], s30 offen  lds
    s_add_u32 s34, s34, 1
    s_cmp_eq_u32 s34, 10
    s_cselect_b32 s35, 0xfffffb80, s38
    s_cselect_b32 s36, 0xffde4000, s37
    s_cselect_b32 s34, 0, s34
    s_add_u32 s28, s28, s35
    s_add_u32 s30, s30, s36
    v_mfma_f32_32x32x16_bf16 v[132:147], v[152:155], v[164:167], v[132:147]
    s_waitcnt vmcnt(10) lgkmcnt(0)
    s_barrier
    v_mfma_f32_32x32x16_bf16 v[52:67], v[168:171], v[176:179], v[52:67]
    ds_read_b64_tr_b16 v[156:157], v40 offset:0
    ds_read_b64_tr_b16 v[158:159], v40 offset:1536
    s_add_u32 m0, s32, 40960
    s_nop 0
    buffer_load_dwordx4 v6, s[20:23], s28 offen  lds
    v_mfma_f32_32x32x16_bf16 v[100:115], v[172:175], v[176:179], v[100:115]
    ds_read_b128 v[148:151], v36 offset:0
    ds_read_b64_tr_b16 v[160:161], v41 offset:0
    v_mfma_f32_32x32x16_bf16 v[68:83], v[168:171], v[180:183], v[68:83]
    ds_read_b64_tr_b16 v[162:163], v41 offset:1536
    ds_read_b128 v[152:155], v36 offset:4096
    s_add_u32 m0, s32, 41984
    s_add_u32 s29, s28, 10240
    buffer_load_dwordx4 v7, s[20:23], s29 offen  lds
    v_mfma_f32_32x32x16_bf16 v[116:131], v[172:175], v[180:183], v[116:131]
    ds_read_b64_tr_b16 v[164:165], v42 offset:0
    ds_read_b64_tr_b16 v[166:167], v42 offset:1536
    v_mfma_f32_32x32x16_bf16 v[84:99], v[168:171], v[184:187], v[84:99]
    s_add_u32 m0, s32, 43008
    s_add_u32 s29, s28, 20480
    buffer_load_dwordx4 v6, s[20:23], s29 offen  lds
    v_mfma_f32_32x32x16_bf16 v[132:147], v[172:175], v[184:187], v[132:147]
    s_waitcnt lgkmcnt(0)
    v_mfma_f32_32x32x16_bf16 v[52:67], v[148:151], v[156:159], v[52:67]
    ds_read_b64_tr_b16 v[176:177], v40 offset:6144
    ds_read_b64_tr_b16 v[178:179], v40 offset:7680
    s_add_u32 m0, s32, 44032
    s_add_u32 s29, s28, 30720
    buffer_load_dwordx4 v7, s[20:23], s29 offen  lds
    v_mfma_f32_32x32x16_bf16 v[100:115], v[152:155], v[156:159], v[100:115]
    ds_read_b128 v[168:171], v37 offset:0
    ds_read_b64_tr_b16 v[180:181], v41 offset:6144
    v_mfma_f32_32x32x16_bf16 v[68:83], v[148:151], v[160:163], v[68:83]
    ds_read_b64_tr_b16 v[182:183], v41 offset:7680
    ds_read_b128 v[172:175], v37 offset:4096
    s_add_u32 m0, s33, 57344
    s_nop 0
    buffer_load_dwordx4 v16, s[24:27], s30 offen  lds
    v_mfma_f32_32x32x16_bf16 v[116:131], v[152:155], v[160:163], v[116:131]
    ds_read_b64_tr_b16 v[184:185], v42 offset:6144
    ds_read_b64_tr_b16 v[186:187], v42 offset:7680
    v_mfma_f32_32x32x16_bf16 v[84:99], v[148:151], v[164:167], v[84:99]
    s_add_u32 m0, s33, 58368
    s_nop 0
    buffer_load_dwordx4 v17, s[24:27], s30 offen  lds
    v_mfma_f32_32x32x16_bf16 v[132:147], v[152:155], v[164:167], v[132:147]
    s_waitcnt lgkmcnt(0)
    v_mfma_f32_32x32x16_bf16 v[52:67], v[168:171], v[176:179], v[52:67]
    ds_read_b64_tr_b16 v[156:157], v40 offset:12288
    ds_read_b64_tr_b16 v[158:159], v40 offset:13824
    v_mfma_f32_32x32x16_bf16 v[100:115], v[172:175], v[176:179], v[100:115]
    ds_read_b128 v[148:151], v38 offset:0
    ds_read_b64_tr_b16 v[160:161], v41 offset:12288
    s_add_u32 m0, s33, 59392
    s_nop 0
    buffer_load_dwordx4 v18, s[24:27], s30 offen  lds
    v_mfma_f32_32x32x16_bf16 v[68:83], v[168:171], v[180:183], v[68:83]
    ds_read_b64_tr_b16 v[162:163], v41 offset:13824
    ds_read_b128 v[152:155], v38 offset:4096
    v_mfma_f32_32x32x16_bf16 v[116:131], v[172:175], v[180:183], v[116:131]
    ds_read_b64_tr_b16 v[164:165], v42 offset:12288
    ds_read_b64_tr_b16 v[166:167], v42 offset:13824
    v_mfma_f32_32x32x16_bf16 v[84:99], v[168:171], v[184:187], v[84:99]
    s_add_u32 m0, s33, 60416
    s_nop 0
    buffer_load_dwordx4 v19, s[24:27], s30 offen  lds
    v_mfma_f32_32x32x16_bf16 v[132:147], v[172:175], v[184:187], v[132:147]
    s_waitcnt lgkmcnt(0)
    v_mfma_f32_32x32x16_bf16 v[52:67], v[148:151], v[156:159], v[52:67]
    ds_read_b64_tr_b16 v[176:177], v40 offset:18432
    ds_read_b64_tr_b16 v[178:179], v40 offset:19968
    v_mfma_f32_32x32x16_bf16 v[100:115], v[152:155], v[156:159], v[100:115]
    ds_read_b128 v[168:171], v39 offset:0
    ds_read_b64_tr_b16 v[180:181], v41 offset:18432
    s_add_u32 m0, s33, 61440
    s_nop 0
    buffer_load_dwordx4 v20, s[24:27], s30 offen  lds
    v_mfma_f32_32x32x16_bf16 v[68:83], v[148:151], v[160:163], v[68:83]
    ds_read_b64_tr_b16 v[182:183], v41 offset:19968
    ds_read_b128 v[172:175], v39 offset:4096
    v_mfma_f32_32x32x16_bf16 v[116:131], v[152:155], v[160:163], v[116:131]
    ds_read_b64_tr_b16 v[184:185], v42 offset:18432
    ds_read_b64_tr_b16 v[186:187], v42 offset:19968
    v_mfma_f32_32x32x16_bf16 v[84:99], v[148:151], v[164:167], v[84:99]
    s_add_u32 m0, s33, 62464
    s_nop 0
    buffer_load_dwordx4 v21, s[24:27], s30 offen  lds
    s_add_u32 s34, s34, 1
    s_cmp_eq_u32 s34, 10
    s_cselect_b32 s35, 0xfffffb80, s38
    s_cselect_b32 s36, 0xffde4000, s37
    s_cselect_b32 s34, 0, s34
    s_add_u32 s28, s28, s35
    s_add_u32 s30, s30, s36
    v_mfma_f32_32x32x16_bf16 v[132:147], v[152:155], v[164:167], v[132:147]
    s_waitcnt vmcnt(10) lgkmcnt(0)
    s_barrier
    v_mfma_f32_32x32x16_bf16 v[52:67], v[168:171], v[176:179], v[52:67]
    ds_read_b64_tr_b16 v[156:157], v26 offset:0
    ds_read_b64_tr_b16 v[158:159], v26 offset:1536
    s_add_u32 m0, s32, 81920
    s_nop 0
    buffer_load_dwordx4 v6, s[20:23], s28 offen  lds
    v_mfma_f32_32x32x16_bf16 v[100:115], v[172:175], v[176:179], v[100:115]
    ds_read_b128 v[148:151], v22 offset:0
    ds_read_b64_tr_b16 v[160:161], v27 offset:0
    v_mfma_f32_32x32x16_bf16 v[68:83], v[168:171], v[180:183], v[68:83]
    ds_read_b64_tr_b16 v[162:163], v27 offset:1536
    ds_read_b128 v[152:155], v22 offset:4096
    s_add_u32 m0, s32, 82944
    s_add_u32 s29, s28, 10240
    buffer_load_dwordx4 v7, s[20:23], s29 offen  lds
    v_mfma_f32_32x32x16_bf16 v[116:131], v[172:175], v[180:183], v[116:131]
    ds_read_b64_tr_b16 v[164:165], v28 offset:0
    ds_read_b64_tr_b16 v[166:167], v28 offset:1536
    v_mfma_f32_32x32x16_bf16 v[84:99], v[168:171], v[184:187], v[84:99]
    s_add_u32 m0, s32, 83968
    s_add_u32 s29, s28, 20480
    buffer_load_dwordx4 v6, s[20:23], s29 offen  lds
    v_mfma_f32_32x32x16_bf16 v[132:147], v[172:175], v[184:187], v[132:147]
    s_waitcnt lgkmcnt(0)
    v_mfma_f32_32x32x16_bf16 v[52:67], v[148:151], v[156:159], v[52:67]
    ds_read_b64_tr_b16 v[176:177], v26 offset:6144
    ds_read_b64_tr_b16 v[178:179], v26 offset:7680
    s_add_u32 m0, s32, 84992
    s_add_u32 s29, s28, 30720
    buffer_load_dwordx4 v7, s[20:23], s29 offen  lds
    v_mfma_f32_32x32x16_bf16 v[100:115], v[152:155], v[156:159], v[100:115]
    ds_read_b128 v[168:171], v23 offset:0
    ds_read_b64_tr_b16 v[180:181], v27 offset:6144
    v_mfma_f32_32x32x16_bf16 v[68:83], v[148:151], v[160:163], v[68:83]
    ds_read_b64_tr_b16 v[182:183], v27 offset:7680
    ds_read_b128 v[172:175], v23 offset:4096
    s_add_u32 m0, s33, 98304
    s_nop 0
    buffer_load_dwordx4 v16, s[24:27], s30 offen  lds
    v_mfma_f32_32x32x16_bf16 v[116:131], v[152:155], v[160:163], v[116:131]
    ds_read_b64_tr_b16 v[184:185], v28 offset:6144
    ds_read_b64_tr_b16 v[186:187], v28 offset:7680
    v_mfma_f32_32x32x16_bf16 v[84:99], v[148:151], v[164:167], v[84:99]
    s_add_u32 m0, s33, 99328
    s_nop 0
    buffer_load_dwordx4 v17, s[24:27], s30 offen  lds
    v_mfma_f32_32x32x16_bf16 v[132:147], v[152:155], v[164:167], v[132:147]
    s_waitcnt lgkmcnt(0)
    v_mfma_f32_32x32x16_bf16 v[52:67], v[168:171], v[176:179], v[52:67]
    ds_read_b64_tr_b16 v[156:157], v26 offset:12288
    ds_read_b64_tr_b16 v[158:159], v26 offset:13824
    v_mfma_f32_32x32x16_bf16 v[100:115], v[172:175], v[176:179], v[100:115]
    ds_read_b128 v[148:151], v24 offset:0
    ds_read_b64_tr_b16 v[160:161], v27 offset:12288
    s_add_u32 m0, s33, 100352
    s_nop 0
    buffer_load_dwordx4 v18, s[24:27], s30 offen  lds
    v_mfma_f32_32x32x16_bf16 v[68:83], v[168:171], v[180:183], v[68:83]
    ds_read_b64_tr_b16 v[162:163], v27 offset:13824
    ds_read_b128 v[152:155], v24 offset:4096
    v_mfma_f32_32x32x16_bf16 v[116:131], v[172:175], v[180:183], v[116:131]
    ds_read_b64_tr_b16 v[164:165], v28 offset:12288
    ds_read_b64_tr_b16 v[166:167], v28 offset:13824
    v_mfma_f32_32x32x16_bf16 v[84:99], v[168:171], v[184:187], v[84:99]
    s_add_u32 m0, s33, 101376
    s_nop 0
    buffer_load_dwordx4 v19, s[24:27], s30 offen  lds
    v_mfma_f32_32x32x16_bf16 v[132:147], v[172:175], v[184:187], v[132:147]
    s_waitcnt lgkmcnt(0)
    v_mfma_f32_32x32x16_bf16 v[52:67], v[148:151], v[156:159], v[52:67]
    ds_read_b64_tr_b16 v[176:177], v26 offset:18432
    ds_read_b64_tr_b16 v[178:179], v26 offset:19968
    v_mfma_f32_32x32x16_bf16 v[100:115], v[152:155], v[156:159], v[100:115]
    ds_read_b128 v[168:171], v25 offset:0
    ds_read_b64_tr_b16 v[180:181], v27 offset:18432
    s_add_u32 m0, s33, 102400
    s_nop 0
    buffer_load_dwordx4 v20, s[24:27], s30 offen  lds
    v_mfma_f32_32x32x16_bf16 v[68:83], v[148:151], v[160:163], v[68:83]
    ds_read_b64_tr_b16 v[182:183], v27 offset:19968
    ds_read_b128 v[172:175], v25 offset:4096
    v_mfma_f32_32x32x16_bf16 v[116:131], v[152:155], v[160:163], v[116:131]
    ds_read_b64_tr_b16 v[184:185], v28 offset:18432
    ds_read_b64_tr_b16 v[186:187], v28 offset:19968
    v_mfma_f32_32x32x16_bf16 v[84:99], v[148:151], v[164:167], v[84:99]
    s_add_u32 m0, s33, 103424
    s_nop 0
    buffer_load_dwordx4 v21, s[24:27], s30 offen  lds
    s_add_u32 s34, s34, 1
    s_cmp_eq_u32 s34, 10
    s_cselect_b32 s35, 0xfffffb80, s38
    s_cselect_b32 s36, 0xffde4000, s37
    s_cselect_b32 s34, 0, s34
    s_add_u32 s28, s28, s35
    s_add_u32 s30, s30, s36
    v_mfma_f32_32x32x16_bf16 v[132:147], v[152:155], v[164:167], v[132:147]
    s_waitcnt vmcnt(10) lgkmcnt(0)
    s_barrier
    v_mfma_f32_32x32x16_bf16 v[52:67], v[168:171], v[176:179], v[52:67]
    ds_read_b64_tr_b16 v[156:157], v33 offset:0
    ds_read_b64_tr_b16 v[158:159], v33 offset:1536
    s_add_u32 m0, s32, 0
    s_nop 0
    buffer_load_dwordx4 v6, s[20:23], s28 offen  lds
    v_mfma_f32_32x32x16_bf16 v[100:115], v[172:175], v[176:179], v[100:115]
    ds_read_b128 v[148:151], v29 offset:0
    ds_read_b64_tr_b16 v[160:161], v34 offset:0
    v_mfma_f32_32x32x16_bf16 v[68:83], v[168:171], v[180:183], v[68:83]
    ds_read_b64_tr_b16 v[162:163], v34 offset:1536
    ds_read_b128 v[152:155], v29 offset:4096
    s_add_u32 m0, s32, 1024
    s_add_u32 s29, s28, 10240
    buffer_load_dwordx4 v7, s[20:23], s29 offen  lds
    v_mfma_f32_32x32x16_bf16 v[116:131], v[172:175], v[180:183], v[116:131]
    ds_read_b64_tr_b16 v[164:165], v35 offset:0
    ds_read_b64_tr_b16 v[166:167], v35 offset:1536
    v_mfma_f32_32x32x16_bf16 v[84:99], v[168:171], v[184:187], v[84:99]
    s_add_u32 m0, s32, 2048
    s_add_u32 s29, s28, 20480
    buffer_load_dwordx4 v6, s[20:23], s29 offen  lds
    v_mfma_f32_32x32x16_bf16 v[132:147], v[172:175], v[184:187], v[132:147]
    s_waitcnt lgkmcnt(0)
    v_mfma_f32_32x32x16_bf16 v[52:67], v[148:151], v[156:159], v[52:67]
    ds_read_b64_tr_b16 v[176:177], v33 offset:6144
    ds_read_b64_tr_b16 v[178:179], v33 offset:7680
    s_add_u32 m0, s32, 3072
    s_add_u32 s29, s28, 30720
    buffer_load_dwordx4 v7, s[20:23], s29 offen  lds
    v_mfma_f32_32x32x16_bf16 v[100:115], v[152:155], v[156:159], v[100:115]
    ds_read_b128 v[168:171], v30 offset:0
    ds_read_b64_tr_b16 v[180:181], v34 offset:6144
    v_mfma_f32_32x32x16_bf16 v[68:83], v[148:151], v[160:163], v[68:83]
    ds_read_b64_tr_b16 v[182:183], v34 offset:7680
    ds_read_b128 v[172:175], v30 offset:4096
    s_add_u32 m0, s33, 16384
    s_nop 0
    buffer_load_dwordx4 v16, s[24:27], s30 offen  lds
    v_mfma_f32_32x32x16_bf16 v[116:131], v[152:155], v[160:163], v[116:131]
    ds_read_b64_tr_b16 v[184:185], v35 offset:6144
    ds_read_b64_tr_b16 v[186:187], v35 offset:7680
    v_mfma_f32_32x32x16_bf16 v[84:99], v[148:151], v[164:167], v[84:99]
    s_add_u32 m0, s33, 17408
    s_nop 0
    buffer_load_dwordx4 v17, s[24:27], s30 offen  lds
    v_mfma_f32_32x32x16_bf16 v[132:147], v[152:155], v[164:167], v[132:147]
    s_waitcnt lgkmcnt(0)
    v_mfma_f32_32x32x16_bf16 v[52:67], v[168:171], v[176:179], v[52:67]
    ds_read_b64_tr_b16 v[156:157], v33 offset:12288
    ds_read_b64_tr_b16 v[158:159], v33 offset:13824
    v_mfma_f32_32x32x16_bf16 v[100:115], v[172:175], v[176:179], v[100:115]
    ds_read_b128 v[148:151], v31 offset:0
    ds_read_b64_tr_b16 v[160:161], v34 offset:12288
    s_add_u32 m0, s33, 18432
    s_nop 0
    buffer_load_dwordx4 v18, s[24:27], s30 offen  lds
    v_mfma_f32_32x32x16_bf16 v[68:83], v[168:171], v[180:183], v[68:83]
    ds_read_b64_tr_b16 v[162:163], v34 offset:13824
    ds_read_b128 v[152:155], v31 offset:4096
    v_mfma_f32_32x32x16_bf16 v[116:131], v[172:175], v[180:183], v[116:131]
    ds_read_b64_tr_b16 v[164:165], v35 offset:12288
    ds_read_b64_tr_b16 v[166:167], v35 offset:13824
    v_mfma_f32_32x32x16_bf16 v[84:99], v[168:171], v[184:187], v[84:99]
    s_add_u32 m0, s33, 19456
    s_nop 0
    buffer_load_dwordx4 v19, s[24:27], s30 offen  lds
    v_mfma_f32_32x32x16_bf16 v[132:147], v[172:175], v[184:187], v[132:147]
    s_waitcnt lgkmcnt(0)
    v_mfma_f32_32x32x16_bf16 v[52:67], v[148:151], v[156:159], v[52:67]
    ds_read_b64_tr_b16 v[176:177], v33 offset:18432
    ds_read_b64_tr_b16 v[178:179], v33 offset:19968
    v_mfma_f32_32x32x16_bf16 v[100:115], v[152:155], v[156:159], v[100:115]
    ds_read_b128 v[168:171], v32 offset:0
    ds_read_b64_tr_b16 v[180:181], v34 offset:18432
    s_add_u32 m0, s33, 20480
    s_nop 0
    buffer_load_dwordx4 v20, s[24:27], s30 offen  lds
    v_mfma_f32_32x32x16_bf16 v[68:83], v[148:151], v[160:163], v[68:83]
    ds_read_b64_tr_b16 v[182:183], v34 offset:19968
    ds_read_b128 v[172:175], v32 offset:4096
    v_mfma_f32_32x32x16_bf16 v[116:131], v[152:155], v[160:163], v[116:131]
    ds_read_b64_tr_b16 v[184:185], v35 offset:18432
    ds_read_b64_tr_b16 v[186:187], v35 offset:19968
    v_mfma_f32_32x32x16_bf16 v[84:99], v[148:151], v[164:167], v[84:99]
    s_add_u32 m0, s33, 21504
    s_nop 0
    buffer_load_dwordx4 v21, s[24:27], s30 offen  lds
    s_add_u32 s34, s34, 1
    s_cmp_eq_u32 s34, 10
    s_cselect_b32 s35, 0xfffffb80, s38
    s_cselect_b32 s36, 0xffde4000, s37
    s_cselect_b32 s34, 0, s34
    s_add_u32 s28, s28, s35
    s_add_u32 s30, s30, s36
    v_mfma_f32_32x32x16_bf16 v[132:147], v[152:155], v[164:167], v[132:147]
    s_waitcnt vmcnt(10) lgkmcnt(0)
    s_barrier
    v_mfma_f32_32x32x16_bf16 v[52:67], v[168:171], v[176:179], v[52:67]
    ds_read_b64_tr_b16 v[156:157], v40 offset:0
    ds_read_b64_tr_b16 v[158:159], v40 offset:1536
    s_add_u32 m0, s32, 40960
    s_nop 0
    buffer_load_dwordx4 v6, s[20:23], s28 offen  lds
    v_mfma_f32_32x32x16_bf16 v[100:115], v[172:175], v[176:179], v[100:115]
    ds_read_b128 v[148:151], v36 offset:0
    ds_read_b64_tr_b16 v[160:161], v41 offset:0
    v_mfma_f32_32x32x16_bf16 v[68:83], v[168:171], v[180:183], v[68:83]
    ds_read_b64_tr_b16 v[162:163], v41 offset:1536
    ds_read_b128 v[152:155], v36 offset:4096
    s_add_u32 m0, s32, 41984
    s_add_u32 s29, s28, 10240
    buffer_load_dwordx4 v7, s[20:23], s29 offen  lds
    v_mfma_f32_32x32x16_bf16 v[116:131], v[172:175], v[180:183], v[116:131]
    ds_read_b64_tr_b16 v[164:165], v42 offset:0
    ds_read_b64_tr_b16 v[166:167], v42 offset:1536
    v_mfma_f32_32x32x16_bf16 v[84:99], v[168:171], v[184:187], v[84:99]
    s_add_u32 m0, s32, 43008
    s_add_u32 s29, s28, 20480
    buffer_load_dwordx4 v6, s[20:23], s29 offen  lds
    v_mfma_f32_32x32x16_bf16 v[132:147], v[172:175], v[184:187], v[132:147]
    s_waitcnt lgkmcnt(0)
    v_mfma_f32_32x32x16_bf16 v[52:67], v[148:151], v[156:159], v[52:67]
    ds_read_b64_tr_b16 v[176:177], v40 offset:6144
    ds_read_b64_tr_b16 v[178:179], v40 offset:7680
    s_add_u32 m0, s32, 44032
    s_add_u32 s29, s28, 30720
    buffer_load_dwordx4 v7, s[20:23], s29 offen  lds
    v_mfma_f32_32x32x16_bf16 v[100:115], v[152:155], v[156:159], v[100:115]
    ds_read_b128 v[168:171], v37 offset:0
    ds_read_b64_tr_b16 v[180:181], v41 offset:6144
    v_mfma_f32_32x32x16_bf16 v[68:83], v[148:151], v[160:163], v[68:83]
    ds_read_b64_tr_b16 v[182:183], v41 offset:7680
    ds_read_b128 v[172:175], v37 offset:4096
    s_add_u32 m0, s33, 57344
    s_nop 0
    buffer_load_dwordx4 v16, s[24:27], s30 offen  lds
    v_mfma_f32_32x32x16_bf16 v[116:131], v[152:155], v[160:163], v[116:131]
    ds_read_b64_tr_b16 v[184:185], v42 offset:6144
    ds_read_b64_tr_b16 v[186:187], v42 offset:7680
    v_mfma_f32_32x32x16_bf16 v[84:99], v[148:151], v[164:167], v[84:99]
    s_add_u32 m0, s33, 58368
    s_nop 0
    buffer_load_dwordx4 v17, s[24:27], s30 offen  lds
    v_mfma_f32_32x32x16_bf16 v[132:147], v[152:155], v[164:167], v[132:147]
    s_waitcnt lgkmcnt(0)
    v_mfma_f32_32x32x16_bf16 v[52:67], v[168:171], v[176:179], v[52:67]
    ds_read_b64_tr_b16 v[156:157], v40 offset:12288
    ds_read_b64_tr_b16 v[158:159], v40 offset:13824
    v_mfma_f32_32x32x16_bf16 v[100:115], v[172:175], v[176:179], v[100:115]
    ds_read_b128 v[148:151], v38 offset:0
    ds_read_b64_tr_b16 v[160:161], v41 offset:12288
    s_add_u32 m0, s33, 59392
    s_nop 0
    buffer_load_dwordx4 v18, s[24:27], s30 offen  lds
    v_mfma_f32_32x32x16_bf16 v[68:83], v[168:171], v[180:183], v[68:83]
    ds_read_b64_tr_b16 v[162:163], v41 offset:13824
    ds_read_b128 v[152:155], v38 offset:4096
    v_mfma_f32_32x32x16_bf16 v[116:131], v[172:175], v[180:183], v[116:131]
    ds_read_b64_tr_b16 v[164:165], v42 offset:12288
    ds_read_b64_tr_b16 v[166:167], v42 offset:13824
    v_mfma_f32_32x32x16_bf16 v[84:99], v[168:171], v[184:187], v[84:99]
    s_add_u32 m0, s33, 60416
    s_nop 0
    buffer_load_dwordx4 v19, s[24:27], s30 offen  lds
    v_mfma_f32_32x32x16_bf16 v[132:147], v[172:175], v[184:187], v[132:147]
    s_waitcnt lgkmcnt(0)
    v_mfma_f32_32x32x16_bf16 v[52:67], v[148:151], v[156:159], v[52:67]
    ds_read_b64_tr_b16 v[176:177], v40 offset:18432
    ds_read_b64_tr_b16 v[178:179], v40 offset:19968
    v_mfma_f32_32x32x16_bf16 v[100:115], v[152:155], v[156:159], v[100:115]
    ds_read_b128 v[168:171], v39 offset:0
    ds_read_b64_tr_b16 v[180:181], v41 offset:18432
    s_add_u32 m0, s33, 61440
    s_nop 0
    buffer_load_dwordx4 v20, s[24:27], s30 offen  lds
    v_mfma_f32_32x32x16_bf16 v[68:83], v[148:151], v[160:163], v[68:83]
    ds_read_b64_tr_b16 v[182:183], v41 offset:19968
    ds_read_b128 v[172:175], v39 offset:4096
    v_mfma_f32_32x32x16_bf16 v[116:131], v[152:155], v[160:163], v[116:131]
    ds_read_b64_tr_b16 v[184:185], v42 offset:18432
    ds_read_b64_tr_b16 v[186:187], v42 offset:19968
    v_mfma_f32_32x32x16_bf16 v[84:99], v[148:151], v[164:167], v[84:99]
    s_add_u32 m0, s33, 62464
    s_nop 0
    buffer_load_dwordx4 v21, s[24:27], s30 offen  lds
    s_add_u32 s34, s34, 1
    s_cmp_eq_u32 s34, 10
    s_cselect_b32 s35, 0xfffffb80, s38
    s_cselect_b32 s36, 0xffde4000, s37
    s_cselect_b32 s34, 0, s34
    s_add_u32 s28, s28, s35
    s_add_u32 s30, s30, s36
    v_mfma_f32_32x32x16_bf16 v[132:147], v[152:155], v[164:167], v[132:147]
    s_waitcnt vmcnt(10) lgkmcnt(0)
    s_barrier
    v_mfma_f32_32x32x16_bf16 v[52:67], v[168:171], v[176:179], v[52:67]
    ds_read_b64_tr_b16 v[156:157], v26 offset:0
    ds_read_b64_tr_b16 v[158:159], v26 offset:1536
    s_add_u32 m0, s32, 81920
    s_nop 0
    buffer_load_dwordx4 v6, s[20:23], s28 offen  lds
    v_mfma_f32_32x32x16_bf16 v[100:115], v[172:175], v[176:179], v[100:115]
    ds_read_b128 v[148:151], v22 offset:0
    ds_read_b64_tr_b16 v[160:161], v27 offset:0
    v_mfma_f32_32x32x16_bf16 v[68:83], v[168:171], v[180:183], v[68:83]
    ds_read_b64_tr_b16 v[162:163], v27 offset:1536
    ds_read_b128 v[152:155], v22 offset:4096
    s_add_u32 m0, s32, 82944
    s_add_u32 s29, s28, 10240
    buffer_load_dwordx4 v7, s[20:23], s29 offen  lds
    v_mfma_f32_32x32x16_bf16 v[116:131], v[172:175], v[180:183], v[116:131]
    ds_read_b64_tr_b16 v[164:165], v28 offset:0
    ds_read_b64_tr_b16 v[166:167], v28 offset:1536
    v_mfma_f32_32x32x16_bf16 v[84:99], v[168:171], v[184:187], v[84:99]
    s_add_u32 m0, s32, 83968
    s_add_u32 s29, s28, 20480
    buffer_load_dwordx4 v6, s[20:23], s29 offen  lds
    v_mfma_f32_32x32x16_bf16 v[132:147], v[172:175], v[184:187], v[132:147]
    s_waitcnt lgkmcnt(0)
    v_mfma_f32_32x32x16_bf16 v[52:67], v[148:151], v[156:159], v[52:67]
    ds_read_b64_tr_b16 v[176:177], v26 offset:6144
    ds_read_b64_tr_b16 v[178:179], v26 offset:7680
    s_add_u32 m0, s32, 84992
    s_add_u32 s29, s28, 30720
    buffer_load_dwordx4 v7, s[20:23], s29 offen  lds
    v_mfma_f32_32x32x16_bf16 v[100:115], v[152:155], v[156:159], v[100:115]
    ds_read_b128 v[168:171], v23 offset:0
    ds_read_b64_tr_b16 v[180:181], v27 offset:6144
    v_mfma_f32_32x32x16_bf16 v[68:83], v[148:151], v[160:163], v[68:83]
    ds_read_b64_tr_b16 v[182:183], v27 offset:7680
    ds_read_b128 v[172:175], v23 offset:4096
    s_add_u32 m0, s33, 98304
    s_nop 0
    buffer_load_dwordx4 v16, s[24:27], s30 offen  lds
    v_mfma_f32_32x32x16_bf16 v[116:131], v[152:155], v[160:163], v[116:131]
    ds_read_b64_tr_b16 v[184:185], v28 offset:6144
    ds_read_b64_tr_b16 v[186:187], v28 offset:7680
    v_mfma_f32_32x32x16_bf16 v[84:99], v[148:151], v[164:167], v[84:99]
    s_add_u32 m0, s33, 99328
    s_nop 0
    buffer_load_dwordx4 v17, s[24:27], s30 offen  lds
    v_mfma_f32_32x32x16_bf16 v[132:147], v[152:155], v[164:167], v[132:147]
    s_waitcnt lgkmcnt(0)
    v_mfma_f32_32x32x16_bf16 v[52:67], v[168:171], v[176:179], v[52:67]
    ds_read_b64_tr_b16 v[156:157], v26 offset:12288
    ds_read_b64_tr_b16 v[158:159], v26 offset:13824
    v_mfma_f32_32x32x16_bf16 v[100:115], v[172:175], v[176:179], v[100:115]
    ds_read_b128 v[148:151], v24 offset:0
    ds_read_b64_tr_b16 v[160:161], v27 offset:12288
    s_add_u32 m0, s33, 100352
    s_nop 0
    buffer_load_dwordx4 v18, s[24:27], s30 offen  lds
    v_mfma_f32_32x32x16_bf16 v[68:83], v[168:171], v[180:183], v[68:83]
    ds_read_b64_tr_b16 v[162:163], v27 offset:13824
    ds_read_b128 v[152:155], v24 offset:4096
    v_mfma_f32_32x32x16_bf16 v[116:131], v[172:175], v[180:183], v[116:131]
    ds_read_b64_tr_b16 v[164:165], v28 offset:12288
    ds_read_b64_tr_b16 v[166:167], v28 offset:13824
    v_mfma_f32_32x32x16_bf16 v[84:99], v[168:171], v[184:187], v[84:99]
    s_add_u32 m0, s33, 101376
    s_nop 0
    buffer_load_dwordx4 v19, s[24:27], s30 offen  lds
    v_mfma_f32_32x32x16_bf16 v[132:147], v[172:175], v[184:187], v[132:147]
    s_waitcnt lgkmcnt(0)
    v_mfma_f32_32x32x16_bf16 v[52:67], v[148:151], v[156:159], v[52:67]
    ds_read_b64_tr_b16 v[176:177], v26 offset:18432
    ds_read_b64_tr_b16 v[178:179], v26 offset:19968
    v_mfma_f32_32x32x16_bf16 v[100:115], v[152:155], v[156:159], v[100:115]
    ds_read_b128 v[168:171], v25 offset:0
    ds_read_b64_tr_b16 v[180:181], v27 offset:18432
    s_add_u32 m0, s33, 102400
    s_nop 0
    buffer_load_dwordx4 v20, s[24:27], s30 offen  lds
    v_mfma_f32_32x32x16_bf16 v[68:83], v[148:151], v[160:163], v[68:83]
    ds_read_b64_tr_b16 v[182:183], v27 offset:19968
    ds_read_b128 v[172:175], v25 offset:4096
    v_mfma_f32_32x32x16_bf16 v[116:131], v[152:155], v[160:163], v[116:131]
    ds_read_b64_tr_b16 v[184:185], v28 offset:18432
    ds_read_b64_tr_b16 v[186:187], v28 offset:19968
    v_mfma_f32_32x32x16_bf16 v[84:99], v[148:151], v[164:167], v[84:99]
    s_add_u32 m0, s33, 103424
    s_nop 0
    buffer_load_dwordx4 v21, s[24:27], s30 offen  lds
    s_add_u32 s34, s34, 1
    s_cmp_eq_u32 s34, 10
    s_cselect_b32 s35, 0xfffffb80, s38
    s_cselect_b32 s36, 0xffde4000, s37
    s_cselect_b32 s34, 0, s34
    s_add_u32 s28, s28, s35
    s_add_u32 s30, s30, s36
    v_mfma_f32_32x32x16_bf16 v[132:147], v[152:155], v[164:167], v[132:147]
    s_waitcnt vmcnt(10) lgkmcnt(0)
    s_barrier
    v_mfma_f32_32x32x16_bf16 v[52:67], v[168:171], v[176:179], v[52:67]
    ds_read_b64_tr_b16 v[156:157], v33 offset:0
    ds_read_b64_tr_b16 v[158:159], v33 offset:1536
    s_add_u32 m0, s32, 0
    s_nop 0
    buffer_load_dwordx4 v6, s[20:23], s28 offen  lds
    v_mfma_f32_32x32x16_bf16 v[100:115], v[172:175], v[176:179], v[100:115]
    ds_read_b128 v[148:151], v29 offset:0
    ds_read_b64_tr_b16 v[160:161], v34 offset:0
    v_mfma_f32_32x32x16_bf16 v[68:83], v[168:171], v[180:183], v[68:83]
    ds_read_b64_tr_b16 v[162:163], v34 offset:1536
    ds_read_b128 v[152:155], v29 offset:4096
    s_add_u32 m0, s32, 1024
    s_add_u32 s29, s28, 10240
    buffer_load_dwordx4 v7, s[20:23], s29 offen  lds
    v_mfma_f32_32x32x16_bf16 v[116:131], v[172:175], v[180:183], v[116:131]
    ds_read_b64_tr_b16 v[164:165], v35 offset:0
    ds_read_b64_tr_b16 v[166:167], v35 offset:1536
    v_mfma_f32_32x32x16_bf16 v[84:99], v[168:171], v[184:187], v[84:99]
    s_add_u32 m0, s32, 2048
    s_add_u32 s29, s28, 20480
    buffer_load_dwordx4 v6, s[20:23], s29 offen  lds
    v_mfma_f32_32x32x16_bf16 v[132:147], v[172:175], v[184:187], v[132:147]
    s_waitcnt lgkmcnt(0)
    v_mfma_f32_32x32x16_bf16 v[52:67], v[148:151], v[156:159], v[52:67]
    ds_read_b64_tr_b16 v[176:177], v33 offset:6144
    ds_read_b64_tr_b16 v[178:179], v33 offset:7680
    s_add_u32 m0, s32, 3072
    s_add_u32 s29, s28, 30720
    buffer_load_dwordx4 v7, s[20:23], s29 offen  lds
    v_mfma_f32_32x32x16_bf16 v[100:115], v[152:155], v[156:159], v[100:115]
    ds_read_b128 v[168:171], v30 offset:0
    ds_read_b64_tr_b16 v[180:181], v34 offset:6144
    v_mfma_f32_32x32x16_bf16 v[68:83], v[148:151], v[160:163], v[68:83]
    ds_read_b64_tr_b16 v[182:183], v34 offset:7680
    ds_read_b128 v[172:175], v30 offset:4096
    s_add_u32 m0, s33, 16384
    s_nop 0
    buffer_load_dwordx4 v16, s[24:27], s30 offen  lds
    v_mfma_f32_32x32x16_bf16 v[116:131], v[152:155], v[160:163], v[116:131]
    ds_read_b64_tr_b16 v[184:185], v35 offset:6144
    ds_read_b64_tr_b16 v[186:187], v35 offset:7680
    v_mfma_f32_32x32x16_bf16 v[84:99], v[148:151], v[164:167], v[84:99]
    s_add_u32 m0, s33, 17408
    s_nop 0
    buffer_load_dwordx4 v17, s[24:27], s30 offen  lds
    v_mfma_f32_32x32x16_bf16 v[132:147], v[152:155], v[164:167], v[132:147]
    s_waitcnt lgkmcnt(0)
    v_mfma_f32_32x32x16_bf16 v[52:67], v[168:171], v[176:179], v[52:67]
    ds_read_b64_tr_b16 v[156:157], v33 offset:12288
    ds_read_b64_tr_b16 v[158:159], v33 offset:13824
    v_mfma_f32_32x32x16_bf16 v[100:115], v[172:175], v[176:179], v[100:115]
    ds_read_b128 v[148:151], v31 offset:0
    ds_read_b64_tr_b16 v[160:161], v34 offset:12288
    s_add_u32 m0, s33, 18432
    s_nop 0
    buffer_load_dwordx4 v18, s[24:27], s30 offen  lds
    v_mfma_f32_32x32x16_bf16 v[68:83], v[168:171], v[180:183], v[68:83]
    ds_read_b64_tr_b16 v[162:163], v34 offset:13824
    ds_read_b128 v[152:155], v31 offset:4096
    v_mfma_f32_32x32x16_bf16 v[116:131], v[172:175], v[180:183], v[116:131]
    ds_read_b64_tr_b16 v[164:165], v35 offset:12288
    ds_read_b64_tr_b16 v[166:167], v35 offset:13824
    v_mfma_f32_32x32x16_bf16 v[84:99], v[168:171], v[184:187], v[84:99]
    s_add_u32 m0, s33, 19456
    s_nop 0
    buffer_load_dwordx4 v19, s[24:27], s30 offen  lds
    v_mfma_f32_32x32x16_bf16 v[132:147], v[172:175], v[184:187], v[132:147]
    s_waitcnt lgkmcnt(0)
    v_mfma_f32_32x32x16_bf16 v[52:67], v[148:151], v[156:159], v[52:67]
    ds_read_b64_tr_b16 v[176:177], v33 offset:18432
    ds_read_b64_tr_b16 v[178:179], v33 offset:19968
    v_mfma_f32_32x32x16_bf16 v[100:115], v[152:155], v[156:159], v[100:115]
    ds_read_b128 v[168:171], v32 offset:0
    ds_read_b64_tr_b16 v[180:181], v34 offset:18432
    s_add_u32 m0, s33, 20480
    s_nop 0
    buffer_load_dwordx4 v20, s[24:27], s30 offen  lds
    v_mfma_f32_32x32x16_bf16 v[68:83], v[148:151], v[160:163], v[68:83]
    ds_read_b64_tr_b16 v[182:183], v34 offset:19968
    ds_read_b128 v[172:175], v32 offset:4096
    v_mfma_f32_32x32x16_bf16 v[116:131], v[152:155], v[160:163], v[116:131]
    ds_read_b64_tr_b16 v[184:185], v35 offset:18432
    ds_read_b64_tr_b16 v[186:187], v35 offset:19968
    v_mfma_f32_32x32x16_bf16 v[84:99], v[148:151], v[164:167], v[84:99]
    s_add_u32 m0, s33, 21504
    s_nop 0
    buffer_load_dwordx4 v21, s[24:27], s30 offen  lds
    s_add_u32 s34, s34, 1
    s_cmp_eq_u32 s34, 10
    s_cselect_b32 s35, 0xfffffb80, s38
    s_cselect_b32 s36, 0xffde4000, s37
    s_cselect_b32 s34, 0, s34
    s_add_u32 s28, s28, s35
    s_add_u32 s30, s30, s36
    v_mfma_f32_32x32x16_bf16 v[132:147], v[152:155], v[164:167], v[132:147]
    s_waitcnt vmcnt(10) lgkmcnt(0)
    s_barrier
    v_mfma_f32_32x32x16_bf16 v[52:67], v[168:171], v[176:179], v[52:67]
    ds_read_b64_tr_b16 v[156:157], v40 offset:0
    ds_read_b64_tr_b16 v[158:159], v40 offset:1536
    v_mfma_f32_32x32x16_bf16 v[100:115], v[172:175], v[176:179], v[100:115]
    ds_read_b128 v[148:151], v36 offset:0
    ds_read_b64_tr_b16 v[160:161], v41 offset:0
    v_mfma_f32_32x32x16_bf16 v[68:83], v[168:171], v[180:183], v[68:83]
    ds_read_b64_tr_b16 v[162:163], v41 offset:1536
    ds_read_b128 v[152:155], v36 offset:4096
    v_mfma_f32_32x32x16_bf16 v[116:131], v[172:175], v[180:183], v[116:131]
    ds_read_b64_tr_b16 v[164:165], v42 offset:0
    ds_read_b64_tr_b16 v[166:167], v42 offset:1536
    v_mfma_f32_32x32x16_bf16 v[84:99], v[168:171], v[184:187], v[84:99]
    v_mfma_f32_32x32x16_bf16 v[132:147], v[172:175], v[184:187], v[132:147]
    s_waitcnt lgkmcnt(0)
    v_mfma_f32_32x32x16_bf16 v[52:67], v[148:151], v[156:159], v[52:67]
    ds_read_b64_tr_b16 v[176:177], v40 offset:6144
    ds_read_b64_tr_b16 v[178:179], v40 offset:7680
    v_mfma_f32_32x32x16_bf16 v[100:115], v[152:155], v[156:159], v[100:115]
    ds_read_b128 v[168:171], v37 offset:0
    ds_read_b64_tr_b16 v[180:181], v41 offset:6144
    v_mfma_f32_32x32x16_bf16 v[68:83], v[148:151], v[160:163], v[68:83]
    ds_read_b64_tr_b16 v[182:183], v41 offset:7680
    ds_read_b128 v[172:175], v37 offset:4096
    v_mfma_f32_32x32x16_bf16 v[116:131], v[152:155], v[160:163], v[116:131]
    ds_read_b64_tr_b16 v[184:185], v42 offset:6144
    ds_read_b64_tr_b16 v[186:187], v42 offset:7680
    v_mfma_f32_32x32x16_bf16 v[84:99], v[148:151], v[164:167], v[84:99]
    v_mfma_f32_32x32x16_bf16 v[132:147], v[152:155], v[164:167], v[132:147]
    s_waitcnt lgkmcnt(0)
    v_mfma_f32_32x32x16_bf16 v[52:67], v[168:171], v[176:179], v[52:67]
    ds_read_b64_tr_b16 v[156:157], v40 offset:12288
    ds_read_b64_tr_b16 v[158:159], v40 offset:13824
    v_mfma_f32_32x32x16_bf16 v[100:115], v[172:175], v[176:179], v[100:115]
    ds_read_b128 v[148:151], v38 offset:0
    ds_read_b64_tr_b16 v[160:161], v41 offset:12288
    v_mfma_f32_32x32x16_bf16 v[68:83], v[168:171], v[180:183], v[68:83]
    ds_read_b64_tr_b16 v[162:163], v41 offset:13824
    ds_read_b128 v[152:155], v38 offset:4096
    v_mfma_f32_32x32x16_bf16 v[116:131], v[172:175], v[180:183], v[116:131]
    ds_read_b64_tr_b16 v[164:165], v42 offset:12288
    ds_read_b64_tr_b16 v[166:167], v42 offset:13824
    v_mfma_f32_32x32x16_bf16 v[84:99], v[168:171], v[184:187], v[84:99]
    v_mfma_f32_32x32x16_bf16 v[132:147], v[172:175], v[184:187], v[132:147]
    s_waitcnt lgkmcnt(0)
    v_mfma_f32_32x32x16_bf16 v[52:67], v[148:151], v[156:159], v[52:67]
    ds_read_b64_tr_b16 v[176:177], v40 offset:18432
    ds_read_b64_tr_b16 v[178:179], v40 offset:19968
    v_mfma_f32_32x32x16_bf16 v[100:115], v[152:155], v[156:159], v[100:115]
    ds_read_b128 v[168:171], v39 offset:0
    ds_read_b64_tr_b16 v[180:181], v41 offset:18432
    v_mfma_f32_32x32x16_bf16 v[68:83], v[148:151], v[160:163], v[68:83]
    ds_read_b64_tr_b16 v[182:183], v41 offset:19968
    ds_read_b128 v[172:175], v39 offset:4096
    v_mfma_f32_32x32x16_bf16 v[116:131], v[152:155], v[160:163], v[116:131]
    ds_read_b64_tr_b16 v[184:185], v42 offset:18432
    ds_read_b64_tr_b16 v[186:187], v42 offset:19968
    v_mfma_f32_32x32x16_bf16 v[84:99], v[148:151], v[164:167], v[84:99]
    v_mfma_f32_32x32x16_bf16 v[132:147], v[152:155], v[164:167], v[132:147]
    s_waitcnt vmcnt(0) lgkmcnt(0)
    s_barrier
    v_mfma_f32_32x32x16_bf16 v[52:67], v[168:171], v[176:179], v[52:67]
    ds_read_b64_tr_b16 v[156:157], v26 offset:0
    ds_read_b64_tr_b16 v[158:159], v26 offset:1536
    v_mfma_f32_32x32x16_bf16 v[100:115], v[172:175], v[176:179], v[100:115]
    ds_read_b128 v[148:151], v22 offset:0
    ds_read_b64_tr_b16 v[160:161], v27 offset:0
    v_mfma_f32_32x32x16_bf16 v[68:83], v[168:171], v[180:183], v[68:83]
    ds_read_b64_tr_b16 v[162:163], v27 offset:1536
    ds_read_b128 v[152:155], v22 offset:4096
    v_mfma_f32_32x32x16_bf16 v[116:131], v[172:175], v[180:183], v[116:131]
    ds_read_b64_tr_b16 v[164:165], v28 offset:0
    ds_read_b64_tr_b16 v[166:167], v28 offset:1536
    v_mfma_f32_32x32x16_bf16 v[84:99], v[168:171], v[184:187], v[84:99]
    v_mfma_f32_32x32x16_bf16 v[132:147], v[172:175], v[184:187], v[132:147]
    s_waitcnt lgkmcnt(0)
    v_mfma_f32_32x32x16_bf16 v[52:67], v[148:151], v[156:159], v[52:67]
    ds_read_b64_tr_b16 v[176:177], v26 offset:6144
    ds_read_b64_tr_b16 v[178:179], v26 offset:7680
    v_mfma_f32_32x32x16_bf16 v[100:115], v[152:155], v[156:159], v[100:115]
    ds_read_b128 v[168:171], v23 offset:0
    ds_read_b64_tr_b16 v[180:181], v27 offset:6144
    v_mfma_f32_32x32x16_bf16 v[68:83], v[148:151], v[160:163], v[68:83]
    ds_read_b64_tr_b16 v[182:183], v27 offset:7680
    ds_read_b128 v[172:175], v23 offset:4096
    v_mfma_f32_32x32x16_bf16 v[116:131], v[152:155], v[160:163], v[116:131]
    ds_read_b64_tr_b16 v[184:185], v28 offset:6144
    ds_read_b64_tr_b16 v[186:187], v28 offset:7680
    v_mfma_f32_32x32x16_bf16 v[84:99], v[148:151], v[164:167], v[84:99]
    v_mfma_f32_32x32x16_bf16 v[132:147], v[152:155], v[164:167], v[132:147]
    s_waitcnt lgkmcnt(0)
    v_mfma_f32_32x32x16_bf16 v[52:67], v[168:171], v[176:179], v[52:67]
    ds_read_b64_tr_b16 v[156:157], v26 offset:12288
    ds_read_b64_tr_b16 v[158:159], v26 offset:13824
    v_mfma_f32_32x32x16_bf16 v[100:115], v[172:175], v[176:179], v[100:115]
    ds_read_b128 v[148:151], v24 offset:0
    ds_read_b64_tr_b16 v[160:161], v27 offset:12288
    v_mfma_f32_32x32x16_bf16 v[68:83], v[168:171], v[180:183], v[68:83]
    ds_read_b64_tr_b16 v[162:163], v27 offset:13824
    ds_read_b128 v[152:155], v24 offset:4096
    v_mfma_f32_32x32x16_bf16 v[116:131], v[172:175], v[180:183], v[116:131]
    ds_read_b64_tr_b16 v[164:165], v28 offset:12288
    ds_read_b64_tr_b16 v[166:167], v28 offset:13824
    v_mfma_f32_32x32x16_bf16 v[84:99], v[168:171], v[184:187], v[84:99]
    v_mfma_f32_32x32x16_bf16 v[132:147], v[172:175], v[184:187], v[132:147]
    s_waitcnt lgkmcnt(0)
    v_mfma_f32_32x32x16_bf16 v[52:67], v[148:151], v[156:159], v[52:67]
    ds_read_b64_tr_b16 v[176:177], v26 offset:18432
    ds_read_b64_tr_b16 v[178:179], v26 offset:19968
    v_mfma_f32_32x32x16_bf16 v[100:115], v[152:155], v[156:159], v[100:115]
    ds_read_b128 v[168:171], v25 offset:0
    ds_read_b64_tr_b16 v[180:181], v27 offset:18432
    v_mfma_f32_32x32x16_bf16 v[68:83], v[148:151], v[160:163], v[68:83]
    ds_read_b64_tr_b16 v[182:183], v27 offset:19968
    ds_read_b128 v[172:175], v25 offset:4096
    v_mfma_f32_32x32x16_bf16 v[116:131], v[152:155], v[160:163], v[116:131]
    ds_read_b64_tr_b16 v[184:185], v28 offset:18432
    ds_read_b64_tr_b16 v[186:187], v28 offset:19968
    v_mfma_f32_32x32x16_bf16 v[84:99], v[148:151], v[164:167], v[84:99]
    v_mfma_f32_32x32x16_bf16 v[132:147], v[152:155], v[164:167], v[132:147]
    s_waitcnt lgkmcnt(0)
    v_mfma_f32_32x32x16_bf16 v[52:67], v[168:171], v[176:179], v[52:67]
    v_mfma_f32_32x32x16_bf16 v[100:115], v[172:175], v[176:179], v[100:115]
    v_mfma_f32_32x32x16_bf16 v[68:83], v[168:171], v[180:183], v[68:83]
    v_mfma_f32_32x32x16_bf16 v[116:131], v[172:175], v[180:183], v[116:131]
    v_mfma_f32_32x32x16_bf16 v[84:99], v[168:171], v[184:187], v[84:99]
    v_mfma_f32_32x32x16_bf16 v[132:147], v[172:175], v[184:187], v[132:147]
    s_nop 15
    s_add_u32 s44, s8, 0x780000
    s_addc_u32 s45, s9, 0
    s_mov_b32 s46, 0x280000
    s_mov_b32 s47, 0x00020000
    v_lshlrev_b32 v20, 5, v8
    v_lshl_add_u32 v20, v9, 4, v20
    s_mul_i32 s50, s15, 81920
    v_add_u32 v20, s50, v20
    s_mul_i32 s50, s10, 163840
    s_lshl_b32 s51, s39, 10
    s_add_u32 s50, s50, s51
    s_sub_u32 s50, s50, 40960
    s_add_u32 s51, s50, 0
    v_cvt_pk_bf16_f32 v148, v52, v53
    v_cvt_pk_bf16_f32 v149, v54, v55
    v_cvt_pk_bf16_f32 v150, v56, v57
    v_cvt_pk_bf16_f32 v151, v58, v59
    buffer_store_dwordx4 v[148:151], v20, s[44:47], s51 offen sc1
    s_add_u32 s51, s50, 20480
    v_cvt_pk_bf16_f32 v152, v60, v61
    v_cvt_pk_bf16_f32 v153, v62, v63
    v_cvt_pk_bf16_f32 v154, v64, v65
    v_cvt_pk_bf16_f32 v155, v66, v67
    buffer_store_dwordx4 v[152:155], v20, s[44:47], s51 offen sc1
    s_add_u32 s51, s50, 40960
    v_cvt_pk_bf16_f32 v156, v100, v101
    v_cvt_pk_bf16_f32 v157, v102, v103
    v_cvt_pk_bf16_f32 v158, v104, v105
    v_cvt_pk_bf16_f32 v159, v106, v107
    buffer_store_dwordx4 v[156:159], v20, s[44:47], s51 offen sc1
    s_add_u32 s51, s50, 61440
    v_cvt_pk_bf16_f32 v160, v108, v109
    v_cvt_pk_bf16_f32 v161, v110, v111
    v_cvt_pk_bf16_f32 v162, v112, v113
    v_cvt_pk_bf16_f32 v163, v114, v115
    buffer_store_dwordx4 v[160:163], v20, s[44:47], s51 offen sc1
    s_add_u32 s51, s50, 1024
    v_cvt_pk_bf16_f32 v164, v68, v69
    v_cvt_pk_bf16_f32 v165, v70, v71
    v_cvt_pk_bf16_f32 v166, v72, v73
    v_cvt_pk_bf16_f32 v167, v74, v75
    buffer_store_dwordx4 v[164:167], v20, s[44:47], s51 offen sc1
    s_add_u32 s51, s50, 21504
    v_cvt_pk_bf16_f32 v168, v76, v77
    v_cvt_pk_bf16_f32 v169, v78, v79
    v_cvt_pk_bf16_f32 v170, v80, v81
    v_cvt_pk_bf16_f32 v171, v82, v83
    buffer_store_dwordx4 v[168:171], v20, s[44:47], s51 offen sc1
    s_add_u32 s51, s50, 41984
    v_cvt_pk_bf16_f32 v172, v116, v117
    v_cvt_pk_bf16_f32 v173, v118, v119
    v_cvt_pk_bf16_f32 v174, v120, v121
    v_cvt_pk_bf16_f32 v175, v122, v123
    buffer_store_dwordx4 v[172:175], v20, s[44:47], s51 offen sc1
    s_add_u32 s51, s50, 62464
    v_cvt_pk_bf16_f32 v176, v124, v125
    v_cvt_pk_bf16_f32 v177, v126, v127
    v_cvt_pk_bf16_f32 v178, v128, v129
    v_cvt_pk_bf16_f32 v179, v130, v131
    buffer_store_dwordx4 v[176:179], v20, s[44:47], s51 offen sc1
    s_add_u32 s51, s50, 2048
    v_cvt_pk_bf16_f32 v148, v84, v85
    v_cvt_pk_bf16_f32 v149, v86, v87
    v_cvt_pk_bf16_f32 v150, v88, v89
    v_cvt_pk_bf16_f32 v151, v90, v91
    buffer_store_dwordx4 v[148:151], v20, s[44:47], s51 offen sc1
    s_add_u32 s51, s50, 22528
    v_cvt_pk_bf16_f32 v152, v92, v93
    v_cvt_pk_bf16_f32 v153, v94, v95
    v_cvt_pk_bf16_f32 v154, v96, v97
    v_cvt_pk_bf16_f32 v155, v98, v99
    buffer_store_dwordx4 v[152:155], v20, s[44:47], s51 offen sc1
    s_add_u32 s51, s50, 43008
    v_cvt_pk_bf16_f32 v156, v132, v133
    v_cvt_pk_bf16_f32 v157, v134, v135
    v_cvt_pk_bf16_f32 v158, v136, v137
    v_cvt_pk_bf16_f32 v159, v138, v139
    buffer_store_dwordx4 v[156:159], v20, s[44:47], s51 offen sc1
    s_add_u32 s51, s50, 63488
    v_cvt_pk_bf16_f32 v160, v140, v141
    v_cvt_pk_bf16_f32 v161, v142, v143
    v_cvt_pk_bf16_f32 v162, v144, v145
    v_cvt_pk_bf16_f32 v163, v146, v147
    buffer_store_dwordx4 v[160:163], v20, s[44:47], s51 offen sc1
    s_endpgm
.g1m_4:
    s_waitcnt vmcnt(10) lgkmcnt(0)
    s_barrier
    ds_read_b64_tr_b16 v[156:157], v26 offset:0
    ds_read_b64_tr_b16 v[158:159], v26 offset:1536
    ds_read_b128 v[148:151], v22 offset:0
    ds_read_b64_tr_b16 v[160:161], v27 offset:0
    ds_read_b64_tr_b16 v[162:163], v27 offset:1536
    ds_read_b128 v[152:155], v22 offset:4096
    ds_read_b64_tr_b16 v[164:165], v28 offset:0
    ds_read_b64_tr_b16 v[166:167], v28 offset:1536
    s_add_u32 m0, s32, 81920
    s_nop 0
    buffer_load_dwordx4 v6, s[20:23], s28 offen  lds
    s_add_u32 m0, s32, 82944
    s_add_u32 s29, s28, 10240
    buffer_load_dwordx4 v7, s[20:23], s29 offen  lds
    s_add_u32 m0, s32, 83968
    s_add_u32 s29, s28, 20480
    buffer_load_dwordx4 v6, s[20:23], s29 offen  lds
    s_waitcnt lgkmcnt(0)
    v_mfma_f32_32x32x16_bf16 v[52:67], v[156:159], v[148:151], 0
    ds_read_b64_tr_b16 v[176:177], v26 offset:6144
    ds_read_b64_tr_b16 v[178:179], v26 offset:7680
    s_add_u32 m0, s32, 84992
    s_add_u32 s29, s28, 30720
    buffer_load_dwordx4 v7, s[20:23], s29 offen  lds
    v_mfma_f32_32x32x16_bf16 v[100:115], v[156:159], v[152:155], 0
    ds_read_b128 v[168:171], v23 offset:0
    ds_read_b64_tr_b16 v[180:181], v27 offset:6144
    v_mfma_f32_32x32x16_bf16 v[68:83], v[148:151], v[160:163], 0
    ds_read_b64_tr_b16 v[182:183], v27 offset:7680
    ds_read_b128 v[172:175], v23 offset:4096
    s_add_u32 m0, s33, 98304
    s_nop 0
    buffer_load_dwordx4 v16, s[24:27], s30 offen  lds
    v_mfma_f32_32x32x16_bf16 v[116:131], v[152:155], v[160:163], 0
    ds_read_b64_tr_b16 v[184:185], v28 offset:6144
    ds_read_b64_tr_b16 v[186:187], v28 offset:7680
    v_mfma_f32_32x32x16_bf16 v[84:99], v[148:151], v[164:167], 0
    s_add_u32 m0, s33, 99328
    s_nop 0
    buffer_load_dwordx4 v17, s[24:27], s30 offen  lds
    v_mfma_f32_32x32x16_bf16 v[132:147], v[152:155], v[164:167], 0
    s_waitcnt lgkmcnt(0)
    v_mfma_f32_32x32x16_bf16 v[52:67], v[176:179], v[168:171], v[52:67]
    ds_read_b64_tr_b16 v[156:157], v26 offset:12288
    ds_read_b64_tr_b16 v[158:159], v26 offset:13824
    v_mfma_f32_32x32x16_bf16 v[100:115], v[176:179], v[172:175], v[100:115]
    ds_read_b128 v[148:151], v24 offset:0
    ds_read_b64_tr_b16 v[160:161], v27 offset:12288
    s_add_u32 m0, s33, 100352
    s_nop 0
    buffer_load_dwordx4 v18, s[24:27], s30 offen  lds
    v_mfma_f32_32x32x16_bf16 v[68:83], v[168:171], v[180:183], v[68:83]
    ds_read_b64_tr_b16 v[162:163], v27 offset:13824
    ds_read_b128 v[152:155], v24 offset:4096
    v_mfma_f32_32x32x16_bf16 v[116:131], v[172:175], v[180:183], v[116:131]
    ds_read_b64_tr_b16 v[164:165], v28 offset:12288
    ds_read_b64_tr_b16 v[166:167], v28 offset:13824
    v_mfma_f32_32x32x16_bf16 v[84:99], v[168:171], v[184:187], v[84:99]
    s_add_u32 m0, s33, 101376
    s_nop 0
    buffer_load_dwordx4 v19, s[24:27], s30 offen  lds
    v_mfma_f32_32x32x16_bf16 v[132:147], v[172:175], v[184:187], v[132:147]
    s_waitcnt lgkmcnt(0)
    v_mfma_f32_32x32x16_bf16 v[52:67], v[156:159], v[148:151], v[52:67]
    ds_read_b64_tr_b16 v[176:177], v26 offset:18432
    ds_read_b64_tr_b16 v[178:179], v26 offset:19968
    v_mfma_f32_32x32x16_bf16 v[100:115], v[156:159], v[152:155], v[100:115]
    ds_read_b128 v[168:171], v25 offset:0
    ds_read_b64_tr_b16 v[180:181], v27 offset:18432
    s_add_u32 m0, s33, 102400
    s_nop 0
    buffer_load_dwordx4 v20, s[24:27], s30 offen  lds
    v_mfma_f32_32x32x16_bf16 v[68:83], v[148:151], v[160:163], v[68:83]
    ds_read_b64_tr_b16 v[182:183], v27 offset:19968
    ds_read_b128 v[172:175], v25 offset:4096
    v_mfma_f32_32x32x16_bf16 v[116:131], v[152:155], v[160:163], v[116:131]
    ds_read_b64_tr_b16 v[184:185], v28 offset:18432
    ds_read_b64_tr_b16 v[186:187], v28 offset:19968
    v_mfma_f32_32x32x16_bf16 v[84:99], v[148:151], v[164:167], v[84:99]
    s_add_u32 m0, s33, 103424
    s_nop 0
    buffer_load_dwordx4 v21, s[24:27], s30 offen  lds
    s_add_u32 s34, s34, 1
    s_cmp_eq_u32 s34, 10
    s_cselect_b32 s35, 0xfffffb80, s38
    s_cselect_b32 s36, 0xffde4000, s37
    s_cselect_b32 s34, 0, s34
    s_add_u32 s28, s28, s35
    s_add_u32 s30, s30, s36
    v_mfma_f32_32x32x16_bf16 v[132:147], v[152:155], v[164:167], v[132:147]
    s_waitcnt vmcnt(10) lgkmcnt(0)
    s_barrier
    v_mfma_f32_32x32x16_bf16 v[52:67], v[176:179], v[168:171], v[52:67]
    ds_read_b64_tr_b16 v[156:157], v33 offset:0
    ds_read_b64_tr_b16 v[158:159], v33 offset:1536
    s_add_u32 m0, s32, 0
    s_nop 0
    buffer_load_dwordx4 v6, s[20:23], s28 offen  lds
    v_mfma_f32_32x32x16_bf16 v[100:115], v[176:179], v[172:175], v[100:115]
    ds_read_b128 v[148:151], v29 offset:0
    ds_read_b64_tr_b16 v[160:161], v34 offset:0
    v_mfma_f32_32x32x16_bf16 v[68:83], v[168:171], v[180:183], v[68:83]
    ds_read_b64_tr_b16 v[162:163], v34 offset:1536
    ds_read_b128 v[152:155], v29 offset:4096
    s_add_u32 m0, s32, 1024
    s_add_u32 s29, s28, 10240
    buffer_load_dwordx4 v7, s[20:23], s29 offen  lds
    v_mfma_f32_32x32x16_bf16 v[116:131], v[172:175], v[180:183], v[116:131]
    ds_read_b64_tr_b16 v[164:165], v35 offset:0
    ds_read_b64_tr_b16 v[166:167], v35 offset:1536
    v_mfma_f32_32x32x16_bf16 v[84:99], v[168:171], v[184:187], v[84:99]
    s_add_u32 m0, s32, 2048
    s_add_u32 s29, s28, 20480
    buffer_load_dwordx4 v6, s[20:23], s29 offen  lds
    v_mfma_f32_32x32x16_bf16 v[132:147], v[172:175], v[184:187], v[132:147]
    s_waitcnt lgkmcnt(0)
    v_mfma_f32_32x32x16_bf16 v[52:67], v[156:159], v[148:151], v[52:67]
    ds_read_b64_tr_b16 v[176:177], v33 offset:6144
    ds_read_b64_tr_b16 v[178:179], v33 offset:7680
    s_add_u32 m0, s32, 3072
    s_add_u32 s29, s28, 30720
    buffer_load_dwordx4 v7, s[20:23], s29 offen  lds
    v_mfma_f32_32x32x16_bf16 v[100:115], v[156:159], v[152:155], v[100:115]
    ds_read_b128 v[168:171], v30 offset:0
    ds_read_b64_tr_b16 v[180:181], v34 offset:6144
    v_mfma_f32_32x32x16_bf16 v[68:83], v[148:151], v[160:163], v[68:83]
    ds_read_b64_tr_b16 v[182:183], v34 offset:7680
    ds_read_b128 v[172:175], v30 offset:4096
    s_add_u32 m0, s33, 16384
    s_nop 0
    buffer_load_dwordx4 v16, s[24:27], s30 offen  lds
    v_mfma_f32_32x32x16_bf16 v[116:131], v[152:155], v[160:163], v[116:131]
    ds_read_b64_tr_b16 v[184:185], v35 offset:6144
    ds_read_b64_tr_b16 v[186:187], v35 offset:7680
    v_mfma_f32_32x32x16_bf16 v[84:99], v[148:151], v[164:167], v[84:99]
    s_add_u32 m0, s33, 17408
    s_nop 0
    buffer_load_dwordx4 v17, s[24:27], s30 offen  lds
    v_mfma_f32_32x32x16_bf16 v[132:147], v[152:155], v[164:167], v[132:147]
    s_waitcnt lgkmcnt(0)
    v_mfma_f32_32x32x16_bf16 v[52:67], v[176:179], v[168:171], v[52:67]
    ds_read_b64_tr_b16 v[156:157], v33 offset:12288
    ds_read_b64_tr_b16 v[158:159], v33 offset:13824
    v_mfma_f32_32x32x16_bf16 v[100:115], v[176:179], v[172:175], v[100:115]
    ds_read_b128 v[148:151], v31 offset:0
    ds_read_b64_tr_b16 v[160:161], v34 offset:12288
    s_add_u32 m0, s33, 18432
    s_nop 0
    buffer_load_dwordx4 v18, s[24:27], s30 offen  lds
    v_mfma_f32_32x32x16_bf16 v[68:83], v[168:171], v[180:183], v[68:83]
    ds_read_b64_tr_b16 v[162:163], v34 offset:13824
    ds_read_b128 v[152:155], v31 offset:4096
    v_mfma_f32_32x32x16_bf16 v[116:131], v[172:175], v[180:183], v[116:131]
    ds_read_b64_tr_b16 v[164:165], v35 offset:12288
    ds_read_b64_tr_b16 v[166:167], v35 offset:13824
    v_mfma_f32_32x32x16_bf16 v[84:99], v[168:171], v[184:187], v[84:99]
    s_add_u32 m0, s33, 19456
    s_nop 0
    buffer_load_dwordx4 v19, s[24:27], s30 offen  lds
    v_mfma_f32_32x32x16_bf16 v[132:147], v[172:175], v[184:187], v[132:147]
    s_waitcnt lgkmcnt(0)
    v_mfma_f32_32x32x16_bf16 v[52:67], v[156:159], v[148:151], v[52:67]
    ds_read_b64_tr_b16 v[176:177], v33 offset:18432
    ds_read_b64_tr_b16 v[178:179], v33 offset:19968
    v_mfma_f32_32x32x16_bf16 v[100:115], v[156:159], v[152:155], v[100:115]
    ds_read_b128 v[168:171], v32 offset:0
    ds_read_b64_tr_b16 v[180:181], v34 offset:18432
    s_add_u32 m0, s33, 20480
    s_nop 0
    buffer_load_dwordx4 v20, s[24:27], s30 offen  lds
    v_mfma_f32_32x32x16_bf16 v[68:83], v[148:151], v[160:163], v[68:83]
    ds_read_b64_tr_b16 v[182:183], v34 offset:19968
    ds_read_b128 v[172:175], v32 offset:4096
    v_mfma_f32_32x32x16_bf16 v[116:131], v[152:155], v[160:163], v[116:131]
    ds_read_b64_tr_b16 v[184:185], v35 offset:18432
    ds_read_b64_tr_b16 v[186:187], v35 offset:19968
    v_mfma_f32_32x32x16_bf16 v[84:99], v[148:151], v[164:167], v[84:99]
    s_add_u32 m0, s33, 21504
    s_nop 0
    buffer_load_dwordx4 v21, s[24:27], s30 offen  lds
    s_add_u32 s34, s34, 1
    s_cmp_eq_u32 s34, 10
    s_cselect_b32 s35, 0xfffffb80, s38
    s_cselect_b32 s36, 0xffde4000, s37
    s_cselect_b32 s34, 0, s34
    s_add_u32 s28, s28, s35
    s_add_u32 s30, s30, s36
    v_mfma_f32_32x32x16_bf16 v[132:147], v[152:155], v[164:167], v[132:147]
    s_waitcnt vmcnt(10) lgkmcnt(0)
    s_barrier
    v_mfma_f32_32x32x16_bf16 v[52:67], v[176:179], v[168:171], v[52:67]
    ds_read_b64_tr_b16 v[156:157], v40 offset:0
    ds_read_b64_tr_b16 v[158:159], v40 offset:1536
    s_add_u32 m0, s32, 40960
    s_nop 0
    buffer_load_dwordx4 v6, s[20:23], s28 offen  lds
    v_mfma_f32_32x32x16_bf16 v[100:115], v[176:179], v[172:175], v[100:115]
    ds_read_b128 v[148:151], v36 offset:0
    ds_read_b64_tr_b16 v[160:161], v41 offset:0
    v_mfma_f32_32x32x16_bf16 v[68:83], v[168:171], v[180:183], v[68:83]
    ds_read_b64_tr_b16 v[162:163], v41 offset:1536
    ds_read_b128 v[152:155], v36 offset:4096
    s_add_u32 m0, s32, 41984
    s_add_u32 s29, s28, 10240
    buffer_load_dwordx4 v7, s[20:23], s29 offen  lds
    v_mfma_f32_32x32x16_bf16 v[116:131], v[172:175], v[180:183], v[116:131]
    ds_read_b64_tr_b16 v[164:165], v42 offset:0
    ds_read_b64_tr_b16 v[166:167], v42 offset:1536
    v_mfma_f32_32x32x16_bf16 v[84:99], v[168:171], v[184:187], v[84:99]
    s_add_u32 m0, s32, 43008
    s_add_u32 s29, s28, 20480
    buffer_load_dwordx4 v6, s[20:23], s29 offen  lds
    v_mfma_f32_32x32x16_bf16 v[132:147], v[172:175], v[184:187], v[132:147]
    s_waitcnt lgkmcnt(0)
    v_mfma_f32_32x32x16_bf16 v[52:67], v[156:159], v[148:151], v[52:67]
    ds_read_b64_tr_b16 v[176:177], v40 offset:6144
    ds_read_b64_tr_b16 v[178:179], v40 offset:7680
    s_add_u32 m0, s32, 44032
    s_add_u32 s29, s28, 30720
    buffer_load_dwordx4 v7, s[20:23], s29 offen  lds
    v_mfma_f32_32x32x16_bf16 v[100:115], v[156:159], v[152:155], v[100:115]
    ds_read_b128 v[168:171], v37 offset:0
    ds_read_b64_tr_b16 v[180:181], v41 offset:6144
    v_mfma_f32_32x32x16_bf16 v[68:83], v[148:151], v[160:163], v[68:83]
    ds_read_b64_tr_b16 v[182:183], v41 offset:7680
    ds_read_b128 v[172:175], v37 offset:4096
    s_add_u32 m0, s33, 57344
    s_nop 0
    buffer_load_dwordx4 v16, s[24:27], s30 offen  lds
    v_mfma_f32_32x32x16_bf16 v[116:131], v[152:155], v[160:163], v[116:131]
    ds_read_b64_tr_b16 v[184:185], v42 offset:6144
    ds_read_b64_tr_b16 v[186:187], v42 offset:7680
    v_mfma_f32_32x32x16_bf16 v[84:99], v[148:151], v[164:167], v[84:99]
    s_add_u32 m0, s33, 58368
    s_nop 0
    buffer_load_dwordx4 v17, s[24:27], s30 offen  lds
    v_mfma_f32_32x32x16_bf16 v[132:147], v[152:155], v[164:167], v[132:147]
    s_waitcnt lgkmcnt(0)
    v_mfma_f32_32x32x16_bf16 v[52:67], v[176:179], v[168:171], v[52:67]
    ds_read_b64_tr_b16 v[156:157], v40 offset:12288
    ds_read_b64_tr_b16 v[158:159], v40 offset:13824
    v_mfma_f32_32x32x16_bf16 v[100:115], v[176:179], v[172:175], v[100:115]
    ds_read_b128 v[148:151], v38 offset:0
    ds_read_b64_tr_b16 v[160:161], v41 offset:12288
    s_add_u32 m0, s33, 59392
    s_nop 0
    buffer_load_dwordx4 v18, s[24:27], s30 offen  lds
    v_mfma_f32_32x32x16_bf16 v[68:83], v[168:171], v[180:183], v[68:83]
    ds_read_b64_tr_b16 v[162:163], v41 offset:13824
    ds_read_b128 v[152:155], v38 offset:4096
    v_mfma_f32_32x32x16_bf16 v[116:131], v[172:175], v[180:183], v[116:131]
    ds_read_b64_tr_b16 v[164:165], v42 offset:12288
    ds_read_b64_tr_b16 v[166:167], v42 offset:13824
    v_mfma_f32_32x32x16_bf16 v[84:99], v[168:171], v[184:187], v[84:99]
    s_add_u32 m0, s33, 60416
    s_nop 0
    buffer_load_dwordx4 v19, s[24:27], s30 offen  lds
    v_mfma_f32_32x32x16_bf16 v[132:147], v[172:175], v[184:187], v[132:147]
    s_waitcnt lgkmcnt(0)
    v_mfma_f32_32x32x16_bf16 v[52:67], v[156:159], v[148:151], v[52:67]
    ds_read_b64_tr_b16 v[176:177], v40 offset:18432
    ds_read_b64_tr_b16 v[178:179], v40 offset:19968
    v_mfma_f32_32x32x16_bf16 v[100:115], v[156:159], v[152:155], v[100:115]
    ds_read_b128 v[168:171], v39 offset:0
    ds_read_b64_tr_b16 v[180:181], v41 offset:18432
    s_add_u32 m0, s33, 61440
    s_nop 0
    buffer_load_dwordx4 v20, s[24:27], s30 offen  lds
    v_mfma_f32_32x32x16_bf16 v[68:83], v[148:151], v[160:163], v[68:83]
    ds_read_b64_tr_b16 v[182:183], v41 offset:19968
    ds_read_b128 v[172:175], v39 offset:4096
    v_mfma_f32_32x32x16_bf16 v[116:131], v[152:155], v[160:163], v[116:131]
    ds_read_b64_tr_b16 v[184:185], v42 offset:18432
    ds_read_b64_tr_b16 v[186:187], v42 offset:19968
    v_mfma_f32_32x32x16_bf16 v[84:99], v[148:151], v[164:167], v[84:99]
    s_add_u32 m0, s33, 62464
    s_nop 0
    buffer_load_dwordx4 v21, s[24:27], s30 offen  lds
    s_add_u32 s34, s34, 1
    s_cmp_eq_u32 s34, 10
    s_cselect_b32 s35, 0xfffffb80, s38
    s_cselect_b32 s36, 0xffde4000, s37
    s_cselect_b32 s34, 0, s34
    s_add_u32 s28, s28, s35
    s_add_u32 s30, s30, s36
    v_mfma_f32_32x32x16_bf16 v[132:147], v[152:155], v[164:167], v[132:147]
    s_waitcnt vmcnt(10) lgkmcnt(0)
    s_barrier
    v_mfma_f32_32x32x16_bf16 v[52:67], v[176:179], v[168:171], v[52:67]
    ds_read_b64_tr_b16 v[156:157], v26 offset:0
    ds_read_b64_tr_b16 v[158:159], v26 offset:1536
    s_add_u32 m0, s32, 81920
    s_nop 0
    buffer_load_dwordx4 v6, s[20:23], s28 offen  lds
    v_mfma_f32_32x32x16_bf16 v[100:115], v[176:179], v[172:175], v[100:115]
    ds_read_b128 v[148:151], v22 offset:0
    ds_read_b64_tr_b16 v[160:161], v27 offset:0
    v_mfma_f32_32x32x16_bf16 v[68:83], v[168:171], v[180:183], v[68:83]
    ds_read_b64_tr_b16 v[162:163], v27 offset:1536
    ds_read_b128 v[152:155], v22 offset:4096
    s_add_u32 m0, s32, 82944
    s_add_u32 s29, s28, 10240
    buffer_load_dwordx4 v7, s[20:23], s29 offen  lds
    v_mfma_f32_32x32x16_bf16 v[116:131], v[172:175], v[180:183], v[116:131]
    ds_read_b64_tr_b16 v[164:165], v28 offset:0
    ds_read_b64_tr_b16 v[166:167], v28 offset:1536
    v_mfma_f32_32x32x16_bf16 v[84:99], v[168:171], v[184:187], v[84:99]
    s_add_u32 m0, s32, 83968
    s_add_u32 s29, s28, 20480
    buffer_load_dwordx4 v6, s[20:23], s29 offen  lds
    v_mfma_f32_32x32x16_bf16 v[132:147], v[172:175], v[184:187], v[132:147]
    s_waitcnt lgkmcnt(0)
    v_mfma_f32_32x32x16_bf16 v[52:67], v[156:159], v[148:151], v[52:67]
    ds_read_b64_tr_b16 v[176:177], v26 offset:6144
    ds_read_b64_tr_b16 v[178:179], v26 offset:7680
    s_add_u32 m0, s32, 84992
    s_add_u32 s29, s28, 30720
    buffer_load_dwordx4 v7, s[20:23], s29 offen  lds
    v_mfma_f32_32x32x16_bf16 v[100:115], v[156:159], v[152:155], v[100:115]
    ds_read_b128 v[168:171], v23 offset:0
    ds_read_b64_tr_b16 v[180:181], v27 offset:6144
    v_mfma_f32_32x32x16_bf16 v[68:83], v[148:151], v[160:163], v[68:83]
    ds_read_b64_tr_b16 v[182:183], v27 offset:7680
    ds_read_b128 v[172:175], v23 offset:4096
    s_add_u32 m0, s33, 98304
    s_nop 0
    buffer_load_dwordx4 v16, s[24:27], s30 offen  lds
    v_mfma_f32_32x32x16_bf16 v[116:131], v[152:155], v[160:163], v[116:131]
    ds_read_b64_tr_b16 v[184:185], v28 offset:6144
    ds_read_b64_tr_b16 v[186:187], v28 offset:7680
    v_mfma_f32_32x32x16_bf16 v[84:99], v[148:151], v[164:167], v[84:99]
    s_add_u32 m0, s33, 99328
    s_nop 0
    buffer_load_dwordx4 v17, s[24:27], s30 offen  lds
    v_mfma_f32_32x32x16_bf16 v[132:147], v[152:155], v[164:167], v[132:147]
    s_waitcnt lgkmcnt(0)
    v_mfma_f32_32x32x16_bf16 v[52:67], v[176:179], v[168:171], v[52:67]
    ds_read_b64_tr_b16 v[156:157], v26 offset:12288
    ds_read_b64_tr_b16 v[158:159], v26 offset:13824
    v_mfma_f32_32x32x16_bf16 v[100:115], v[176:179], v[172:175], v[100:115]
    ds_read_b128 v[148:151], v24 offset:0
    ds_read_b64_tr_b16 v[160:161], v27 offset:12288
    s_add_u32 m0, s33, 100352
    s_nop 0
    buffer_load_dwordx4 v18, s[24:27], s30 offen  lds
    v_mfma_f32_32x32x16_bf16 v[68:83], v[168:171], v[180:183], v[68:83]
    ds_read_b64_tr_b16 v[162:163], v27 offset:13824
    ds_read_b128 v[152:155], v24 offset:4096
    v_mfma_f32_32x32x16_bf16 v[116:131], v[172:175], v[180:183], v[116:131]
    ds_read_b64_tr_b16 v[164:165], v28 offset:12288
    ds_read_b64_tr_b16 v[166:167], v28 offset:13824
    v_mfma_f32_32x32x16_bf16 v[84:99], v[168:171], v[184:187], v[84:99]
    s_add_u32 m0, s33, 101376
    s_nop 0
    buffer_load_dwordx4 v19, s[24:27], s30 offen  lds
    v_mfma_f32_32x32x16_bf16 v[132:147], v[172:175], v[184:187], v[132:147]
    s_waitcnt lgkmcnt(0)
    v_mfma_f32_32x32x16_bf16 v[52:67], v[156:159], v[148:151], v[52:67]
    ds_read_b64_tr_b16 v[176:177], v26 offset:18432
    ds_read_b64_tr_b16 v[178:179], v26 offset:19968
    v_mfma_f32_32x32x16_bf16 v[100:115], v[156:159], v[152:155], v[100:115]
    ds_read_b128 v[168:171], v25 offset:0
    ds_read_b64_tr_b16 v[180:181], v27 offset:18432
    s_add_u32 m0, s33, 102400
    s_nop 0
    buffer_load_dwordx4 v20, s[24:27], s30 offen  lds
    v_mfma_f32_32x32x16_bf16 v[68:83], v[148:151], v[160:163], v[68:83]
    ds_read_b64_tr_b16 v[182:183], v27 offset:19968
    ds_read_b128 v[172:175], v25 offset:4096
    v_mfma_f32_32x32x16_bf16 v[116:131], v[152:155], v[160:163], v[116:131]
    ds_read_b64_tr_b16 v[184:185], v28 offset:18432
    ds_read_b64_tr_b16 v[186:187], v28 offset:19968
    v_mfma_f32_32x32x16_bf16 v[84:99], v[148:151], v[164:167], v[84:99]
    s_add_u32 m0, s33, 103424
    s_nop 0
    buffer_load_dwordx4 v21, s[24:27], s30 offen  lds
    s_add_u32 s34, s34, 1
    s_cmp_eq_u32 s34, 10
    s_cselect_b32 s35, 0xfffffb80, s38
    s_cselect_b32 s36, 0xffde4000, s37
    s_cselect_b32 s34, 0, s34
    s_add_u32 s28, s28, s35
    s_add_u32 s30, s30, s36
    v_mfma_f32_32x32x16_bf16 v[132:147], v[152:155], v[164:167], v[132:147]
    s_waitcnt vmcnt(10) lgkmcnt(0)
    s_barrier
    v_mfma_f32_32x32x16_bf16 v[52:67], v[176:179], v[168:171], v[52:67]
    ds_read_b64_tr_b16 v[156:157], v33 offset:0
    ds_read_b64_tr_b16 v[158:159], v33 offset:1536
    s_add_u32 m0, s32, 0
    s_nop 0
    buffer_load_dwordx4 v6, s[20:23], s28 offen  lds
    v_mfma_f32_32x32x16_bf16 v[100:115], v[176:179], v[172:175], v[100:115]
    ds_read_b128 v[148:151], v29 offset:0
    ds_read_b64_tr_b16 v[160:161], v34 offset:0
    v_mfma_f32_32x32x16_bf16 v[68:83], v[168:171], v[180:183], v[68:83]
    ds_read_b64_tr_b16 v[162:163], v34 offset:1536
    ds_read_b128 v[152:155], v29 offset:4096
    s_add_u32 m0, s32, 1024
    s_add_u32 s29, s28, 10240
    buffer_load_dwordx4 v7, s[20:23], s29 offen  lds
    v_mfma_f32_32x32x16_bf16 v[116:131], v[172:175], v[180:183], v[116:131]
    ds_read_b64_tr_b16 v[164:165], v35 offset:0
    ds_read_b64_tr_b16 v[166:167], v35 offset:1536
    v_mfma_f32_32x32x16_bf16 v[84:99], v[168:171], v[184:187], v[84:99]
    s_add_u32 m0, s32, 2048
    s_add_u32 s29, s28, 20480
    buffer_load_dwordx4 v6, s[20:23], s29 offen  lds
    v_mfma_f32_32x32x16_bf16 v[132:147], v[172:175], v[184:187], v[132:147]
    s_waitcnt lgkmcnt(0)
    v_mfma_f32_32x32x16_bf16 v[52:67], v[156:159], v[148:151], v[52:67]
    ds_read_b64_tr_b16 v[176:177], v33 offset:6144
    ds_read_b64_tr_b16 v[178:179], v33 offset:7680
    s_add_u32 m0, s32, 3072
    s_add_u32 s29, s28, 30720
    buffer_load_dwordx4 v7, s[20:23], s29 offen  lds
    v_mfma_f32_32x32x16_bf16 v[100:115], v[156:159], v[152:155], v[100:115]
    ds_read_b128 v[168:171], v30 offset:0
    ds_read_b64_tr_b16 v[180:181], v34 offset:6144
    v_mfma_f32_32x32x16_bf16 v[68:83], v[148:151], v[160:163], v[68:83]
    ds_read_b64_tr_b16 v[182:183], v34 offset:7680
    ds_read_b128 v[172:175], v30 offset:4096
    s_add_u32 m0, s33, 16384
    s_nop 0
    buffer_load_dwordx4 v16, s[24:27], s30 offen  lds
    v_mfma_f32_32x32x16_bf16 v[116:131], v[152:155], v[160:163], v[116:131]
    ds_read_b64_tr_b16 v[184:185], v35 offset:6144
    ds_read_b64_tr_b16 v[186:187], v35 offset:7680
    v_mfma_f32_32x32x16_bf16 v[84:99], v[148:151], v[164:167], v[84:99]
    s_add_u32 m0, s33, 17408
    s_nop 0
    buffer_load_dwordx4 v17, s[24:27], s30 offen  lds
    v_mfma_f32_32x32x16_bf16 v[132:147], v[152:155], v[164:167], v[132:147]
    s_waitcnt lgkmcnt(0)
    v_mfma_f32_32x32x16_bf16 v[52:67], v[176:179], v[168:171], v[52:67]
    ds_read_b64_tr_b16 v[156:157], v33 offset:12288
    ds_read_b64_tr_b16 v[158:159], v33 offset:13824
    v_mfma_f32_32x32x16_bf16 v[100:115], v[176:179], v[172:175], v[100:115]
    ds_read_b128 v[148:151], v31 offset:0
    ds_read_b64_tr_b16 v[160:161], v34 offset:12288
    s_add_u32 m0, s33, 18432
    s_nop 0
    buffer_load_dwordx4 v18, s[24:27], s30 offen  lds
    v_mfma_f32_32x32x16_bf16 v[68:83], v[168:171], v[180:183], v[68:83]
    ds_read_b64_tr_b16 v[162:163], v34 offset:13824
    ds_read_b128 v[152:155], v31 offset:4096
    v_mfma_f32_32x32x16_bf16 v[116:131], v[172:175], v[180:183], v[116:131]
    ds_read_b64_tr_b16 v[164:165], v35 offset:12288
    ds_read_b64_tr_b16 v[166:167], v35 offset:13824
    v_mfma_f32_32x32x16_bf16 v[84:99], v[168:171], v[184:187], v[84:99]
    s_add_u32 m0, s33, 19456
    s_nop 0
    buffer_load_dwordx4 v19, s[24:27], s30 offen  lds
    v_mfma_f32_32x32x16_bf16 v[132:147], v[172:175], v[184:187], v[132:147]
    s_waitcnt lgkmcnt(0)
    v_mfma_f32_32x32x16_bf16 v[52:67], v[156:159], v[148:151], v[52:67]
    ds_read_b64_tr_b16 v[176:177], v33 offset:18432
    ds_read_b64_tr_b16 v[178:179], v33 offset:19968
    v_mfma_f32_32x32x16_bf16 v[100:115], v[156:159], v[152:155], v[100:115]
    ds_read_b128 v[168:171], v32 offset:0
    ds_read_b64_tr_b16 v[180:181], v34 offset:18432
    s_add_u32 m0, s33, 20480
    s_nop 0
    buffer_load_dwordx4 v20, s[24:27], s30 offen  lds
    v_mfma_f32_32x32x16_bf16 v[68:83], v[148:151], v[160:163], v[68:83]
    ds_read_b64_tr_b16 v[182:183], v34 offset:19968
    ds_read_b128 v[172:175], v32 offset:4096
    v_mfma_f32_32x32x16_bf16 v[116:131], v[152:155], v[160:163], v[116:131]
    ds_read_b64_tr_b16 v[184:185], v35 offset:18432
    ds_read_b64_tr_b16 v[186:187], v35 offset:19968
    v_mfma_f32_32x32x16_bf16 v[84:99], v[148:151], v[164:167], v[84:99]
    s_add_u32 m0, s33, 21504
    s_nop 0
    buffer_load_dwordx4 v21, s[24:27], s30 offen  lds
    s_add_u32 s34, s34, 1
    s_cmp_eq_u32 s34, 10
    s_cselect_b32 s35, 0xfffffb80, s38
    s_cselect_b32 s36, 0xffde4000, s37
    s_cselect_b32 s34, 0, s34
    s_add_u32 s28, s28, s35
    s_add_u32 s30, s30, s36
    v_mfma_f32_32x32x16_bf16 v[132:147], v[152:155], v[164:167], v[132:147]
    s_waitcnt vmcnt(10) lgkmcnt(0)
    s_barrier
    v_mfma_f32_32x32x16_bf16 v[52:67], v[176:179], v[168:171], v[52:67]
    ds_read_b64_tr_b16 v[156:157], v40 offset:0
    ds_read_b64_tr_b16 v[158:159], v40 offset:1536
    s_add_u32 m0, s32, 40960
    s_nop 0
    buffer_load_dwordx4 v6, s[20:23], s28 offen  lds
    v_mfma_f32_32x32x16_bf16 v[100:115], v[176:179], v[172:175], v[100:115]
    ds_read_b128 v[148:151], v36 offset:0
    ds_read_b64_tr_b16 v[160:161], v41 offset:0
    v_mfma_f32_32x32x16_bf16 v[68:83], v[168:171], v[180:183], v[68:83]
    ds_read_b64_tr_b16 v[162:163], v41 offset:1536
    ds_read_b128 v[152:155], v36 offset:4096
    s_add_u32 m0, s32, 41984
    s_add_u32 s29, s28, 10240
    buffer_load_dwordx4 v7, s[20:23], s29 offen  lds
    v_mfma_f32_32x32x16_bf16 v[116:131], v[172:175], v[180:183], v[116:131]
    ds_read_b64_tr_b16 v[164:165], v42 offset:0
    ds_read_b64_tr_b16 v[166:167], v42 offset:1536
    v_mfma_f32_32x32x16_bf16 v[84:99], v[168:171], v[184:187], v[84:99]
    s_add_u32 m0, s32, 43008
    s_add_u32 s29, s28, 20480
    buffer_load_dwordx4 v6, s[20:23], s29 offen  lds
    v_mfma_f32_32x32x16_bf16 v[132:147], v[172:175], v[184:187], v[132:147]
    s_waitcnt lgkmcnt(0)
    v_mfma_f32_32x32x16_bf16 v[52:67], v[156:159], v[148:151], v[52:67]
    ds_read_b64_tr_b16 v[176:177], v40 offset:6144
    ds_read_b64_tr_b16 v[178:179], v40 offset:7680
    s_add_u32 m0, s32, 44032
    s_add_u32 s29, s28, 30720
    buffer_load_dwordx4 v7, s[20:23], s29 offen  lds
    v_mfma_f32_32x32x16_bf16 v[100:115], v[156:159], v[152:155], v[100:115]
    ds_read_b128 v[168:171], v37 offset:0
    ds_read_b64_tr_b16 v[180:181], v41 offset:6144
    v_mfma_f32_32x32x16_bf16 v[68:83], v[148:151], v[160:163], v[68:83]
    ds_read_b64_tr_b16 v[182:183], v41 offset:7680
    ds_read_b128 v[172:175], v37 offset:4096
    s_add_u32 m0, s33, 57344
    s_nop 0
    buffer_load_dwordx4 v16, s[24:27], s30 offen  lds
    v_mfma_f32_32x32x16_bf16 v[116:131], v[152:155], v[160:163], v[116:131]
    ds_read_b64_tr_b16 v[184:185], v42 offset:6144
    ds_read_b64_tr_b16 v[186:187], v42 offset:7680
    v_mfma_f32_32x32x16_bf16 v[84:99], v[148:151], v[164:167], v[84:99]
    s_add_u32 m0, s33, 58368
    s_nop 0
    buffer_load_dwordx4 v17, s[24:27], s30 offen  lds
    v_mfma_f32_32x32x16_bf16 v[132:147], v[152:155], v[164:167], v[132:147]
    s_waitcnt lgkmcnt(0)
    v_mfma_f32_32x32x16_bf16 v[52:67], v[176:179], v[168:171], v[52:67]
    ds_read_b64_tr_b16 v[156:157], v40 offset:12288
    ds_read_b64_tr_b16 v[158:159], v40 offset:13824
    v_mfma_f32_32x32x16_bf16 v[100:115], v[176:179], v[172:175], v[100:115]
    ds_read_b128 v[148:151], v38 offset:0
    ds_read_b64_tr_b16 v[160:161], v41 offset:12288
    s_add_u32 m0, s33, 59392
    s_nop 0
    buffer_load_dwordx4 v18, s[24:27], s30 offen  lds
    v_mfma_f32_32x32x16_bf16 v[68:83], v[168:171], v[180:183], v[68:83]
    ds_read_b64_tr_b16 v[162:163], v41 offset:13824
    ds_read_b128 v[152:155], v38 offset:4096
    v_mfma_f32_32x32x16_bf16 v[116:131], v[172:175], v[180:183], v[116:131]
    ds_read_b64_tr_b16 v[164:165], v42 offset:12288
    ds_read_b64_tr_b16 v[166:167], v42 offset:13824
    v_mfma_f32_32x32x16_bf16 v[84:99], v[168:171], v[184:187], v[84:99]
    s_add_u32 m0, s33, 60416
    s_nop 0
    buffer_load_dwordx4 v19, s[24:27], s30 offen  lds
    v_mfma_f32_32x32x16_bf16 v[132:147], v[172:175], v[184:187], v[132:147]
    s_waitcnt lgkmcnt(0)
    v_mfma_f32_32x32x16_bf16 v[52:67], v[156:159], v[148:151], v[52:67]
    ds_read_b64_tr_b16 v[176:177], v40 offset:18432
    ds_read_b64_tr_b16 v[178:179], v40 offset:19968
    v_mfma_f32_32x32x16_bf16 v[100:115], v[156:159], v[152:155], v[100:115]
    ds_read_b128 v[168:171], v39 offset:0
    ds_read_b64_tr_b16 v[180:181], v41 offset:18432
    s_add_u32 m0, s33, 61440
    s_nop 0
    buffer_load_dwordx4 v20, s[24:27], s30 offen  lds
    v_mfma_f32_32x32x16_bf16 v[68:83], v[148:151], v[160:163], v[68:83]
    ds_read_b64_tr_b16 v[182:183], v41 offset:19968
    ds_read_b128 v[172:175], v39 offset:4096
    v_mfma_f32_32x32x16_bf16 v[116:131], v[152:155], v[160:163], v[116:131]
    ds_read_b64_tr_b16 v[184:185], v42 offset:18432
    ds_read_b64_tr_b16 v[186:187], v42 offset:19968
    v_mfma_f32_32x32x16_bf16 v[84:99], v[148:151], v[164:167], v[84:99]
    s_add_u32 m0, s33, 62464
    s_nop 0
    buffer_load_dwordx4 v21, s[24:27], s30 offen  lds
    s_add_u32 s34, s34, 1
    s_cmp_eq_u32 s34, 10
    s_cselect_b32 s35, 0xfffffb80, s38
    s_cselect_b32 s36, 0xffde4000, s37
    s_cselect_b32 s34, 0, s34
    s_add_u32 s28, s28, s35
    s_add_u32 s30, s30, s36
    v_mfma_f32_32x32x16_bf16 v[132:147], v[152:155], v[164:167], v[132:147]
    s_waitcnt vmcnt(10) lgkmcnt(0)
    s_barrier
    v_mfma_f32_32x32x16_bf16 v[52:67], v[176:179], v[168:171], v[52:67]
    ds_read_b64_tr_b16 v[156:157], v26 offset:0
    ds_read_b64_tr_b16 v[158:159], v26 offset:1536
    s_add_u32 m0, s32, 81920
    s_nop 0
    buffer_load_dwordx4 v6, s[20:23], s28 offen  lds
    v_mfma_f32_32x32x16_bf16 v[100:115], v[176:179], v[172:175], v[100:115]
    ds_read_b128 v[148:151], v22 offset:0
    ds_read_b64_tr_b16 v[160:161], v27 offset:0
    v_mfma_f32_32x32x16_bf16 v[68:83], v[168:171], v[180:183], v[68:83]
    ds_read_b64_tr_b16 v[162:163], v27 offset:1536
    ds_read_b128 v[152:155], v22 offset:4096
    s_add_u32 m0, s32, 82944
    s_add_u32 s29, s28, 10240
    buffer_load_dwordx4 v7, s[20:23], s29 offen  lds
    v_mfma_f32_32x32x16_bf16 v[116:131], v[172:175], v[180:183], v[116:131]
    ds_read_b64_tr_b16 v[164:165], v28 offset:0
    ds_read_b64_tr_b16 v[166:167], v28 offset:1536
    v_mfma_f32_32x32x16_bf16 v[84:99], v[168:171], v[184:187], v[84:99]
    s_add_u32 m0, s32, 83968
    s_add_u32 s29, s28, 20480
    buffer_load_dwordx4 v6, s[20:23], s29 offen  lds
    v_mfma_f32_32x32x16_bf16 v[132:147], v[172:175], v[184:187], v[132:147]
    s_waitcnt lgkmcnt(0)
    v_mfma_f32_32x32x16_bf16 v[52:67], v[156:159], v[148:151], v[52:67]
    ds_read_b64_tr_b16 v[176:177], v26 offset:6144
    ds_read_b64_tr_b16 v[178:179], v26 offset:7680
    s_add_u32 m0, s32, 84992
    s_add_u32 s29, s28, 30720
    buffer_load_dwordx4 v7, s[20:23], s29 offen  lds
    v_mfma_f32_32x32x16_bf16 v[100:115], v[156:159], v[152:155], v[100:115]
    ds_read_b128 v[168:171], v23 offset:0
    ds_read_b64_tr_b16 v[180:181], v27 offset:6144
    v_mfma_f32_32x32x16_bf16 v[68:83], v[148:151], v[160:163], v[68:83]
    ds_read_b64_tr_b16 v[182:183], v27 offset:7680
    ds_read_b128 v[172:175], v23 offset:4096
    s_add_u32 m0, s33, 98304
    s_nop 0
    buffer_load_dwordx4 v16, s[24:27], s30 offen  lds
    v_mfma_f32_32x32x16_bf16 v[116:131], v[152:155], v[160:163], v[116:131]
    ds_read_b64_tr_b16 v[184:185], v28 offset:6144
    ds_read_b64_tr_b16 v[186:187], v28 offset:7680
    v_mfma_f32_32x32x16_bf16 v[84:99], v[148:151], v[164:167], v[84:99]
    s_add_u32 m0, s33, 99328
    s_nop 0
    buffer_load_dwordx4 v17, s[24:27], s30 offen  lds
    v_mfma_f32_32x32x16_bf16 v[132:147], v[152:155], v[164:167], v[132:147]
    s_waitcnt lgkmcnt(0)
    v_mfma_f32_32x32x16_bf16 v[52:67], v[176:179], v[168:171], v[52:67]
    ds_read_b64_tr_b16 v[156:157], v26 offset:12288
    ds_read_b64_tr_b16 v[158:159], v26 offset:13824
    v_mfma_f32_32x32x16_bf16 v[100:115], v[176:179], v[172:175], v[100:115]
    ds_read_b128 v[148:151], v24 offset:0
    ds_read_b64_tr_b16 v[160:161], v27 offset:12288
    s_add_u32 m0, s33, 100352
    s_nop 0
    buffer_load_dwordx4 v18, s[24:27], s30 offen  lds
    v_mfma_f32_32x32x16_bf16 v[68:83], v[168:171], v[180:183], v[68:83]
    ds_read_b64_tr_b16 v[162:163], v27 offset:13824
    ds_read_b128 v[152:155], v24 offset:4096
    v_mfma_f32_32x32x16_bf16 v[116:131], v[172:175], v[180:183], v[116:131]
    ds_read_b64_tr_b16 v[164:165], v28 offset:12288
    ds_read_b64_tr_b16 v[166:167], v28 offset:13824
    v_mfma_f32_32x32x16_bf16 v[84:99], v[168:171], v[184:187], v[84:99]
    s_add_u32 m0, s33, 101376
    s_nop 0
    buffer_load_dwordx4 v19, s[24:27], s30 offen  lds
    v_mfma_f32_32x32x16_bf16 v[132:147], v[172:175], v[184:187], v[132:147]
    s_waitcnt lgkmcnt(0)
    v_mfma_f32_32x32x16_bf16 v[52:67], v[156:159], v[148:151], v[52:67]
    ds_read_b64_tr_b16 v[176:177], v26 offset:18432
    ds_read_b64_tr_b16 v[178:179], v26 offset:19968
    v_mfma_f32_32x32x16_bf16 v[100:115], v[156:159], v[152:155], v[100:115]
    ds_read_b128 v[168:171], v25 offset:0
    ds_read_b64_tr_b16 v[180:181], v27 offset:18432
    s_add_u32 m0, s33, 102400
    s_nop 0
    buffer_load_dwordx4 v20, s[24:27], s30 offen  lds
    v_mfma_f32_32x32x16_bf16 v[68:83], v[148:151], v[160:163], v[68:83]
    ds_read_b64_tr_b16 v[182:183], v27 offset:19968
    ds_read_b128 v[172:175], v25 offset:4096
    v_mfma_f32_32x32x16_bf16 v[116:131], v[152:155], v[160:163], v[116:131]
    ds_read_b64_tr_b16 v[184:185], v28 offset:18432
    ds_read_b64_tr_b16 v[186:187], v28 offset:19968
    v_mfma_f32_32x32x16_bf16 v[84:99], v[148:151], v[164:167], v[84:99]
    s_add_u32 m0, s33, 103424
    s_nop 0
    buffer_load_dwordx4 v21, s[24:27], s30 offen  lds
    s_add_u32 s34, s34, 1
    s_cmp_eq_u32 s34, 10
    s_cselect_b32 s35, 0xfffffb80, s38
    s_cselect_b32 s36, 0xffde4000, s37
    s_cselect_b32 s34, 0, s34
    s_add_u32 s28, s28, s35
    s_add_u32 s30, s30, s36
    v_mfma_f32_32x32x16_bf16 v[132:147], v[152:155], v[164:167], v[132:147]
    s_waitcnt vmcnt(10) lgkmcnt(0)
    s_barrier
    v_mfma_f32_32x32x16_bf16 v[52:67], v[176:179], v[168:171], v[52:67]
    ds_read_b64_tr_b16 v[156:157], v33 offset:0
    ds_read_b64_tr_b16 v[158:159], v33 offset:1536
    s_add_u32 m0, s32, 0
    s_nop 0
    buffer_load_dwordx4 v6, s[20:23], s28 offen  lds
    v_mfma_f32_32x32x16_bf16 v[100:115], v[176:179], v[172:175], v[100:115]
    ds_read_b128 v[148:151], v29 offset:0
    ds_read_b64_tr_b16 v[160:161], v34 offset:0
    v_mfma_f32_32x32x16_bf16 v[68:83], v[168:171], v[180:183], v[68:83]
    ds_read_b64_tr_b16 v[162:163], v34 offset:1536
    ds_read_b128 v[152:155], v29 offset:4096
    s_add_u32 m0, s32, 1024
    s_add_u32 s29, s28, 10240
    buffer_load_dwordx4 v7, s[20:23], s29 offen  lds
    v_mfma_f32_32x32x16_bf16 v[116:131], v[172:175], v[180:183], v[116:131]
    ds_read_b64_tr_b16 v[164:165], v35 offset:0
    ds_read_b64_tr_b16 v[166:167], v35 offset:1536
    v_mfma_f32_32x32x16_bf16 v[84:99], v[168:171], v[184:187], v[84:99]
    s_add_u32 m0, s32, 2048
    s_add_u32 s29, s28, 20480
    buffer_load_dwordx4 v6, s[20:23], s29 offen  lds
    v_mfma_f32_32x32x16_bf16 v[132:147], v[172:175], v[184:187], v[132:147]
    s_waitcnt lgkmcnt(0)
    v_mfma_f32_32x32x16_bf16 v[52:67], v[156:159], v[148:151], v[52:67]
    ds_read_b64_tr_b16 v[176:177], v33 offset:6144
    ds_read_b64_tr_b16 v[178:179], v33 offset:7680
    s_add_u32 m0, s32, 3072
    s_add_u32 s29, s28, 30720
    buffer_load_dwordx4 v7, s[20:23], s29 offen  lds
    v_mfma_f32_32x32x16_bf16 v[100:115], v[156:159], v[152:155], v[100:115]
    ds_read_b128 v[168:171], v30 offset:0
    ds_read_b64_tr_b16 v[180:181], v34 offset:6144
    v_mfma_f32_32x32x16_bf16 v[68:83], v[148:151], v[160:163], v[68:83]
    ds_read_b64_tr_b16 v[182:183], v34 offset:7680
    ds_read_b128 v[172:175], v30 offset:4096
    s_add_u32 m0, s33, 16384
    s_nop 0
    buffer_load_dwordx4 v16, s[24:27], s30 offen  lds
    v_mfma_f32_32x32x16_bf16 v[116:131], v[152:155], v[160:163], v[116:131]
    ds_read_b64_tr_b16 v[184:185], v35 offset:6144
    ds_read_b64_tr_b16 v[186:187], v35 offset:7680
    v_mfma_f32_32x32x16_bf16 v[84:99], v[148:151], v[164:167], v[84:99]
    s_add_u32 m0, s33, 17408
    s_nop 0
    buffer_load_dwordx4 v17, s[24:27], s30 offen  lds
    v_mfma_f32_32x32x16_bf16 v[132:147], v[152:155], v[164:167], v[132:147]
    s_waitcnt lgkmcnt(0)
    v_mfma_f32_32x32x16_bf16 v[52:67], v[176:179], v[168:171], v[52:67]
    ds_read_b64_tr_b16 v[156:157], v33 offset:12288
    ds_read_b64_tr_b16 v[158:159], v33 offset:13824
    v_mfma_f32_32x32x16_bf16 v[100:115], v[176:179], v[172:175], v[100:115]
    ds_read_b128 v[148:151], v31 offset:0
    ds_read_b64_tr_b16 v[160:161], v34 offset:12288
    s_add_u32 m0, s33, 18432
    s_nop 0
    buffer_load_dwordx4 v18, s[24:27], s30 offen  lds
    v_mfma_f32_32x32x16_bf16 v[68:83], v[168:171], v[180:183], v[68:83]
    ds_read_b64_tr_b16 v[162:163], v34 offset:13824
    ds_read_b128 v[152:155], v31 offset:4096
    v_mfma_f32_32x32x16_bf16 v[116:131], v[172:175], v[180:183], v[116:131]
    ds_read_b64_tr_b16 v[164:165], v35 offset:12288
    ds_read_b64_tr_b16 v[166:167], v35 offset:13824
    v_mfma_f32_32x32x16_bf16 v[84:99], v[168:171], v[184:187], v[84:99]
    s_add_u32 m0, s33, 19456
    s_nop 0
    buffer_load_dwordx4 v19, s[24:27], s30 offen  lds
    v_mfma_f32_32x32x16_bf16 v[132:147], v[172:175], v[184:187], v[132:147]
    s_waitcnt lgkmcnt(0)
    v_mfma_f32_32x32x16_bf16 v[52:67], v[156:159], v[148:151], v[52:67]
    ds_read_b64_tr_b16 v[176:177], v33 offset:18432
    ds_read_b64_tr_b16 v[178:179], v33 offset:19968
    v_mfma_f32_32x32x16_bf16 v[100:115], v[156:159], v[152:155], v[100:115]
    ds_read_b128 v[168:171], v32 offset:0
    ds_read_b64_tr_b16 v[180:181], v34 offset:18432
    s_add_u32 m0, s33, 20480
    s_nop 0
    buffer_load_dwordx4 v20, s[24:27], s30 offen  lds
    v_mfma_f32_32x32x16_bf16 v[68:83], v[148:151], v[160:163], v[68:83]
    ds_read_b64_tr_b16 v[182:183], v34 offset:19968
    ds_read_b128 v[172:175], v32 offset:4096
    v_mfma_f32_32x32x16_bf16 v[116:131], v[152:155], v[160:163], v[116:131]
    ds_read_b64_tr_b16 v[184:185], v35 offset:18432
    ds_read_b64_tr_b16 v[186:187], v35 offset:19968
    v_mfma_f32_32x32x16_bf16 v[84:99], v[148:151], v[164:167], v[84:99]
    s_add_u32 m0, s33, 21504
    s_nop 0
    buffer_load_dwordx4 v21, s[24:27], s30 offen  lds
    s_add_u32 s34, s34, 1
    s_cmp_eq_u32 s34, 10
    s_cselect_b32 s35, 0xfffffb80, s38
    s_cselect_b32 s36, 0xffde4000, s37
    s_cselect_b32 s34, 0, s34
    s_add_u32 s28, s28, s35
    s_add_u32 s30, s30, s36
    v_mfma_f32_32x32x16_bf16 v[132:147], v[152:155], v[164:167], v[132:147]
    s_waitcnt vmcnt(10) lgkmcnt(0)
    s_barrier
    v_mfma_f32_32x32x16_bf16 v[52:67], v[176:179], v[168:171], v[52:67]
    ds_read_b64_tr_b16 v[156:157], v40 offset:0
    ds_read_b64_tr_b16 v[158:159], v40 offset:1536
    v_mfma_f32_32x32x16_bf16 v[100:115], v[176:179], v[172:175], v[100:115]
    ds_read_b128 v[148:151], v36 offset:0
    ds_read_b64_tr_b16 v[160:161], v41 offset:0
    v_mfma_f32_32x32x16_bf16 v[68:83], v[168:171], v[180:183], v[68:83]
    ds_read_b64_tr_b16 v[162:163], v41 offset:1536
    ds_read_b128 v[152:155], v36 offset:4096
    v_mfma_f32_32x32x16_bf16 v[116:131], v[172:175], v[180:183], v[116:131]
    ds_read_b64_tr_b16 v[164:165], v42 offset:0
    ds_read_b64_tr_b16 v[166:167], v42 offset:1536
    v_mfma_f32_32x32x16_bf16 v[84:99], v[168:171], v[184:187], v[84:99]
    v_mfma_f32_32x32x16_bf16 v[132:147], v[172:175], v[184:187], v[132:147]
    s_waitcnt lgkmcnt(0)
    v_mfma_f32_32x32x16_bf16 v[52:67], v[156:159], v[148:151], v[52:67]
    ds_read_b64_tr_b16 v[176:177], v40 offset:6144
    ds_read_b64_tr_b16 v[178:179], v40 offset:7680
    v_mfma_f32_32x32x16_bf16 v[100:115], v[156:159], v[152:155], v[100:115]
    ds_read_b128 v[168:171], v37 offset:0
    ds_read_b64_tr_b16 v[180:181], v41 offset:6144
    v_mfma_f32_32x32x16_bf16 v[68:83], v[148:151], v[160:163], v[68:83]
    ds_read_b64_tr_b16 v[182:183], v41 offset:7680
    ds_read_b128 v[172:175], v37 offset:4096
    v_mfma_f32_32x32x16_bf16 v[116:131], v[152:155], v[160:163], v[116:131]
    ds_read_b64_tr_b16 v[184:185], v42 offset:6144
    ds_read_b64_tr_b16 v[186:187], v42 offset:7680
    v_mfma_f32_32x32x16_bf16 v[84:99], v[148:151], v[164:167], v[84:99]
    v_mfma_f32_32x32x16_bf16 v[132:147], v[152:155], v[164:167], v[132:147]
    s_waitcnt lgkmcnt(0)
    v_mfma_f32_32x32x16_bf16 v[52:67], v[176:179], v[168:171], v[52:67]
    ds_read_b64_tr_b16 v[156:157], v40 offset:12288
    ds_read_b64_tr_b16 v[158:159], v40 offset:13824
    v_mfma_f32_32x32x16_bf16 v[100:115], v[176:179], v[172:175], v[100:115]
    ds_read_b128 v[148:151], v38 offset:0
    ds_read_b64_tr_b16 v[160:161], v41 offset:12288
    v_mfma_f32_32x32x16_bf16 v[68:83], v[168:171], v[180:183], v[68:83]
    ds_read_b64_tr_b16 v[162:163], v41 offset:13824
    ds_read_b128 v[152:155], v38 offset:4096
    v_mfma_f32_32x32x16_bf16 v[116:131], v[172:175], v[180:183], v[116:131]
    ds_read_b64_tr_b16 v[164:165], v42 offset:12288
    ds_read_b64_tr_b16 v[166:167], v42 offset:13824
    v_mfma_f32_32x32x16_bf16 v[84:99], v[168:171], v[184:187], v[84:99]
    v_mfma_f32_32x32x16_bf16 v[132:147], v[172:175], v[184:187], v[132:147]
    s_waitcnt lgkmcnt(0)
    v_mfma_f32_32x32x16_bf16 v[52:67], v[156:159], v[148:151], v[52:67]
    ds_read_b64_tr_b16 v[176:177], v40 offset:18432
    ds_read_b64_tr_b16 v[178:179], v40 offset:19968
    v_mfma_f32_32x32x16_bf16 v[100:115], v[156:159], v[152:155], v[100:115]
    ds_read_b128 v[168:171], v39 offset:0
    ds_read_b64_tr_b16 v[180:181], v41 offset:18432
    v_mfma_f32_32x32x16_bf16 v[68:83], v[148:151], v[160:163], v[68:83]
    ds_read_b64_tr_b16 v[182:183], v41 offset:19968
    ds_read_b128 v[172:175], v39 offset:4096
    v_mfma_f32_32x32x16_bf16 v[116:131], v[152:155], v[160:163], v[116:131]
    ds_read_b64_tr_b16 v[184:185], v42 offset:18432
    ds_read_b64_tr_b16 v[186:187], v42 offset:19968
    v_mfma_f32_32x32x16_bf16 v[84:99], v[148:151], v[164:167], v[84:99]
    v_mfma_f32_32x32x16_bf16 v[132:147], v[152:155], v[164:167], v[132:147]
    s_waitcnt vmcnt(0) lgkmcnt(0)
    s_barrier
    v_mfma_f32_32x32x16_bf16 v[52:67], v[176:179], v[168:171], v[52:67]
    ds_read_b64_tr_b16 v[156:157], v26 offset:0
    ds_read_b64_tr_b16 v[158:159], v26 offset:1536
    v_mfma_f32_32x32x16_bf16 v[100:115], v[176:179], v[172:175], v[100:115]
    ds_read_b128 v[148:151], v22 offset:0
    ds_read_b64_tr_b16 v[160:161], v27 offset:0
    v_mfma_f32_32x32x16_bf16 v[68:83], v[168:171], v[180:183], v[68:83]
    ds_read_b64_tr_b16 v[162:163], v27 offset:1536
    ds_read_b128 v[152:155], v22 offset:4096
    v_mfma_f32_32x32x16_bf16 v[116:131], v[172:175], v[180:183], v[116:131]
    ds_read_b64_tr_b16 v[164:165], v28 offset:0
    ds_read_b64_tr_b16 v[166:167], v28 offset:1536
    v_mfma_f32_32x32x16_bf16 v[84:99], v[168:171], v[184:187], v[84:99]
    v_mfma_f32_32x32x16_bf16 v[132:147], v[172:175], v[184:187], v[132:147]
    s_waitcnt lgkmcnt(0)
    v_mfma_f32_32x32x16_bf16 v[52:67], v[156:159], v[148:151], v[52:67]
    ds_read_b64_tr_b16 v[176:177], v26 offset:6144
    ds_read_b64_tr_b16 v[178:179], v26 offset:7680
    v_mfma_f32_32x32x16_bf16 v[100:115], v[156:159], v[152:155], v[100:115]
    ds_read_b128 v[168:171], v23 offset:0
    ds_read_b64_tr_b16 v[180:181], v27 offset:6144
    v_mfma_f32_32x32x16_bf16 v[68:83], v[148:151], v[160:163], v[68:83]
    ds_read_b64_tr_b16 v[182:183], v27 offset:7680
    ds_read_b128 v[172:175], v23 offset:4096
    v_mfma_f32_32x32x16_bf16 v[116:131], v[152:155], v[160:163], v[116:131]
    ds_read_b64_tr_b16 v[184:185], v28 offset:6144
    ds_read_b64_tr_b16 v[186:187], v28 offset:7680
    v_mfma_f32_32x32x16_bf16 v[84:99], v[148:151], v[164:167], v[84:99]
    v_mfma_f32_32x32x16_bf16 v[132:147], v[152:155], v[164:167], v[132:147]
    s_waitcnt lgkmcnt(0)
    v_mfma_f32_32x32x16_bf16 v[52:67], v[176:179], v[168:171], v[52:67]
    ds_read_b64_tr_b16 v[156:157], v26 offset:12288
    ds_read_b64_tr_b16 v[158:159], v26 offset:13824
    v_mfma_f32_32x32x16_bf16 v[100:115], v[176:179], v[172:175], v[100:115]
    ds_read_b128 v[148:151], v24 offset:0
    ds_read_b64_tr_b16 v[160:161], v27 offset:12288
    v_mfma_f32_32x32x16_bf16 v[68:83], v[168:171], v[180:183], v[68:83]
    ds_read_b64_tr_b16 v[162:163], v27 offset:13824
    ds_read_b128 v[152:155], v24 offset:4096
    v_mfma_f32_32x32x16_bf16 v[116:131], v[172:175], v[180:183], v[116:131]
    ds_read_b64_tr_b16 v[164:165], v28 offset:12288
    ds_read_b64_tr_b16 v[166:167], v28 offset:13824
    v_mfma_f32_32x32x16_bf16 v[84:99], v[168:171], v[184:187], v[84:99]
    v_mfma_f32_32x32x16_bf16 v[132:147], v[172:175], v[184:187], v[132:147]
    s_waitcnt lgkmcnt(0)
    v_mfma_f32_32x32x16_bf16 v[52:67], v[156:159], v[148:151], v[52:67]
    ds_read_b64_tr_b16 v[176:177], v26 offset:18432
    ds_read_b64_tr_b16 v[178:179], v26 offset:19968
    v_mfma_f32_32x32x16_bf16 v[100:115], v[156:159], v[152:155], v[100:115]
    ds_read_b128 v[168:171], v25 offset:0
    ds_read_b64_tr_b16 v[180:181], v27 offset:18432
    v_mfma_f32_32x32x16_bf16 v[68:83], v[148:151], v[160:163], v[68:83]
    ds_read_b64_tr_b16 v[182:183], v27 offset:19968
    ds_read_b128 v[172:175], v25 offset:4096
    v_mfma_f32_32x32x16_bf16 v[116:131], v[152:155], v[160:163], v[116:131]
    ds_read_b64_tr_b16 v[184:185], v28 offset:18432
    ds_read_b64_tr_b16 v[186:187], v28 offset:19968
    v_mfma_f32_32x32x16_bf16 v[84:99], v[148:151], v[164:167], v[84:99]
    v_mfma_f32_32x32x16_bf16 v[132:147], v[152:155], v[164:167], v[132:147]
    s_waitcnt lgkmcnt(0)
    v_mfma_f32_32x32x16_bf16 v[52:67], v[176:179], v[168:171], v[52:67]
    v_mfma_f32_32x32x16_bf16 v[100:115], v[176:179], v[172:175], v[100:115]
    v_mfma_f32_32x32x16_bf16 v[68:83], v[168:171], v[180:183], v[68:83]
    v_mfma_f32_32x32x16_bf16 v[116:131], v[172:175], v[180:183], v[116:131]
    v_mfma_f32_32x32x16_bf16 v[84:99], v[168:171], v[184:187], v[84:99]
    v_mfma_f32_32x32x16_bf16 v[132:147], v[172:175], v[184:187], v[132:147]
    s_nop 15
    s_add_u32 s40, s8, 0x280000
    s_addc_u32 s41, s9, 0
    s_mov_b32 s42, 0x500000
    s_mov_b32 s43, 0x00020000
    v_lshlrev_b32 v21, 14, v9
    v_lshl_add_u32 v21, v8, 3, v21
    s_lshl_b32 s48, s15, 9
    v_add_u32 v21, s48, v21
    s_lshl_b32 s48, s39, 17
    s_lshl_b32 s49, s10, 10
    s_add_u32 s48, s48, s49
    s_add_u32 s44, s8, 0x780000
    s_addc_u32 s45, s9, 0
    s_mov_b32 s46, 0x280000
    s_mov_b32 s47, 0x00020000
    v_lshlrev_b32 v20, 5, v8
    v_lshl_add_u32 v20, v9, 4, v20
    s_mul_i32 s50, s15, 81920
    v_add_u32 v20, s50, v20
    s_mul_i32 s50, s10, 163840
    s_lshl_b32 s51, s39, 10
    s_add_u32 s50, s50, s51
    s_sub_u32 s50, s50, 40960
    s_add_u32 s49, s48, 0
    v_cvt_pk_bf16_f32 v148, v52, v53
    v_cvt_pk_bf16_f32 v149, v54, v55
    buffer_store_dwordx2 v[148:149], v21, s[40:43], s49 offen offset:0 sc1
    v_cvt_pk_bf16_f32 v152, v100, v101
    v_cvt_pk_bf16_f32 v153, v102, v103
    buffer_store_dwordx2 v[152:153], v21, s[40:43], s49 offen offset:256 sc1
    s_add_u32 s49, s48, 32768
    v_cvt_pk_bf16_f32 v156, v56, v57
    v_cvt_pk_bf16_f32 v157, v58, v59
    buffer_store_dwordx2 v[156:157], v21, s[40:43], s49 offen offset:0 sc1
    v_cvt_pk_bf16_f32 v160, v104, v105
    v_cvt_pk_bf16_f32 v161, v106, v107
    buffer_store_dwordx2 v[160:161], v21, s[40:43], s49 offen offset:256 sc1
    s_add_u32 s49, s48, 65536
    v_cvt_pk_bf16_f32 v164, v60, v61
    v_cvt_pk_bf16_f32 v165, v62, v63
    buffer_store_dwordx2 v[164:165], v21, s[40:43], s49 offen offset:0 sc1
    v_cvt_pk_bf16_f32 v168, v108, v109
    v_cvt_pk_bf16_f32 v169, v110, v111
    buffer_store_dwordx2 v[168:169], v21, s[40:43], s49 offen offset:256 sc1
    s_add_u32 s49, s48, 98304
    v_cvt_pk_bf16_f32 v172, v64, v65
    v_cvt_pk_bf16_f32 v173, v66, v67
    buffer_store_dwordx2 v[172:173], v21, s[40:43], s49 offen offset:0 sc1
    v_cvt_pk_bf16_f32 v176, v112, v113
    v_cvt_pk_bf16_f32 v177, v114, v115
    buffer_store_dwordx2 v[176:177], v21, s[40:43], s49 offen offset:256 sc1
    s_add_u32 s51, s50, 1024
    v_cvt_pk_bf16_f32 v148, v68, v69
    v_cvt_pk_bf16_f32 v149, v70, v71
    v_cvt_pk_bf16_f32 v150, v72, v73
    v_cvt_pk_bf16_f32 v151, v74, v75
    buffer_store_dwordx4 v[148:151], v20, s[44:47], s51 offen sc1
    s_add_u32 s51, s50, 21504
    v_cvt_pk_bf16_f32 v152, v76, v77
    v_cvt_pk_bf16_f32 v153, v78, v79
    v_cvt_pk_bf16_f32 v154, v80, v81
    v_cvt_pk_bf16_f32 v155, v82, v83
    buffer_store_dwordx4 v[152:155], v20, s[44:47], s51 offen sc1
    s_add_u32 s51, s50, 41984
    v_cvt_pk_bf16_f32 v156, v116, v117
    v_cvt_pk_bf16_f32 v157, v118, v119
    v_cvt_pk_bf16_f32 v158, v120, v121
    v_cvt_pk_bf16_f32 v159, v122, v123
    buffer_store_dwordx4 v[156:159], v20, s[44:47], s51 offen sc1
    s_add_u32 s51, s50, 62464
    v_cvt_pk_bf16_f32 v160, v124, v125
    v_cvt_pk_bf16_f32 v161, v126, v127
    v_cvt_pk_bf16_f32 v162, v128, v129
    v_cvt_pk_bf16_f32 v163, v130, v131
    buffer_store_dwordx4 v[160:163], v20, s[44:47], s51 offen sc1
    s_add_u32 s51, s50, 2048
    v_cvt_pk_bf16_f32 v164, v84, v85
    v_cvt_pk_bf16_f32 v165, v86, v87
    v_cvt_pk_bf16_f32 v166, v88, v89
    v_cvt_pk_bf16_f32 v167, v90, v91
    buffer_store_dwordx4 v[164:167], v20, s[44:47], s51 offen sc1
    s_add_u32 s51, s50, 22528
    v_cvt_pk_bf16_f32 v168, v92, v93
    v_cvt_pk_bf16_f32 v169, v94, v95
    v_cvt_pk_bf16_f32 v170, v96, v97
    v_cvt_pk_bf16_f32 v171, v98, v99
    buffer_store_dwordx4 v[168:171], v20, s[44:47], s51 offen sc1
    s_add_u32 s51, s50, 43008
    v_cvt_pk_bf16_f32 v172, v132, v133
    v_cvt_pk_bf16_f32 v173, v134, v135
    v_cvt_pk_bf16_f32 v174, v136, v137
    v_cvt_pk_bf16_f32 v175, v138, v139
    buffer_store_dwordx4 v[172:175], v20, s[44:47], s51 offen sc1
    s_add_u32 s51, s50, 63488
    v_cvt_pk_bf16_f32 v176, v140, v141
    v_cvt_pk_bf16_f32 v177, v142, v143
    v_cvt_pk_bf16_f32 v178, v144, v145
    v_cvt_pk_bf16_f32 v179, v146, v147
    buffer_store_dwordx4 v[176:179], v20, s[44:47], s51 offen sc1
    s_endpgm
.aux_2:
    s_cmp_ge_u32 s2, 256
    s_cbranch_scc1 .end_1
    v_lshrrev_b32 v1, 6, v0
    s_sub_u32 s3, s2, 160
    s_lshl_b32 s3, s3, 2
    v_readfirstlane_b32 s19, v1
    s_nop 3
    s_add_u32 s3, s3, s19
    s_load_dwordx4 s[4:7], s[0:1], 8
    s_load_dwordx2 s[8:9], s[0:1], 24
    s_load_dwordx2 s[10:11], s[0:1], 88
    v_and_b32 v1, 63, v0
    v_and_b32 v2, 7, v1
    v_lshrrev_b32 v3, 3, v1
    v_mul_u32_u24 v3, 4, v3
    v_mov_b32 v9, 0x80000000
    s_waitcnt lgkmcnt(0)
    s_mov_b32 s20, s4
    s_mov_b32 s21, s5
    s_mov_b32 s22, 0x280000
    s_mov_b32 s23, 0x00020000
    s_mov_b32 s24, s6
    s_mov_b32 s25, s7
    s_mov_b32 s26, 0x280000
    s_mov_b32 s27, 0x00020000
    s_mov_b32 s28, s8
    s_mov_b32 s29, s9
    s_mov_b32 s30, 0x1400
    s_mov_b32 s31, 0x00020000
    s_mov_b32 s32, s10
    s_mov_b32 s33, s11
    s_mov_b32 s34, 0x280000
    s_mov_b32 s35, 0x00020000
    s_add_u32 s12, s3, 0
    s_mul_hi_u32 s13, s12, 0x1999999a
    s_mul_i32 s14, s13, 10
    s_sub_u32 s14, s12, s14
    s_mul_i32 s13, s13, 32
    v_add_u32 v4, s13, v3
    s_lshl_b32 s15, s14, 6
    v_lshl_add_u32 v5, v2, 3, s15
    v_mul_u32_u24 v6, 1280, v4
    v_lshl_add_u32 v6, v5, 1, v6
    v_subrev_u32 v8, 3840, v6
    v_cmp_eq_u32 vcc, 0, v4
    v_lshlrev_b32 v7, 3, v5
    v_lshlrev_b32 v10, 12, v5
    v_cndmask_b32 v8, v8, v9, vcc
    v_sub_u32 v4, 2044, v4
    v_lshl_add_u32 v10, v4, 1, v10
    buffer_load_dwordx4 v[64:67], v8, s[20:23], 0 offen offset:0
    buffer_load_dwordx4 v[68:71], v8, s[20:23], 0 offen offset:1280
    buffer_load_dwordx4 v[72:75], v8, s[20:23], 0 offen offset:2560
    buffer_load_dwordx4 v[76:79], v6, s[20:23], 0 offen offset:0
    buffer_load_dwordx4 v[80:83], v6, s[20:23], 0 offen offset:1280
    buffer_load_dwordx4 v[84:87], v6, s[20:23], 0 offen offset:2560
    buffer_load_dwordx4 v[88:91], v6, s[20:23], 0 offen offset:3840
    buffer_load_dwordx4 v[108:111], v7, s[28:31], 0 offen offset:0
    buffer_load_dwordx4 v[112:115], v7, s[28:31], 0 offen offset:16
    buffer_load_dwordx4 v[116:119], v7, s[28:31], 0 offen offset:32
    buffer_load_dwordx4 v[120:123], v7, s[28:31], 0 offen offset:48
    buffer_load_dwordx4 v[92:95], v6, s[24:27], 0 offen offset:0
    buffer_load_dwordx4 v[96:99], v6, s[24:27], 0 offen offset:1280
    buffer_load_dwordx4 v[100:103], v6, s[24:27], 0 offen offset:2560
    buffer_load_dwordx4 v[104:107], v6, s[24:27], 0 offen offset:3840
    s_add_u32 s12, s3, 384
    s_mul_hi_u32 s13, s12, 0x1999999a
    s_mul_i32 s14, s13, 10
    s_sub_u32 s14, s12, s14
    s_mul_i32 s13, s13, 32
    v_add_u32 v4, s13, v3
    s_lshl_b32 s15, s14, 6
    v_lshl_add_u32 v5, v2, 3, s15
    v_mul_u32_u24 v6, 1280, v4
    v_lshl_add_u32 v6, v5, 1, v6
    v_subrev_u32 v8, 3840, v6
    v_cmp_eq_u32 vcc, 0, v4
    v_lshlrev_b32 v7, 3, v5
    v_lshlrev_b32 v11, 12, v5
    v_cndmask_b32 v8, v8, v9, vcc
    v_sub_u32 v4, 2044, v4
    v_lshl_add_u32 v11, v4, 1, v11
    buffer_load_dwordx4 v[124:127], v8, s[20:23], 0 offen offset:0
    buffer_load_dwordx4 v[128:131], v8, s[20:23], 0 offen offset:1280
    buffer_load_dwordx4 v[132:135], v8, s[20:23], 0 offen offset:2560
    buffer_load_dwordx4 v[136:139], v6, s[20:23], 0 offen offset:0
    buffer_load_dwordx4 v[140:143], v6, s[20:23], 0 offen offset:1280
    buffer_load_dwordx4 v[144:147], v6, s[20:23], 0 offen offset:2560
    buffer_load_dwordx4 v[148:151], v6, s[20:23], 0 offen offset:3840
    buffer_load_dwordx4 v[168:171], v7, s[28:31], 0 offen offset:0
    buffer_load_dwordx4 v[172:175], v7, s[28:31], 0 offen offset:16
    buffer_load_dwordx4 v[176:179], v7, s[28:31], 0 offen offset:32
    buffer_load_dwordx4 v[180:183], v7, s[28:31], 0 offen offset:48
    buffer_load_dwordx4 v[152:155], v6, s[24:27], 0 offen offset:0
    buffer_load_dwordx4 v[156:159], v6, s[24:27], 0 offen offset:1280
    buffer_load_dwordx4 v[160:163], v6, s[24:27], 0 offen offset:2560
    buffer_load_dwordx4 v[164:167], v6, s[24:27], 0 offen offset:3840
    s_mov_b32 s17, 0xffff0000
    s_waitcnt vmcnt(15)
    v_lshlrev_b32 v16, 16, v64
    v_lshlrev_b32 v17, 16, v68
    v_lshlrev_b32 v18, 16, v72
    v_lshlrev_b32 v19, 16, v76
    v_lshlrev_b32 v20, 16, v80
    v_lshlrev_b32 v21, 16, v84
    v_lshlrev_b32 v22, 16, v88
    v_lshlrev_b32 v28, 16, v108
    v_and_b32 v29, s17, v108
    v_lshlrev_b32 v30, 16, v109
    v_and_b32 v31, s17, v109
    v_mul_f32 v32, v16, v31
    v_mul_f32 v33, v17, v30
    v_mul_f32 v34, v18, v29
    v_mul_f32 v35, v19, v28
    v_lshlrev_b32 v36, 16, v92
    v_mul_f32 v38, v17, v31
    v_mul_f32 v39, v18, v30
    v_mul_f32 v40, v19, v29
    v_mul_f32 v41, v20, v28
    v_lshlrev_b32 v42, 16, v96
    v_cvt_pk_bf16_f32 v32, 0, v32
    v_cvt_pk_bf16_f32 v33, 0, v33
    v_cvt_pk_bf16_f32 v34, 0, v34
    v_cvt_pk_bf16_f32 v35, 0, v35
    v_cvt_pk_bf16_f32 v38, 0, v38
    v_cvt_pk_bf16_f32 v39, 0, v39
    v_cvt_pk_bf16_f32 v40, 0, v40
    v_cvt_pk_bf16_f32 v41, 0, v41
    v_add_f32 v32, v32, v33
    v_add_f32 v38, v38, v39
    v_cvt_pk_bf16_f32 v32, 0, v32
    v_cvt_pk_bf16_f32 v38, 0, v38
    v_add_f32 v32, v32, v34
    v_add_f32 v38, v38, v40
    v_cvt_pk_bf16_f32 v32, 0, v32
    v_cvt_pk_bf16_f32 v38, 0, v38
    v_add_f32 v32, v32, v35
    v_add_f32 v38, v38, v41
    v_cvt_pk_bf16_f32 v32, 0, v32
    v_cvt_pk_bf16_f32 v38, 0, v38
    v_mul_f32 v44, v32, v36
    v_mul_f32 v45, v38, v42
    v_mul_f32 v32, v18, v31
    v_mul_f32 v33, v19, v30
    v_mul_f32 v34, v20, v29
    v_mul_f32 v35, v21, v28
    v_lshlrev_b32 v36, 16, v100
    v_mul_f32 v38, v19, v31
    v_mul_f32 v39, v20, v30
    v_mul_f32 v40, v21, v29
    v_mul_f32 v41, v22, v28
    v_lshlrev_b32 v42, 16, v104
    v_cvt_pk_bf16_f32 v32, 0, v32
    v_cvt_pk_bf16_f32 v33, 0, v33
    v_cvt_pk_bf16_f32 v34, 0, v34
    v_cvt_pk_bf16_f32 v35, 0, v35
    v_cvt_pk_bf16_f32 v38, 0, v38
    v_cvt_pk_bf16_f32 v39, 0, v39
    v_cvt_pk_bf16_f32 v40, 0, v40
    v_cvt_pk_bf16_f32 v41, 0, v41
    v_add_f32 v32, v32, v33
    v_add_f32 v38, v38, v39
    v_cvt_pk_bf16_f32 v32, 0, v32
    v_cvt_pk_bf16_f32 v38, 0, v38
    v_add_f32 v32, v32, v34
    v_add_f32 v38, v38, v40
    v_cvt_pk_bf16_f32 v32, 0, v32
    v_cvt_pk_bf16_f32 v38, 0, v38
    v_add_f32 v32, v32, v35
    v_add_f32 v38, v38, v41
    v_cvt_pk_bf16_f32 v32, 0, v32
    v_cvt_pk_bf16_f32 v38, 0, v38
    v_mul_f32 v46, v32, v36
    v_mul_f32 v47, v38, v42
    v_cvt_pk_bf16_f32 v52, v47, v46
    v_cvt_pk_bf16_f32 v53, v45, v44
    s_mov_b32 s18, 0
    buffer_store_dwordx2 v[52:53], v10, s[32:35], s18 offen sc1
    v_and_b32 v16, s17, v64
    v_and_b32 v17, s17, v68
    v_and_b32 v18, s17, v72
    v_and_b32 v19, s17, v76
    v_and_b32 v20, s17, v80
    v_and_b32 v21, s17, v84
    v_and_b32 v22, s17, v88
    v_lshlrev_b32 v28, 16, v110
    v_and_b32 v29, s17, v110
    v_lshlrev_b32 v30, 16, v111
    v_and_b32 v31, s17, v111
    v_mul_f32 v32, v16, v31
    v_mul_f32 v33, v17, v30
    v_mul_f32 v34, v18, v29
    v_mul_f32 v35, v19, v28
    v_and_b32 v36, s17, v92
    v_mul_f32 v38, v17, v31
    v_mul_f32 v39, v18, v30
    v_mul_f32 v40, v19, v29
    v_mul_f32 v41, v20, v28
    v_and_b32 v42, s17, v96
    v_cvt_pk_bf16_f32 v32, 0, v32
    v_cvt_pk_bf16_f32 v33, 0, v33
    v_cvt_pk_bf16_f32 v34, 0, v34
    v_cvt_pk_bf16_f32 v35, 0, v35
    v_cvt_pk_bf16_f32 v38, 0, v38
    v_cvt_pk_bf16_f32 v39, 0, v39
    v_cvt_pk_bf16_f32 v40, 0, v40
    v_cvt_pk_bf16_f32 v41, 0, v41
    v_add_f32 v32, v32, v33
    v_add_f32 v38, v38, v39
    v_cvt_pk_bf16_f32 v32, 0, v32
    v_cvt_pk_bf16_f32 v38, 0, v38
    v_add_f32 v32, v32, v34
    v_add_f32 v38, v38, v40
    v_cvt_pk_bf16_f32 v32, 0, v32
    v_cvt_pk_bf16_f32 v38, 0, v38
    v_add_f32 v32, v32, v35
    v_add_f32 v38, v38, v41
    v_cvt_pk_bf16_f32 v32, 0, v32
    v_cvt_pk_bf16_f32 v38, 0, v38
    v_mul_f32 v44, v32, v36
    v_mul_f32 v45, v38, v42
    v_mul_f32 v32, v18, v31
    v_mul_f32 v33, v19, v30
    v_mul_f32 v34, v20, v29
    v_mul_f32 v35, v21, v28
    v_and_b32 v36, s17, v100
    v_mul_f32 v38, v19, v31
    v_mul_f32 v39, v20, v30
    v_mul_f32 v40, v21, v29
    v_mul_f32 v41, v22, v28
    v_and_b32 v42, s17, v104
    v_cvt_pk_bf16_f32 v32, 0, v32
    v_cvt_pk_bf16_f32 v33, 0, v33
    v_cvt_pk_bf16_f32 v34, 0, v34
    v_cvt_pk_bf16_f32 v35, 0, v35
    v_cvt_pk_bf16_f32 v38, 0, v38
    v_cvt_pk_bf16_f32 v39, 0, v39
    v_cvt_pk_bf16_f32 v40, 0, v40
    v_cvt_pk_bf16_f32 v41, 0, v41
    v_add_f32 v32, v32, v33
    v_add_f32 v38, v38, v39
    v_cvt_pk_bf16_f32 v32, 0, v32
    v_cvt_pk_bf16_f32 v38, 0, v38
    v_add_f32 v32, v32, v34
    v_add_f32 v38, v38, v40
    v_cvt_pk_bf16_f32 v32, 0, v32
    v_cvt_pk_bf16_f32 v38, 0, v38
    v_add_f32 v32, v32, v35
    v_add_f32 v38, v38, v41
    v_cvt_pk_bf16_f32 v32, 0, v32
    v_cvt_pk_bf16_f32 v38, 0, v38
    v_mul_f32 v46, v32, v36
    v_mul_f32 v47, v38, v42
    v_cvt_pk_bf16_f32 v54, v47, v46
    v_cvt_pk_bf16_f32 v55, v45, v44
    s_mov_b32 s18, 4096
    buffer_store_dwordx2 v[54:55], v10, s[32:35], s18 offen sc1
    v_lshlrev_b32 v16, 16, v65
    v_lshlrev_b32 v17, 16, v69
    v_lshlrev_b32 v18, 16, v73
    v_lshlrev_b32 v19, 16, v77
    v_lshlrev_b32 v20, 16, v81
    v_lshlrev_b32 v21, 16, v85
    v_lshlrev_b32 v22, 16, v89
    v_lshlrev_b32 v28, 16, v112
    v_and_b32 v29, s17, v112
    v_lshlrev_b32 v30, 16, v113
    v_and_b32 v31, s17, v113
    v_mul_f32 v32, v16, v31
    v_mul_f32 v33, v17, v30
    v_mul_f32 v34, v18, v29
    v_mul_f32 v35, v19, v28
    v_lshlrev_b32 v36, 16, v93
    v_mul_f32 v38, v17, v31
    v_mul_f32 v39, v18, v30
    v_mul_f32 v40, v19, v29
    v_mul_f32 v41, v20, v28
    v_lshlrev_b32 v42, 16, v97
    v_cvt_pk_bf16_f32 v32, 0, v32
    v_cvt_pk_bf16_f32 v33, 0, v33
    v_cvt_pk_bf16_f32 v34, 0, v34
    v_cvt_pk_bf16_f32 v35, 0, v35
    v_cvt_pk_bf16_f32 v38, 0, v38
    v_cvt_pk_bf16_f32 v39, 0, v39
    v_cvt_pk_bf16_f32 v40, 0, v40
    v_cvt_pk_bf16_f32 v41, 0, v41
    v_add_f32 v32, v32, v33
    v_add_f32 v38, v38, v39
    v_cvt_pk_bf16_f32 v32, 0, v32
    v_cvt_pk_bf16_f32 v38, 0, v38
    v_add_f32 v32, v32, v34
    v_add_f32 v38, v38, v40
    v_cvt_pk_bf16_f32 v32, 0, v32
    v_cvt_pk_bf16_f32 v38, 0, v38
    v_add_f32 v32, v32, v35
    v_add_f32 v38, v38, v41
    v_cvt_pk_bf16_f32 v32, 0, v32
    v_cvt_pk_bf16_f32 v38, 0, v38
    v_mul_f32 v44, v32, v36
    v_mul_f32 v45, v38, v42
    v_mul_f32 v32, v18, v31
    v_mul_f32 v33, v19, v30
    v_mul_f32 v34, v20, v29
    v_mul_f32 v35, v21, v28
    v_lshlrev_b32 v36, 16, v101
    v_mul_f32 v38, v19, v31
    v_mul_f32 v39, v20, v30
    v_mul_f32 v40, v21, v29
    v_mul_f32 v41, v22, v28
    v_lshlrev_b32 v42, 16, v105
    v_cvt_pk_bf16_f32 v32, 0, v32
    v_cvt_pk_bf16_f32 v33, 0, v33
    v_cvt_pk_bf16_f32 v34, 0, v34
    v_cvt_pk_bf16_f32 v35, 0, v35
    v_cvt_pk_bf16_f32 v38, 0, v38
    v_cvt_pk_bf16_f32 v39, 0, v39
    v_cvt_pk_bf16_f32 v40, 0, v40
    v_cvt_pk_bf16_f32 v41, 0, v41
    v_add_f32 v32, v32, v33
    v_add_f32 v38, v38, v39
    v_cvt_pk_bf16_f32 v32, 0, v32
    v_cvt_pk_bf16_f32 v38, 0, v38
    v_add_f32 v32, v32, v34
    v_add_f32 v38, v38, v40
    v_cvt_pk_bf16_f32 v32, 0, v32
    v_cvt_pk_bf16_f32 v38, 0, v38
    v_add_f32 v32, v32, v35
    v_add_f32 v38, v38, v41
    v_cvt_pk_bf16_f32 v32, 0, v32
    v_cvt_pk_bf16_f32 v38, 0, v38
    v_mul_f32 v46, v32, v36
    v_mul_f32 v47, v38, v42
    v_cvt_pk_bf16_f32 v56, v47, v46
    v_cvt_pk_bf16_f32 v57, v45, v44
    s_mov_b32 s18, 8192
    buffer_store_dwordx2 v[56:57], v10, s[32:35], s18 offen sc1
    v_and_b32 v16, s17, v65
    v_and_b32 v17, s17, v69
    v_and_b32 v18, s17, v73
    v_and_b32 v19, s17, v77
    v_and_b32 v20, s17, v81
    v_and_b32 v21, s17, v85
    v_and_b32 v22, s17, v89
    v_lshlrev_b32 v28, 16, v114
    v_and_b32 v29, s17, v114
    v_lshlrev_b32 v30, 16, v115
    v_and_b32 v31, s17, v115
    v_mul_f32 v32, v16, v31
    v_mul_f32 v33, v17, v30
    v_mul_f32 v34, v18, v29
    v_mul_f32 v35, v19, v28
    v_and_b32 v36, s17, v93
    v_mul_f32 v38, v17, v31
    v_mul_f32 v39, v18, v30
    v_mul_f32 v40, v19, v29
    v_mul_f32 v41, v20, v28
    v_and_b32 v42, s17, v97
    v_cvt_pk_bf16_f32 v32, 0, v32
    v_cvt_pk_bf16_f32 v33, 0, v33
    v_cvt_pk_bf16_f32 v34, 0, v34
    v_cvt_pk_bf16_f32 v35, 0, v35
    v_cvt_pk_bf16_f32 v38, 0, v38
    v_cvt_pk_bf16_f32 v39, 0, v39
    v_cvt_pk_bf16_f32 v40, 0, v40
    v_cvt_pk_bf16_f32 v41, 0, v41
    v_add_f32 v32, v32, v33
    v_add_f32 v38, v38, v39
    v_cvt_pk_bf16_f32 v32, 0, v32
    v_cvt_pk_bf16_f32 v38, 0, v38
    v_add_f32 v32, v32, v34
    v_add_f32 v38, v38, v40
    v_cvt_pk_bf16_f32 v32, 0, v32
    v_cvt_pk_bf16_f32 v38, 0, v38
    v_add_f32 v32, v32, v35
    v_add_f32 v38, v38, v41
    v_cvt_pk_bf16_f32 v32, 0, v32
    v_cvt_pk_bf16_f32 v38, 0, v38
    v_mul_f32 v44, v32, v36
    v_mul_f32 v45, v38, v42
    v_mul_f32 v32, v18, v31
    v_mul_f32 v33, v19, v30
    v_mul_f32 v34, v20, v29
    v_mul_f32 v35, v21, v28
    v_and_b32 v36, s17, v101
    v_mul_f32 v38, v19, v31
    v_mul_f32 v39, v20, v30
    v_mul_f32 v40, v21, v29
    v_mul_f32 v41, v22, v28
    v_and_b32 v42, s17, v105
    v_cvt_pk_bf16_f32 v32, 0, v32
    v_cvt_pk_bf16_f32 v33, 0, v33
    v_cvt_pk_bf16_f32 v34, 0, v34
    v_cvt_pk_bf16_f32 v35, 0, v35
    v_cvt_pk_bf16_f32 v38, 0, v38
    v_cvt_pk_bf16_f32 v39, 0, v39
    v_cvt_pk_bf16_f32 v40, 0, v40
    v_cvt_pk_bf16_f32 v41, 0, v41
    v_add_f32 v32, v32, v33
    v_add_f32 v38, v38, v39
    v_cvt_pk_bf16_f32 v32, 0, v32
    v_cvt_pk_bf16_f32 v38, 0, v38
    v_add_f32 v32, v32, v34
    v_add_f32 v38, v38, v40
    v_cvt_pk_bf16_f32 v32, 0, v32
    v_cvt_pk_bf16_f32 v38, 0, v38
    v_add_f32 v32, v32, v35
    v_add_f32 v38, v38, v41
    v_cvt_pk_bf16_f32 v32, 0, v32
    v_cvt_pk_bf16_f32 v38, 0, v38
    v_mul_f32 v46, v32, v36
    v_mul_f32 v47, v38, v42
    v_cvt_pk_bf16_f32 v58, v47, v46
    v_cvt_pk_bf16_f32 v59, v45, v44
    s_mov_b32 s18, 12288
    buffer_store_dwordx2 v[58:59], v10, s[32:35], s18 offen sc1
    v_lshlrev_b32 v16, 16, v66
    v_lshlrev_b32 v17, 16, v70
    v_lshlrev_b32 v18, 16, v74
    v_lshlrev_b32 v19, 16, v78
    v_lshlrev_b32 v20, 16, v82
    v_lshlrev_b32 v21, 16, v86
    v_lshlrev_b32 v22, 16, v90
    v_lshlrev_b32 v28, 16, v116
    v_and_b32 v29, s17, v116
    v_lshlrev_b32 v30, 16, v117
    v_and_b32 v31, s17, v117
    v_mul_f32 v32, v16, v31
    v_mul_f32 v33, v17, v30
    v_mul_f32 v34, v18, v29
    v_mul_f32 v35, v19, v28
    v_lshlrev_b32 v36, 16, v94
    v_mul_f32 v38, v17, v31
    v_mul_f32 v39, v18, v30
    v_mul_f32 v40, v19, v29
    v_mul_f32 v41, v20, v28
    v_lshlrev_b32 v42, 16, v98
    v_cvt_pk_bf16_f32 v32, 0, v32
    v_cvt_pk_bf16_f32 v33, 0, v33
    v_cvt_pk_bf16_f32 v34, 0, v34
    v_cvt_pk_bf16_f32 v35, 0, v35
    v_cvt_pk_bf16_f32 v38, 0, v38
    v_cvt_pk_bf16_f32 v39, 0, v39
    v_cvt_pk_bf16_f32 v40, 0, v40
    v_cvt_pk_bf16_f32 v41, 0, v41
    v_add_f32 v32, v32, v33
    v_add_f32 v38, v38, v39
    v_cvt_pk_bf16_f32 v32, 0, v32
    v_cvt_pk_bf16_f32 v38, 0, v38
    v_add_f32 v32, v32, v34
    v_add_f32 v38, v38, v40
    v_cvt_pk_bf16_f32 v32, 0, v32
    v_cvt_pk_bf16_f32 v38, 0, v38
    v_add_f32 v32, v32, v35
    v_add_f32 v38, v38, v41
    v_cvt_pk_bf16_f32 v32, 0, v32
    v_cvt_pk_bf16_f32 v38, 0, v38
    v_mul_f32 v44, v32, v36
    v_mul_f32 v45, v38, v42
    v_mul_f32 v32, v18, v31
    v_mul_f32 v33, v19, v30
    v_mul_f32 v34, v20, v29
    v_mul_f32 v35, v21, v28
    v_lshlrev_b32 v36, 16, v102
    v_mul_f32 v38, v19, v31
    v_mul_f32 v39, v20, v30
    v_mul_f32 v40, v21, v29
    v_mul_f32 v41, v22, v28
    v_lshlrev_b32 v42, 16, v106
    v_cvt_pk_bf16_f32 v32, 0, v32
    v_cvt_pk_bf16_f32 v33, 0, v33
    v_cvt_pk_bf16_f32 v34, 0, v34
    v_cvt_pk_bf16_f32 v35, 0, v35
    v_cvt_pk_bf16_f32 v38, 0, v38
    v_cvt_pk_bf16_f32 v39, 0, v39
    v_cvt_pk_bf16_f32 v40, 0, v40
    v_cvt_pk_bf16_f32 v41, 0, v41
    v_add_f32 v32, v32, v33
    v_add_f32 v38, v38, v39
    v_cvt_pk_bf16_f32 v32, 0, v32
    v_cvt_pk_bf16_f32 v38, 0, v38
    v_add_f32 v32, v32, v34
    v_add_f32 v38, v38, v40
    v_cvt_pk_bf16_f32 v32, 0, v32
    v_cvt_pk_bf16_f32 v38, 0, v38
    v_add_f32 v32, v32, v35
    v_add_f32 v38, v38, v41
    v_cvt_pk_bf16_f32 v32, 0, v32
    v_cvt_pk_bf16_f32 v38, 0, v38
    v_mul_f32 v46, v32, v36
    v_mul_f32 v47, v38, v42
    v_cvt_pk_bf16_f32 v52, v47, v46
    v_cvt_pk_bf16_f32 v53, v45, v44
    s_mov_b32 s18, 16384
    buffer_store_dwordx2 v[52:53], v10, s[32:35], s18 offen sc1
    v_and_b32 v16, s17, v66
    v_and_b32 v17, s17, v70
    v_and_b32 v18, s17, v74
    v_and_b32 v19, s17, v78
    v_and_b32 v20, s17, v82
    v_and_b32 v21, s17, v86
    v_and_b32 v22, s17, v90
    v_lshlrev_b32 v28, 16, v118
    v_and_b32 v29, s17, v118
    v_lshlrev_b32 v30, 16, v119
    v_and_b32 v31, s17, v119
    v_mul_f32 v32, v16, v31
    v_mul_f32 v33, v17, v30
    v_mul_f32 v34, v18, v29
    v_mul_f32 v35, v19, v28
    v_and_b32 v36, s17, v94
    v_mul_f32 v38, v17, v31
    v_mul_f32 v39, v18, v30
    v_mul_f32 v40, v19, v29
    v_mul_f32 v41, v20, v28
    v_and_b32 v42, s17, v98
    v_cvt_pk_bf16_f32 v32, 0, v32
    v_cvt_pk_bf16_f32 v33, 0, v33
    v_cvt_pk_bf16_f32 v34, 0, v34
    v_cvt_pk_bf16_f32 v35, 0, v35
    v_cvt_pk_bf16_f32 v38, 0, v38
    v_cvt_pk_bf16_f32 v39, 0, v39
    v_cvt_pk_bf16_f32 v40, 0, v40
    v_cvt_pk_bf16_f32 v41, 0, v41
    v_add_f32 v32, v32, v33
    v_add_f32 v38, v38, v39
    v_cvt_pk_bf16_f32 v32, 0, v32
    v_cvt_pk_bf16_f32 v38, 0, v38
    v_add_f32 v32, v32, v34
    v_add_f32 v38, v38, v40
    v_cvt_pk_bf16_f32 v32, 0, v32
    v_cvt_pk_bf16_f32 v38, 0, v38
    v_add_f32 v32, v32, v35
    v_add_f32 v38, v38, v41
    v_cvt_pk_bf16_f32 v32, 0, v32
    v_cvt_pk_bf16_f32 v38, 0, v38
    v_mul_f32 v44, v32, v36
    v_mul_f32 v45, v38, v42
    v_mul_f32 v32, v18, v31
    v_mul_f32 v33, v19, v30
    v_mul_f32 v34, v20, v29
    v_mul_f32 v35, v21, v28
    v_and_b32 v36, s17, v102
    v_mul_f32 v38, v19, v31
    v_mul_f32 v39, v20, v30
    v_mul_f32 v40, v21, v29
    v_mul_f32 v41, v22, v28
    v_and_b32 v42, s17, v106
    v_cvt_pk_bf16_f32 v32, 0, v32
    v_cvt_pk_bf16_f32 v33, 0, v33
    v_cvt_pk_bf16_f32 v34, 0, v34
    v_cvt_pk_bf16_f32 v35, 0, v35
    v_cvt_pk_bf16_f32 v38, 0, v38
    v_cvt_pk_bf16_f32 v39, 0, v39
    v_cvt_pk_bf16_f32 v40, 0, v40
    v_cvt_pk_bf16_f32 v41, 0, v41
    v_add_f32 v32, v32, v33
    v_add_f32 v38, v38, v39
    v_cvt_pk_bf16_f32 v32, 0, v32
    v_cvt_pk_bf16_f32 v38, 0, v38
    v_add_f32 v32, v32, v34
    v_add_f32 v38, v38, v40
    v_cvt_pk_bf16_f32 v32, 0, v32
    v_cvt_pk_bf16_f32 v38, 0, v38
    v_add_f32 v32, v32, v35
    v_add_f32 v38, v38, v41
    v_cvt_pk_bf16_f32 v32, 0, v32
    v_cvt_pk_bf16_f32 v38, 0, v38
    v_mul_f32 v46, v32, v36
    v_mul_f32 v47, v38, v42
    v_cvt_pk_bf16_f32 v54, v47, v46
    v_cvt_pk_bf16_f32 v55, v45, v44
    s_mov_b32 s18, 20480
    buffer_store_dwordx2 v[54:55], v10, s[32:35], s18 offen sc1
    v_lshlrev_b32 v16, 16, v67
    v_lshlrev_b32 v17, 16, v71
    v_lshlrev_b32 v18, 16, v75
    v_lshlrev_b32 v19, 16, v79
    v_lshlrev_b32 v20, 16, v83
    v_lshlrev_b32 v21, 16, v87
    v_lshlrev_b32 v22, 16, v91
    v_lshlrev_b32 v28, 16, v120
    v_and_b32 v29, s17, v120
    v_lshlrev_b32 v30, 16, v121
    v_and_b32 v31, s17, v121
    v_mul_f32 v32, v16, v31
    v_mul_f32 v33, v17, v30
    v_mul_f32 v34, v18, v29
    v_mul_f32 v35, v19, v28
    v_lshlrev_b32 v36, 16, v95
    v_mul_f32 v38, v17, v31
    v_mul_f32 v39, v18, v30
    v_mul_f32 v40, v19, v29
    v_mul_f32 v41, v20, v28
    v_lshlrev_b32 v42, 16, v99
    v_cvt_pk_bf16_f32 v32, 0, v32
    v_cvt_pk_bf16_f32 v33, 0, v33
    v_cvt_pk_bf16_f32 v34, 0, v34
    v_cvt_pk_bf16_f32 v35, 0, v35
    v_cvt_pk_bf16_f32 v38, 0, v38
    v_cvt_pk_bf16_f32 v39, 0, v39
    v_cvt_pk_bf16_f32 v40, 0, v40
    v_cvt_pk_bf16_f32 v41, 0, v41
    v_add_f32 v32, v32, v33
    v_add_f32 v38, v38, v39
    v_cvt_pk_bf16_f32 v32, 0, v32
    v_cvt_pk_bf16_f32 v38, 0, v38
    v_add_f32 v32, v32, v34
    v_add_f32 v38, v38, v40
    v_cvt_pk_bf16_f32 v32, 0, v32
    v_cvt_pk_bf16_f32 v38, 0, v38
    v_add_f32 v32, v32, v35
    v_add_f32 v38, v38, v41
    v_cvt_pk_bf16_f32 v32, 0, v32
    v_cvt_pk_bf16_f32 v38, 0, v38
    v_mul_f32 v44, v32, v36
    v_mul_f32 v45, v38, v42
    v_mul_f32 v32, v18, v31
    v_mul_f32 v33, v19, v30
    v_mul_f32 v34, v20, v29
    v_mul_f32 v35, v21, v28
    v_lshlrev_b32 v36, 16, v103
    v_mul_f32 v38, v19, v31
    v_mul_f32 v39, v20, v30
    v_mul_f32 v40, v21, v29
    v_mul_f32 v41, v22, v28
    v_lshlrev_b32 v42, 16, v107
    v_cvt_pk_bf16_f32 v32, 0, v32
    v_cvt_pk_bf16_f32 v33, 0, v33
    v_cvt_pk_bf16_f32 v34, 0, v34
    v_cvt_pk_bf16_f32 v35, 0, v35
    v_cvt_pk_bf16_f32 v38, 0, v38
    v_cvt_pk_bf16_f32 v39, 0, v39
    v_cvt_pk_bf16_f32 v40, 0, v40
    v_cvt_pk_bf16_f32 v41, 0, v41
    v_add_f32 v32, v32, v33
    v_add_f32 v38, v38, v39
    v_cvt_pk_bf16_f32 v32, 0, v32
    v_cvt_pk_bf16_f32 v38, 0, v38
    v_add_f32 v32, v32, v34
    v_add_f32 v38, v38, v40
    v_cvt_pk_bf16_f32 v32, 0, v32
    v_cvt_pk_bf16_f32 v38, 0, v38
    v_add_f32 v32, v32, v35
    v_add_f32 v38, v38, v41
    v_cvt_pk_bf16_f32 v32, 0, v32
    v_cvt_pk_bf16_f32 v38, 0, v38
    v_mul_f32 v46, v32, v36
    v_mul_f32 v47, v38, v42
    v_cvt_pk_bf16_f32 v56, v47, v46
    v_cvt_pk_bf16_f32 v57, v45, v44
    s_mov_b32 s18, 24576
    buffer_store_dwordx2 v[56:57], v10, s[32:35], s18 offen sc1
    v_and_b32 v16, s17, v67
    v_and_b32 v17, s17, v71
    v_and_b32 v18, s17, v75
    v_and_b32 v19, s17, v79
    v_and_b32 v20, s17, v83
    v_and_b32 v21, s17, v87
    v_and_b32 v22, s17, v91
    v_lshlrev_b32 v28, 16, v122
    v_and_b32 v29, s17, v122
    v_lshlrev_b32 v30, 16, v123
    v_and_b32 v31, s17, v123
    v_mul_f32 v32, v16, v31
    v_mul_f32 v33, v17, v30
    v_mul_f32 v34, v18, v29
    v_mul_f32 v35, v19, v28
    v_and_b32 v36, s17, v95
    v_mul_f32 v38, v17, v31
    v_mul_f32 v39, v18, v30
    v_mul_f32 v40, v19, v29
    v_mul_f32 v41, v20, v28
    v_and_b32 v42, s17, v99
    v_cvt_pk_bf16_f32 v32, 0, v32
    v_cvt_pk_bf16_f32 v33, 0, v33
    v_cvt_pk_bf16_f32 v34, 0, v34
    v_cvt_pk_bf16_f32 v35, 0, v35
    v_cvt_pk_bf16_f32 v38, 0, v38
    v_cvt_pk_bf16_f32 v39, 0, v39
    v_cvt_pk_bf16_f32 v40, 0, v40
    v_cvt_pk_bf16_f32 v41, 0, v41
    v_add_f32 v32, v32, v33
    v_add_f32 v38, v38, v39
    v_cvt_pk_bf16_f32 v32, 0, v32
    v_cvt_pk_bf16_f32 v38, 0, v38
    v_add_f32 v32, v32, v34
    v_add_f32 v38, v38, v40
    v_cvt_pk_bf16_f32 v32, 0, v32
    v_cvt_pk_bf16_f32 v38, 0, v38
    v_add_f32 v32, v32, v35
    v_add_f32 v38, v38, v41
    v_cvt_pk_bf16_f32 v32, 0, v32
    v_cvt_pk_bf16_f32 v38, 0, v38
    v_mul_f32 v44, v32, v36
    v_mul_f32 v45, v38, v42
    v_mul_f32 v32, v18, v31
    v_mul_f32 v33, v19, v30
    v_mul_f32 v34, v20, v29
    v_mul_f32 v35, v21, v28
    v_and_b32 v36, s17, v103
    v_mul_f32 v38, v19, v31
    v_mul_f32 v39, v20, v30
    v_mul_f32 v40, v21, v29
    v_mul_f32 v41, v22, v28
    v_and_b32 v42, s17, v107
    v_cvt_pk_bf16_f32 v32, 0, v32
    v_cvt_pk_bf16_f32 v33, 0, v33
    v_cvt_pk_bf16_f32 v34, 0, v34
    v_cvt_pk_bf16_f32 v35, 0, v35
    v_cvt_pk_bf16_f32 v38, 0, v38
    v_cvt_pk_bf16_f32 v39, 0, v39
    v_cvt_pk_bf16_f32 v40, 0, v40
    v_cvt_pk_bf16_f32 v41, 0, v41
    v_add_f32 v32, v32, v33
    v_add_f32 v38, v38, v39
    v_cvt_pk_bf16_f32 v32, 0, v32
    v_cvt_pk_bf16_f32 v38, 0, v38
    v_add_f32 v32, v32, v34
    v_add_f32 v38, v38, v40
    v_cvt_pk_bf16_f32 v32, 0, v32
    v_cvt_pk_bf16_f32 v38, 0, v38
    v_add_f32 v32, v32, v35
    v_add_f32 v38, v38, v41
    v_cvt_pk_bf16_f32 v32, 0, v32
    v_cvt_pk_bf16_f32 v38, 0, v38
    v_mul_f32 v46, v32, v36
    v_mul_f32 v47, v38, v42
    v_cvt_pk_bf16_f32 v58, v47, v46
    v_cvt_pk_bf16_f32 v59, v45, v44
    s_mov_b32 s18, 28672
    buffer_store_dwordx2 v[58:59], v10, s[32:35], s18 offen sc1
    s_add_u32 s12, s3, 384
    s_cmp_ge_u32 s12, 640
    s_cbranch_scc1 .a1done_5
    s_waitcnt vmcnt(8)
    v_lshlrev_b32 v16, 16, v124
    v_lshlrev_b32 v17, 16, v128
    v_lshlrev_b32 v18, 16, v132
    v_lshlrev_b32 v19, 16, v136
    v_lshlrev_b32 v20, 16, v140
    v_lshlrev_b32 v21, 16, v144
    v_lshlrev_b32 v22, 16, v148
    v_lshlrev_b32 v28, 16, v168
    v_and_b32 v29, s17, v168
    v_lshlrev_b32 v30, 16, v169
    v_and_b32 v31, s17, v169
    v_mul_f32 v32, v16, v31
    v_mul_f32 v33, v17, v30
    v_mul_f32 v34, v18, v29
    v_mul_f32 v35, v19, v28
    v_lshlrev_b32 v36, 16, v152
    v_mul_f32 v38, v17, v31
    v_mul_f32 v39, v18, v30
    v_mul_f32 v40, v19, v29
    v_mul_f32 v41, v20, v28
    v_lshlrev_b32 v42, 16, v156
    v_cvt_pk_bf16_f32 v32, 0, v32
    v_cvt_pk_bf16_f32 v33, 0, v33
    v_cvt_pk_bf16_f32 v34, 0, v34
    v_cvt_pk_bf16_f32 v35, 0, v35
    v_cvt_pk_bf16_f32 v38, 0, v38
    v_cvt_pk_bf16_f32 v39, 0, v39
    v_cvt_pk_bf16_f32 v40, 0, v40
    v_cvt_pk_bf16_f32 v41, 0, v41
    v_add_f32 v32, v32, v33
    v_add_f32 v38, v38, v39
    v_cvt_pk_bf16_f32 v32, 0, v32
    v_cvt_pk_bf16_f32 v38, 0, v38
    v_add_f32 v32, v32, v34
    v_add_f32 v38, v38, v40
    v_cvt_pk_bf16_f32 v32, 0, v32
    v_cvt_pk_bf16_f32 v38, 0, v38
    v_add_f32 v32, v32, v35
    v_add_f32 v38, v38, v41
    v_cvt_pk_bf16_f32 v32, 0, v32
    v_cvt_pk_bf16_f32 v38, 0, v38
    v_mul_f32 v44, v32, v36
    v_mul_f32 v45, v38, v42
    v_mul_f32 v32, v18, v31
    v_mul_f32 v33, v19, v30
    v_mul_f32 v34, v20, v29
    v_mul_f32 v35, v21, v28
    v_lshlrev_b32 v36, 16, v160
    v_mul_f32 v38, v19, v31
    v_mul_f32 v39, v20, v30
    v_mul_f32 v40, v21, v29
    v_mul_f32 v41, v22, v28
    v_lshlrev_b32 v42, 16, v164
    v_cvt_pk_bf16_f32 v32, 0, v32
    v_cvt_pk_bf16_f32 v33, 0, v33
    v_cvt_pk_bf16_f32 v34, 0, v34
    v_cvt_pk_bf16_f32 v35, 0, v35
    v_cvt_pk_bf16_f32 v38, 0, v38
    v_cvt_pk_bf16_f32 v39, 0, v39
    v_cvt_pk_bf16_f32 v40, 0, v40
    v_cvt_pk_bf16_f32 v41, 0, v41
    v_add_f32 v32, v32, v33
    v_add_f32 v38, v38, v39
    v_cvt_pk_bf16_f32 v32, 0, v32
    v_cvt_pk_bf16_f32 v38, 0, v38
    v_add_f32 v32, v32, v34
    v_add_f32 v38, v38, v40
    v_cvt_pk_bf16_f32 v32, 0, v32
    v_cvt_pk_bf16_f32 v38, 0, v38
    v_add_f32 v32, v32, v35
    v_add_f32 v38, v38, v41
    v_cvt_pk_bf16_f32 v32, 0, v32
    v_cvt_pk_bf16_f32 v38, 0, v38
    v_mul_f32 v46, v32, v36
    v_mul_f32 v47, v38, v42
    v_cvt_pk_bf16_f32 v52, v47, v46
    v_cvt_pk_bf16_f32 v53, v45, v44
    s_mov_b32 s18, 0
    buffer_store_dwordx2 v[52:53], v11, s[32:35], s18 offen sc1
    v_and_b32 v16, s17, v124
    v_and_b32 v17, s17, v128
    v_and_b32 v18, s17, v132
    v_and_b32 v19, s17, v136
    v_and_b32 v20, s17, v140
    v_and_b32 v21, s17, v144
    v_and_b32 v22, s17, v148
    v_lshlrev_b32 v28, 16, v170
    v_and_b32 v29, s17, v170
    v_lshlrev_b32 v30, 16, v171
    v_and_b32 v31, s17, v171
    v_mul_f32 v32, v16, v31
    v_mul_f32 v33, v17, v30
    v_mul_f32 v34, v18, v29
    v_mul_f32 v35, v19, v28
    v_and_b32 v36, s17, v152
    v_mul_f32 v38, v17, v31
    v_mul_f32 v39, v18, v30
    v_mul_f32 v40, v19, v29
    v_mul_f32 v41, v20, v28
    v_and_b32 v42, s17, v156
    v_cvt_pk_bf16_f32 v32, 0, v32
    v_cvt_pk_bf16_f32 v33, 0, v33
    v_cvt_pk_bf16_f32 v34, 0, v34
    v_cvt_pk_bf16_f32 v35, 0, v35
    v_cvt_pk_bf16_f32 v38, 0, v38
    v_cvt_pk_bf16_f32 v39, 0, v39
    v_cvt_pk_bf16_f32 v40, 0, v40
    v_cvt_pk_bf16_f32 v41, 0, v41
    v_add_f32 v32, v32, v33
    v_add_f32 v38, v38, v39
    v_cvt_pk_bf16_f32 v32, 0, v32
    v_cvt_pk_bf16_f32 v38, 0, v38
    v_add_f32 v32, v32, v34
    v_add_f32 v38, v38, v40
    v_cvt_pk_bf16_f32 v32, 0, v32
    v_cvt_pk_bf16_f32 v38, 0, v38
    v_add_f32 v32, v32, v35
    v_add_f32 v38, v38, v41
    v_cvt_pk_bf16_f32 v32, 0, v32
    v_cvt_pk_bf16_f32 v38, 0, v38
    v_mul_f32 v44, v32, v36
    v_mul_f32 v45, v38, v42
    v_mul_f32 v32, v18, v31
    v_mul_f32 v33, v19, v30
    v_mul_f32 v34, v20, v29
    v_mul_f32 v35, v21, v28
    v_and_b32 v36, s17, v160
    v_mul_f32 v38, v19, v31
    v_mul_f32 v39, v20, v30
    v_mul_f32 v40, v21, v29
    v_mul_f32 v41, v22, v28
    v_and_b32 v42, s17, v164
    v_cvt_pk_bf16_f32 v32, 0, v32
    v_cvt_pk_bf16_f32 v33, 0, v33
    v_cvt_pk_bf16_f32 v34, 0, v34
    v_cvt_pk_bf16_f32 v35, 0, v35
    v_cvt_pk_bf16_f32 v38, 0, v38
    v_cvt_pk_bf16_f32 v39, 0, v39
    v_cvt_pk_bf16_f32 v40, 0, v40
    v_cvt_pk_bf16_f32 v41, 0, v41
    v_add_f32 v32, v32, v33
    v_add_f32 v38, v38, v39
    v_cvt_pk_bf16_f32 v32, 0, v32
    v_cvt_pk_bf16_f32 v38, 0, v38
    v_add_f32 v32, v32, v34
    v_add_f32 v38, v38, v40
    v_cvt_pk_bf16_f32 v32, 0, v32
    v_cvt_pk_bf16_f32 v38, 0, v38
    v_add_f32 v32, v32, v35
    v_add_f32 v38, v38, v41
    v_cvt_pk_bf16_f32 v32, 0, v32
    v_cvt_pk_bf16_f32 v38, 0, v38
    v_mul_f32 v46, v32, v36
    v_mul_f32 v47, v38, v42
    v_cvt_pk_bf16_f32 v54, v47, v46
    v_cvt_pk_bf16_f32 v55, v45, v44
    s_mov_b32 s18, 4096
    buffer_store_dwordx2 v[54:55], v11, s[32:35], s18 offen sc1
    v_lshlrev_b32 v16, 16, v125
    v_lshlrev_b32 v17, 16, v129
    v_lshlrev_b32 v18, 16, v133
    v_lshlrev_b32 v19, 16, v137
    v_lshlrev_b32 v20, 16, v141
    v_lshlrev_b32 v21, 16, v145
    v_lshlrev_b32 v22, 16, v149
    v_lshlrev_b32 v28, 16, v172
    v_and_b32 v29, s17, v172
    v_lshlrev_b32 v30, 16, v173
    v_and_b32 v31, s17, v173
    v_mul_f32 v32, v16, v31
    v_mul_f32 v33, v17, v30
    v_mul_f32 v34, v18, v29
    v_mul_f32 v35, v19, v28
    v_lshlrev_b32 v36, 16, v153
    v_mul_f32 v38, v17, v31
    v_mul_f32 v39, v18, v30
    v_mul_f32 v40, v19, v29
    v_mul_f32 v41, v20, v28
    v_lshlrev_b32 v42, 16, v157
    v_cvt_pk_bf16_f32 v32, 0, v32
    v_cvt_pk_bf16_f32 v33, 0, v33
    v_cvt_pk_bf16_f32 v34, 0, v34
    v_cvt_pk_bf16_f32 v35, 0, v35
    v_cvt_pk_bf16_f32 v38, 0, v38
    v_cvt_pk_bf16_f32 v39, 0, v39
    v_cvt_pk_bf16_f32 v40, 0, v40
    v_cvt_pk_bf16_f32 v41, 0, v41
    v_add_f32 v32, v32, v33
    v_add_f32 v38, v38, v39
    v_cvt_pk_bf16_f32 v32, 0, v32
    v_cvt_pk_bf16_f32 v38, 0, v38
    v_add_f32 v32, v32, v34
    v_add_f32 v38, v38, v40
    v_cvt_pk_bf16_f32 v32, 0, v32
    v_cvt_pk_bf16_f32 v38, 0, v38
    v_add_f32 v32, v32, v35
    v_add_f32 v38, v38, v41
    v_cvt_pk_bf16_f32 v32, 0, v32
    v_cvt_pk_bf16_f32 v38, 0, v38
    v_mul_f32 v44, v32, v36
    v_mul_f32 v45, v38, v42
    v_mul_f32 v32, v18, v31
    v_mul_f32 v33, v19, v30
    v_mul_f32 v34, v20, v29
    v_mul_f32 v35, v21, v28
    v_lshlrev_b32 v36, 16, v161
    v_mul_f32 v38, v19, v31
    v_mul_f32 v39, v20, v30
    v_mul_f32 v40, v21, v29
    v_mul_f32 v41, v22, v28
    v_lshlrev_b32 v42, 16, v165
    v_cvt_pk_bf16_f32 v32, 0, v32
    v_cvt_pk_bf16_f32 v33, 0, v33
    v_cvt_pk_bf16_f32 v34, 0, v34
    v_cvt_pk_bf16_f32 v35, 0, v35
    v_cvt_pk_bf16_f32 v38, 0, v38
    v_cvt_pk_bf16_f32 v39, 0, v39
    v_cvt_pk_bf16_f32 v40, 0, v40
    v_cvt_pk_bf16_f32 v41, 0, v41
    v_add_f32 v32, v32, v33
    v_add_f32 v38, v38, v39
    v_cvt_pk_bf16_f32 v32, 0, v32
    v_cvt_pk_bf16_f32 v38, 0, v38
    v_add_f32 v32, v32, v34
    v_add_f32 v38, v38, v40
    v_cvt_pk_bf16_f32 v32, 0, v32
    v_cvt_pk_bf16_f32 v38, 0, v38
    v_add_f32 v32, v32, v35
    v_add_f32 v38, v38, v41
    v_cvt_pk_bf16_f32 v32, 0, v32
    v_cvt_pk_bf16_f32 v38, 0, v38
    v_mul_f32 v46, v32, v36
    v_mul_f32 v47, v38, v42
    v_cvt_pk_bf16_f32 v56, v47, v46
    v_cvt_pk_bf16_f32 v57, v45, v44
    s_mov_b32 s18, 8192
    buffer_store_dwordx2 v[56:57], v11, s[32:35], s18 offen sc1
    v_and_b32 v16, s17, v125
    v_and_b32 v17, s17, v129
    v_and_b32 v18, s17, v133
    v_and_b32 v19, s17, v137
    v_and_b32 v20, s17, v141
    v_and_b32 v21, s17, v145
    v_and_b32 v22, s17, v149
    v_lshlrev_b32 v28, 16, v174
    v_and_b32 v29, s17, v174
    v_lshlrev_b32 v30, 16, v175
    v_and_b32 v31, s17, v175
    v_mul_f32 v32, v16, v31
    v_mul_f32 v33, v17, v30
    v_mul_f32 v34, v18, v29
    v_mul_f32 v35, v19, v28
    v_and_b32 v36, s17, v153
    v_mul_f32 v38, v17, v31
    v_mul_f32 v39, v18, v30
    v_mul_f32 v40, v19, v29
    v_mul_f32 v41, v20, v28
    v_and_b32 v42, s17, v157
    v_cvt_pk_bf16_f32 v32, 0, v32
    v_cvt_pk_bf16_f32 v33, 0, v33
    v_cvt_pk_bf16_f32 v34, 0, v34
    v_cvt_pk_bf16_f32 v35, 0, v35
    v_cvt_pk_bf16_f32 v38, 0, v38
    v_cvt_pk_bf16_f32 v39, 0, v39
    v_cvt_pk_bf16_f32 v40, 0, v40
    v_cvt_pk_bf16_f32 v41, 0, v41
    v_add_f32 v32, v32, v33
    v_add_f32 v38, v38, v39
    v_cvt_pk_bf16_f32 v32, 0, v32
    v_cvt_pk_bf16_f32 v38, 0, v38
    v_add_f32 v32, v32, v34
    v_add_f32 v38, v38, v40
    v_cvt_pk_bf16_f32 v32, 0, v32
    v_cvt_pk_bf16_f32 v38, 0, v38
    v_add_f32 v32, v32, v35
    v_add_f32 v38, v38, v41
    v_cvt_pk_bf16_f32 v32, 0, v32
    v_cvt_pk_bf16_f32 v38, 0, v38
    v_mul_f32 v44, v32, v36
    v_mul_f32 v45, v38, v42
    v_mul_f32 v32, v18, v31
    v_mul_f32 v33, v19, v30
    v_mul_f32 v34, v20, v29
    v_mul_f32 v35, v21, v28
    v_and_b32 v36, s17, v161
    v_mul_f32 v38, v19, v31
    v_mul_f32 v39, v20, v30
    v_mul_f32 v40, v21, v29
    v_mul_f32 v41, v22, v28
    v_and_b32 v42, s17, v165
    v_cvt_pk_bf16_f32 v32, 0, v32
    v_cvt_pk_bf16_f32 v33, 0, v33
    v_cvt_pk_bf16_f32 v34, 0, v34
    v_cvt_pk_bf16_f32 v35, 0, v35
    v_cvt_pk_bf16_f32 v38, 0, v38
    v_cvt_pk_bf16_f32 v39, 0, v39
    v_cvt_pk_bf16_f32 v40, 0, v40
    v_cvt_pk_bf16_f32 v41, 0, v41
    v_add_f32 v32, v32, v33
    v_add_f32 v38, v38, v39
    v_cvt_pk_bf16_f32 v32, 0, v32
    v_cvt_pk_bf16_f32 v38, 0, v38
    v_add_f32 v32, v32, v34
    v_add_f32 v38, v38, v40
    v_cvt_pk_bf16_f32 v32, 0, v32
    v_cvt_pk_bf16_f32 v38, 0, v38
    v_add_f32 v32, v32, v35
    v_add_f32 v38, v38, v41
    v_cvt_pk_bf16_f32 v32, 0, v32
    v_cvt_pk_bf16_f32 v38, 0, v38
    v_mul_f32 v46, v32, v36
    v_mul_f32 v47, v38, v42
    v_cvt_pk_bf16_f32 v58, v47, v46
    v_cvt_pk_bf16_f32 v59, v45, v44
    s_mov_b32 s18, 12288
    buffer_store_dwordx2 v[58:59], v11, s[32:35], s18 offen sc1
    v_lshlrev_b32 v16, 16, v126
    v_lshlrev_b32 v17, 16, v130
    v_lshlrev_b32 v18, 16, v134
    v_lshlrev_b32 v19, 16, v138
    v_lshlrev_b32 v20, 16, v142
    v_lshlrev_b32 v21, 16, v146
    v_lshlrev_b32 v22, 16, v150
    v_lshlrev_b32 v28, 16, v176
    v_and_b32 v29, s17, v176
    v_lshlrev_b32 v30, 16, v177
    v_and_b32 v31, s17, v177
    v_mul_f32 v32, v16, v31
    v_mul_f32 v33, v17, v30
    v_mul_f32 v34, v18, v29
    v_mul_f32 v35, v19, v28
    v_lshlrev_b32 v36, 16, v154
    v_mul_f32 v38, v17, v31
    v_mul_f32 v39, v18, v30
    v_mul_f32 v40, v19, v29
    v_mul_f32 v41, v20, v28
    v_lshlrev_b32 v42, 16, v158
    v_cvt_pk_bf16_f32 v32, 0, v32
    v_cvt_pk_bf16_f32 v33, 0, v33
    v_cvt_pk_bf16_f32 v34, 0, v34
    v_cvt_pk_bf16_f32 v35, 0, v35
    v_cvt_pk_bf16_f32 v38, 0, v38
    v_cvt_pk_bf16_f32 v39, 0, v39
    v_cvt_pk_bf16_f32 v40, 0, v40
    v_cvt_pk_bf16_f32 v41, 0, v41
    v_add_f32 v32, v32, v33
    v_add_f32 v38, v38, v39
    v_cvt_pk_bf16_f32 v32, 0, v32
    v_cvt_pk_bf16_f32 v38, 0, v38
    v_add_f32 v32, v32, v34
    v_add_f32 v38, v38, v40
    v_cvt_pk_bf16_f32 v32, 0, v32
    v_cvt_pk_bf16_f32 v38, 0, v38
    v_add_f32 v32, v32, v35
    v_add_f32 v38, v38, v41
    v_cvt_pk_bf16_f32 v32, 0, v32
    v_cvt_pk_bf16_f32 v38, 0, v38
    v_mul_f32 v44, v32, v36
    v_mul_f32 v45, v38, v42
    v_mul_f32 v32, v18, v31
    v_mul_f32 v33, v19, v30
    v_mul_f32 v34, v20, v29
    v_mul_f32 v35, v21, v28
    v_lshlrev_b32 v36, 16, v162
    v_mul_f32 v38, v19, v31
    v_mul_f32 v39, v20, v30
    v_mul_f32 v40, v21, v29
    v_mul_f32 v41, v22, v28
    v_lshlrev_b32 v42, 16, v166
    v_cvt_pk_bf16_f32 v32, 0, v32
    v_cvt_pk_bf16_f32 v33, 0, v33
    v_cvt_pk_bf16_f32 v34, 0, v34
    v_cvt_pk_bf16_f32 v35, 0, v35
    v_cvt_pk_bf16_f32 v38, 0, v38
    v_cvt_pk_bf16_f32 v39, 0, v39
    v_cvt_pk_bf16_f32 v40, 0, v40
    v_cvt_pk_bf16_f32 v41, 0, v41
    v_add_f32 v32, v32, v33
    v_add_f32 v38, v38, v39
    v_cvt_pk_bf16_f32 v32, 0, v32
    v_cvt_pk_bf16_f32 v38, 0, v38
    v_add_f32 v32, v32, v34
    v_add_f32 v38, v38, v40
    v_cvt_pk_bf16_f32 v32, 0, v32
    v_cvt_pk_bf16_f32 v38, 0, v38
    v_add_f32 v32, v32, v35
    v_add_f32 v38, v38, v41
    v_cvt_pk_bf16_f32 v32, 0, v32
    v_cvt_pk_bf16_f32 v38, 0, v38
    v_mul_f32 v46, v32, v36
    v_mul_f32 v47, v38, v42
    v_cvt_pk_bf16_f32 v52, v47, v46
    v_cvt_pk_bf16_f32 v53, v45, v44
    s_mov_b32 s18, 16384
    buffer_store_dwordx2 v[52:53], v11, s[32:35], s18 offen sc1
    v_and_b32 v16, s17, v126
    v_and_b32 v17, s17, v130
    v_and_b32 v18, s17, v134
    v_and_b32 v19, s17, v138
    v_and_b32 v20, s17, v142
    v_and_b32 v21, s17, v146
    v_and_b32 v22, s17, v150
    v_lshlrev_b32 v28, 16, v178
    v_and_b32 v29, s17, v178
    v_lshlrev_b32 v30, 16, v179
    v_and_b32 v31, s17, v179
    v_mul_f32 v32, v16, v31
    v_mul_f32 v33, v17, v30
    v_mul_f32 v34, v18, v29
    v_mul_f32 v35, v19, v28
    v_and_b32 v36, s17, v154
    v_mul_f32 v38, v17, v31
    v_mul_f32 v39, v18, v30
    v_mul_f32 v40, v19, v29
    v_mul_f32 v41, v20, v28
    v_and_b32 v42, s17, v158
    v_cvt_pk_bf16_f32 v32, 0, v32
    v_cvt_pk_bf16_f32 v33, 0, v33
    v_cvt_pk_bf16_f32 v34, 0, v34
    v_cvt_pk_bf16_f32 v35, 0, v35
    v_cvt_pk_bf16_f32 v38, 0, v38
    v_cvt_pk_bf16_f32 v39, 0, v39
    v_cvt_pk_bf16_f32 v40, 0, v40
    v_cvt_pk_bf16_f32 v41, 0, v41
    v_add_f32 v32, v32, v33
    v_add_f32 v38, v38, v39
    v_cvt_pk_bf16_f32 v32, 0, v32
    v_cvt_pk_bf16_f32 v38, 0, v38
    v_add_f32 v32, v32, v34
    v_add_f32 v38, v38, v40
    v_cvt_pk_bf16_f32 v32, 0, v32
    v_cvt_pk_bf16_f32 v38, 0, v38
    v_add_f32 v32, v32, v35
    v_add_f32 v38, v38, v41
    v_cvt_pk_bf16_f32 v32, 0, v32
    v_cvt_pk_bf16_f32 v38, 0, v38
    v_mul_f32 v44, v32, v36
    v_mul_f32 v45, v38, v42
    v_mul_f32 v32, v18, v31
    v_mul_f32 v33, v19, v30
    v_mul_f32 v34, v20, v29
    v_mul_f32 v35, v21, v28
    v_and_b32 v36, s17, v162
    v_mul_f32 v38, v19, v31
    v_mul_f32 v39, v20, v30
    v_mul_f32 v40, v21, v29
    v_mul_f32 v41, v22, v28
    v_and_b32 v42, s17, v166
    v_cvt_pk_bf16_f32 v32, 0, v32
    v_cvt_pk_bf16_f32 v33, 0, v33
    v_cvt_pk_bf16_f32 v34, 0, v34
    v_cvt_pk_bf16_f32 v35, 0, v35
    v_cvt_pk_bf16_f32 v38, 0, v38
    v_cvt_pk_bf16_f32 v39, 0, v39
    v_cvt_pk_bf16_f32 v40, 0, v40
    v_cvt_pk_bf16_f32 v41, 0, v41
    v_add_f32 v32, v32, v33
    v_add_f32 v38, v38, v39
    v_cvt_pk_bf16_f32 v32, 0, v32
    v_cvt_pk_bf16_f32 v38, 0, v38
    v_add_f32 v32, v32, v34
    v_add_f32 v38, v38, v40
    v_cvt_pk_bf16_f32 v32, 0, v32
    v_cvt_pk_bf16_f32 v38, 0, v38
    v_add_f32 v32, v32, v35
    v_add_f32 v38, v38, v41
    v_cvt_pk_bf16_f32 v32, 0, v32
    v_cvt_pk_bf16_f32 v38, 0, v38
    v_mul_f32 v46, v32, v36
    v_mul_f32 v47, v38, v42
    v_cvt_pk_bf16_f32 v54, v47, v46
    v_cvt_pk_bf16_f32 v55, v45, v44
    s_mov_b32 s18, 20480
    buffer_store_dwordx2 v[54:55], v11, s[32:35], s18 offen sc1
    v_lshlrev_b32 v16, 16, v127
    v_lshlrev_b32 v17, 16, v131
    v_lshlrev_b32 v18, 16, v135
    v_lshlrev_b32 v19, 16, v139
    v_lshlrev_b32 v20, 16, v143
    v_lshlrev_b32 v21, 16, v147
    v_lshlrev_b32 v22, 16, v151
    v_lshlrev_b32 v28, 16, v180
    v_and_b32 v29, s17, v180
    v_lshlrev_b32 v30, 16, v181
    v_and_b32 v31, s17, v181
    v_mul_f32 v32, v16, v31
    v_mul_f32 v33, v17, v30
    v_mul_f32 v34, v18, v29
    v_mul_f32 v35, v19, v28
    v_lshlrev_b32 v36, 16, v155
    v_mul_f32 v38, v17, v31
    v_mul_f32 v39, v18, v30
    v_mul_f32 v40, v19, v29
    v_mul_f32 v41, v20, v28
    v_lshlrev_b32 v42, 16, v159
    v_cvt_pk_bf16_f32 v32, 0, v32
    v_cvt_pk_bf16_f32 v33, 0, v33
    v_cvt_pk_bf16_f32 v34, 0, v34
    v_cvt_pk_bf16_f32 v35, 0, v35
    v_cvt_pk_bf16_f32 v38, 0, v38
    v_cvt_pk_bf16_f32 v39, 0, v39
    v_cvt_pk_bf16_f32 v40, 0, v40
    v_cvt_pk_bf16_f32 v41, 0, v41
    v_add_f32 v32, v32, v33
    v_add_f32 v38, v38, v39
    v_cvt_pk_bf16_f32 v32, 0, v32
    v_cvt_pk_bf16_f32 v38, 0, v38
    v_add_f32 v32, v32, v34
    v_add_f32 v38, v38, v40
    v_cvt_pk_bf16_f32 v32, 0, v32
    v_cvt_pk_bf16_f32 v38, 0, v38
    v_add_f32 v32, v32, v35
    v_add_f32 v38, v38, v41
    v_cvt_pk_bf16_f32 v32, 0, v32
    v_cvt_pk_bf16_f32 v38, 0, v38
    v_mul_f32 v44, v32, v36
    v_mul_f32 v45, v38, v42
    v_mul_f32 v32, v18, v31
    v_mul_f32 v33, v19, v30
    v_mul_f32 v34, v20, v29
    v_mul_f32 v35, v21, v28
    v_lshlrev_b32 v36, 16, v163
    v_mul_f32 v38, v19, v31
    v_mul_f32 v39, v20, v30
    v_mul_f32 v40, v21, v29
    v_mul_f32 v41, v22, v28
    v_lshlrev_b32 v42, 16, v167
    v_cvt_pk_bf16_f32 v32, 0, v32
    v_cvt_pk_bf16_f32 v33, 0, v33
    v_cvt_pk_bf16_f32 v34, 0, v34
    v_cvt_pk_bf16_f32 v35, 0, v35
    v_cvt_pk_bf16_f32 v38, 0, v38
    v_cvt_pk_bf16_f32 v39, 0, v39
    v_cvt_pk_bf16_f32 v40, 0, v40
    v_cvt_pk_bf16_f32 v41, 0, v41
    v_add_f32 v32, v32, v33
    v_add_f32 v38, v38, v39
    v_cvt_pk_bf16_f32 v32, 0, v32
    v_cvt_pk_bf16_f32 v38, 0, v38
    v_add_f32 v32, v32, v34
    v_add_f32 v38, v38, v40
    v_cvt_pk_bf16_f32 v32, 0, v32
    v_cvt_pk_bf16_f32 v38, 0, v38
    v_add_f32 v32, v32, v35
    v_add_f32 v38, v38, v41
    v_cvt_pk_bf16_f32 v32, 0, v32
    v_cvt_pk_bf16_f32 v38, 0, v38
    v_mul_f32 v46, v32, v36
    v_mul_f32 v47, v38, v42
    v_cvt_pk_bf16_f32 v56, v47, v46
    v_cvt_pk_bf16_f32 v57, v45, v44
    s_mov_b32 s18, 24576
    buffer_store_dwordx2 v[56:57], v11, s[32:35], s18 offen sc1
    v_and_b32 v16, s17, v127
    v_and_b32 v17, s17, v131
    v_and_b32 v18, s17, v135
    v_and_b32 v19, s17, v139
    v_and_b32 v20, s17, v143
    v_and_b32 v21, s17, v147
    v_and_b32 v22, s17, v151
    v_lshlrev_b32 v28, 16, v182
    v_and_b32 v29, s17, v182
    v_lshlrev_b32 v30, 16, v183
    v_and_b32 v31, s17, v183
    v_mul_f32 v32, v16, v31
    v_mul_f32 v33, v17, v30
    v_mul_f32 v34, v18, v29
    v_mul_f32 v35, v19, v28
    v_and_b32 v36, s17, v155
    v_mul_f32 v38, v17, v31
    v_mul_f32 v39, v18, v30
    v_mul_f32 v40, v19, v29
    v_mul_f32 v41, v20, v28
    v_and_b32 v42, s17, v159
    v_cvt_pk_bf16_f32 v32, 0, v32
    v_cvt_pk_bf16_f32 v33, 0, v33
    v_cvt_pk_bf16_f32 v34, 0, v34
    v_cvt_pk_bf16_f32 v35, 0, v35
    v_cvt_pk_bf16_f32 v38, 0, v38
    v_cvt_pk_bf16_f32 v39, 0, v39
    v_cvt_pk_bf16_f32 v40, 0, v40
    v_cvt_pk_bf16_f32 v41, 0, v41
    v_add_f32 v32, v32, v33
    v_add_f32 v38, v38, v39
    v_cvt_pk_bf16_f32 v32, 0, v32
    v_cvt_pk_bf16_f32 v38, 0, v38
    v_add_f32 v32, v32, v34
    v_add_f32 v38, v38, v40
    v_cvt_pk_bf16_f32 v32, 0, v32
    v_cvt_pk_bf16_f32 v38, 0, v38
    v_add_f32 v32, v32, v35
    v_add_f32 v38, v38, v41
    v_cvt_pk_bf16_f32 v32, 0, v32
    v_cvt_pk_bf16_f32 v38, 0, v38
    v_mul_f32 v44, v32, v36
    v_mul_f32 v45, v38, v42
    v_mul_f32 v32, v18, v31
    v_mul_f32 v33, v19, v30
    v_mul_f32 v34, v20, v29
    v_mul_f32 v35, v21, v28
    v_and_b32 v36, s17, v163
    v_mul_f32 v38, v19, v31
    v_mul_f32 v39, v20, v30
    v_mul_f32 v40, v21, v29
    v_mul_f32 v41, v22, v28
    v_and_b32 v42, s17, v167
    v_cvt_pk_bf16_f32 v32, 0, v32
    v_cvt_pk_bf16_f32 v33, 0, v33
    v_cvt_pk_bf16_f32 v34, 0, v34
    v_cvt_pk_bf16_f32 v35, 0, v35
    v_cvt_pk_bf16_f32 v38, 0, v38
    v_cvt_pk_bf16_f32 v39, 0, v39
    v_cvt_pk_bf16_f32 v40, 0, v40
    v_cvt_pk_bf16_f32 v41, 0, v41
    v_add_f32 v32, v32, v33
    v_add_f32 v38, v38, v39
    v_cvt_pk_bf16_f32 v32, 0, v32
    v_cvt_pk_bf16_f32 v38, 0, v38
    v_add_f32 v32, v32, v34
    v_add_f32 v38, v38, v40
    v_cvt_pk_bf16_f32 v32, 0, v32
    v_cvt_pk_bf16_f32 v38, 0, v38
    v_add_f32 v32, v32, v35
    v_add_f32 v38, v38, v41
    v_cvt_pk_bf16_f32 v32, 0, v32
    v_cvt_pk_bf16_f32 v38, 0, v38
    v_mul_f32 v46, v32, v36
    v_mul_f32 v47, v38, v42
    v_cvt_pk_bf16_f32 v58, v47, v46
    v_cvt_pk_bf16_f32 v59, v45, v44
    s_mov_b32 s18, 28672
    buffer_store_dwordx2 v[58:59], v11, s[32:35], s18 offen sc1
.a1done_5:
    s_load_dwordx2 s[4:5], s[0:1], 32
    s_load_dwordx2 s[6:7], s[0:1], 64
    s_load_dwordx2 s[8:9], s[0:1], 0
    s_sub_u32 s3, s2, 160
    v_lshlrev_b32 v1, 4, v0
    s_lshl_b32 s3, s3, 12
    v_add_u32 v1, s3, v1
    s_waitcnt lgkmcnt(0)
    s_mov_b32 s20, s4
    s_mov_b32 s21, s5
    s_mov_b32 s22, 0x280000
    s_mov_b32 s23, 0x00020000
    s_mov_b32 s24, 0
.pfl_6:
    buffer_load_dwordx4 v[4:7], v1, s[20:23], s24 offen
    s_add_u32 s24, s24, 393216
    buffer_load_dwordx4 v[8:11], v1, s[20:23], s24 offen
    s_add_u32 s24, s24, 393216
    buffer_load_dwordx4 v[12:15], v1, s[20:23], s24 offen
    s_add_u32 s24, s24, 393216
    buffer_load_dwordx4 v[16:19], v1, s[20:23], s24 offen
    s_add_u32 s24, s24, 393216
    s_waitcnt vmcnt(24)
    s_cmp_lt_u32 s24, 2752512
    s_cbranch_scc1 .pfl_6
    s_mov_b32 s20, s6
    s_mov_b32 s21, s7
    s_mov_b32 s22, 0xc8000
    s_mov_b32 s23, 0x00020000
    s_mov_b32 s24, 0
.pfl_7:
    buffer_load_dwordx4 v[4:7], v1, s[20:23], s24 offen
    s_add_u32 s24, s24, 393216
    buffer_load_dwordx4 v[8:11], v1, s[20:23], s24 offen
    s_add_u32 s24, s24, 393216
    buffer_load_dwordx4 v[12:15], v1, s[20:23], s24 offen
    s_add_u32 s24, s24, 393216
    buffer_load_dwordx4 v[16:19], v1, s[20:23], s24 offen
    s_add_u32 s24, s24, 393216
    s_waitcnt vmcnt(24)
    s_cmp_lt_u32 s24, 1179648
    s_cbranch_scc1 .pfl_7
    s_mov_b32 s20, s8
    s_mov_b32 s21, s9
    s_mov_b32 s22, 0x280000
    s_mov_b32 s23, 0x00020000
    s_mov_b32 s24, 0
.pfl_8:
    buffer_load_dwordx4 v[4:7], v1, s[20:23], s24 offen
    s_add_u32 s24, s24, 393216
    buffer_load_dwordx4 v[8:11], v1, s[20:23], s24 offen
    s_add_u32 s24, s24, 393216
    buffer_load_dwordx4 v[12:15], v1, s[20:23], s24 offen
    s_add_u32 s24, s24, 393216
    buffer_load_dwordx4 v[16:19], v1, s[20:23], s24 offen
    s_add_u32 s24, s24, 393216
    s_waitcnt vmcnt(24)
    s_cmp_lt_u32 s24, 2752512
    s_cbranch_scc1 .pfl_8
.end_1:
    s_endpgm
.globl k2_kernel
.p2align 8
.type k2_kernel,@function
k2_kernel:
    s_cmp_ge_u32 s2, 1152
    s_cbranch_scc1 .end_10
    s_cmp_lt_u32 s2, 512
    s_cbranch_scc1 .attn_9
    s_sub_u32 s3, s2, 512
    s_setprio 2
    s_load_dwordx4 s[4:7], s[0:1], 32
    s_load_dwordx2 s[8:9], s[0:1], 88
    v_lshrrev_b32 v1, 6, v0
    v_and_b32 v2, 63, v0
    s_nop 0
    v_readfirstlane_b32 s12, v1
    s_lshl_b32 s16, s3, 12
    v_lshlrev_b32 v4, 4, v0
    s_waitcnt lgkmcnt(0)
    s_lshl_b32 s18, s3, 1
    s_and_b32 s18, s18, 0xfffffffc
    s_load_dword s19, s[6:7], s18
    s_mov_b32 s20, s4
    s_mov_b32 s21, s5
    s_mov_b32 s22, 0x280000
    s_mov_b32 s23, 0x00020000
    s_mov_b32 s24, s8
    s_mov_b32 s25, s9
    s_mov_b32 s26, 0x280000
    s_mov_b32 s27, 0x00020000
    s_add_u32 s28, s8, 0xc80000
    s_addc_u32 s29, s9, 0
    s_mov_b32 s30, 0x280000
    s_mov_b32 s31, 0x00020000
    buffer_load_dwordx4 v[8:11], v4, s[20:23], s16 offen offset:0
    buffer_load_dwordx4 v[12:15], v4, s[20:23], s16 offen offset:4
    buffer_load_dwordx4 v[16:19], v4, s[20:23], s16 offen offset:8
    buffer_load_dwordx4 v[20:23], v4, s[24:27], s16 offen
    v_mov_b32 v44, 0
    v_mov_b32 v45, 0
    v_mov_b32 v46, 0
    v_mov_b32 v47, 0
    v_cmp_gt_u32 vcc, 30, v0
    s_and_saveexec_b64 s[32:33], vcc
    ds_write_b128 v4, v[44:47] offset:20736
    s_mov_b64 exec, s[32:33]
    v_and_b32 v6, 15, v2
    v_lshrrev_b32 v7, 4, v2
    v_add_u32 v32, 1, v6
    v_and_b32 v33, 3, v32
    v_mul_u32_u24 v33, 4160, v33
    v_lshrrev_b32 v32, 2, v32
    v_lshl_add_u32 v33, v32, 3, v33
    v_lshl_add_u32 v33, v7, 4, v33
    s_lshl_b32 s35, s12, 7
    v_add_u32 v3, s35, v33
    v_lshlrev_b32 v32, 5, v6
    v_sub_u32 v32, 17120, v32
    v_lshl_add_u32 v32, v7, 4, v32
    v_add_u32 v5, s35, v32
    s_waitcnt vmcnt(0)
    v_alignbyte_b32 v24, v12, v8, 2
    v_alignbyte_b32 v25, v13, v9, 2
    v_alignbyte_b32 v26, v14, v10, 2
    v_alignbyte_b32 v27, v15, v11, 2
    v_alignbyte_b32 v28, v16, v12, 2
    v_alignbyte_b32 v29, v17, v13, 2
    v_alignbyte_b32 v30, v18, v14, 2
    v_alignbyte_b32 v31, v19, v15, 2
    ds_write_b128 v4, v[8:11] offset:32
    ds_write_b128 v4, v[24:27] offset:4192
    ds_write_b128 v4, v[12:15] offset:8352
    ds_write_b128 v4, v[28:31] offset:12512
    ds_write_b128 v4, v[20:23] offset:16640
    v_cmp_eq_u32 vcc, 0, v0
    s_and_saveexec_b64 s[32:33], vcc
    v_lshlrev_b32 v34, 16, v8
    v_alignbyte_b32 v35, v9, v8, 2
    ds_write_b128 v4, v[44:47] offset:0
    ds_write_b128 v4, v[44:47] offset:4160
    ds_write_b128 v4, v[44:47] offset:8320
    ds_write_b128 v4, v[44:47] offset:12480
    ds_write_b128 v4, v[44:47] offset:16
    v_mov_b32 v36, 0
    v_mov_b32 v37, 0
    v_mov_b32 v38, 0
    v_mov_b32 v39, v34
    ds_write_b128 v4, v[36:39] offset:4176
    v_mov_b32 v40, 0
    v_mov_b32 v41, 0
    v_mov_b32 v42, 0
    v_mov_b32 v43, v8
    ds_write_b128 v4, v[40:43] offset:8336
    v_mov_b32 v48, 0
    v_mov_b32 v49, 0
    v_mov_b32 v50, v34
    v_mov_b32 v51, v35
    ds_write_b128 v4, v[48:51] offset:12496
    s_mov_b64 exec, s[32:33]
    s_waitcnt lgkmcnt(0)
    s_barrier
    v_lshlrev_b32 v14, 5, v6
    v_lshl_add_u32 v14, v7, 3, v14
    v_sub_u32 v15, 20216, v14
    s_lshl_b32 s36, s12, 10
    v_subrev_u32 v15, s36, v15
    ds_read_b64 v[112:113], v15 offset:512
    ds_read_b64 v[114:115], v15 offset:0
    ds_read_b64 v[48:49], v3 offset:0
    ds_read_b64 v[50:51], v3 offset:8
    ds_read_b128 v[80:83], v5 offset:3584
    ds_read_b128 v[84:87], v5 offset:3072
    ds_read_b128 v[88:91], v5 offset:2560
    ds_read_b128 v[92:95], v5 offset:2048
    ds_read_b128 v[96:99], v5 offset:1536
    ds_read_b128 v[100:103], v5 offset:1024
    ds_read_b128 v[104:107], v5 offset:512
    ds_read_b128 v[108:111], v5 offset:0
    ds_read_b64 v[52:53], v3 offset:512
    ds_read_b64 v[54:55], v3 offset:520
    ds_read_b64 v[56:57], v3 offset:1024
    ds_read_b64 v[58:59], v3 offset:1032
    ds_read_b64 v[60:61], v3 offset:1536
    ds_read_b64 v[62:63], v3 offset:1544
    ds_read_b64 v[64:65], v3 offset:2048
    ds_read_b64 v[66:67], v3 offset:2056
    ds_read_b64 v[68:69], v3 offset:2560
    ds_read_b64 v[70:71], v3 offset:2568
    ds_read_b64 v[72:73], v3 offset:3072
    ds_read_b64 v[74:75], v3 offset:3080
    ds_read_b64 v[76:77], v3 offset:3584
    ds_read_b64 v[78:79], v3 offset:3592
    s_waitcnt lgkmcnt(14)
    v_mfma_f32_16x16x32_bf16 v[16:19], v[48:51], v[80:83], 0
    v_mfma_f32_16x16x32_bf16 v[20:23], v[48:51], v[84:87], 0
    v_mfma_f32_16x16x32_bf16 v[24:27], v[48:51], v[88:91], 0
    v_mfma_f32_16x16x32_bf16 v[28:31], v[48:51], v[92:95], 0
    v_mfma_f32_16x16x32_bf16 v[32:35], v[48:51], v[96:99], 0
    v_mfma_f32_16x16x32_bf16 v[36:39], v[48:51], v[100:103], 0
    v_mfma_f32_16x16x32_bf16 v[40:43], v[48:51], v[104:107], 0
    v_mfma_f32_16x16x32_bf16 v[44:47], v[48:51], v[108:111], 0
    ds_read_b64 v[48:49], v3 offset:64
    ds_read_b64 v[50:51], v3 offset:72
    ds_read_b128 v[108:111], v5 offset:64
    s_waitcnt lgkmcnt(15)
    v_mfma_f32_16x16x32_bf16 v[20:23], v[52:55], v[80:83], v[20:23]
    v_mfma_f32_16x16x32_bf16 v[24:27], v[52:55], v[84:87], v[24:27]
    v_mfma_f32_16x16x32_bf16 v[28:31], v[52:55], v[88:91], v[28:31]
    v_mfma_f32_16x16x32_bf16 v[32:35], v[52:55], v[92:95], v[32:35]
    v_mfma_f32_16x16x32_bf16 v[36:39], v[52:55], v[96:99], v[36:39]
    v_mfma_f32_16x16x32_bf16 v[40:43], v[52:55], v[100:103], v[40:43]
    v_mfma_f32_16x16x32_bf16 v[44:47], v[52:55], v[104:107], v[44:47]
    ds_read_b64 v[52:53], v3 offset:576
    ds_read_b64 v[54:55], v3 offset:584
    ds_read_b128 v[104:107], v5 offset:576
    s_waitcnt lgkmcnt(15)
    v_mfma_f32_16x16x32_bf16 v[24:27], v[56:59], v[80:83], v[24:27]
    v_mfma_f32_16x16x32_bf16 v[28:31], v[56:59], v[84:87], v[28:31]
    v_mfma_f32_16x16x32_bf16 v[32:35], v[56:59], v[88:91], v[32:35]
    v_mfma_f32_16x16x32_bf16 v[36:39], v[56:59], v[92:95], v[36:39]
    v_mfma_f32_16x16x32_bf16 v[40:43], v[56:59], v[96:99], v[40:43]
    v_mfma_f32_16x16x32_bf16 v[44:47], v[56:59], v[100:103], v[44:47]
    ds_read_b64 v[56:57], v3 offset:1088
    ds_read_b64 v[58:59], v3 offset:1096
    ds_read_b128 v[100:103], v5 offset:1088
    s_waitcnt lgkmcnt(15)
    v_mfma_f32_16x16x32_bf16 v[28:31], v[60:63], v[80:83], v[28:31]
    v_mfma_f32_16x16x32_bf16 v[32:35], v[60:63], v[84:87], v[32:35]
    v_mfma_f32_16x16x32_bf16 v[36:39], v[60:63], v[88:91], v[36:39]
    v_mfma_f32_16x16x32_bf16 v[40:43], v[60:63], v[92:95], v[40:43]
    v_mfma_f32_16x16x32_bf16 v[44:47], v[60:63], v[96:99], v[44:47]
    ds_read_b64 v[60:61], v3 offset:1600
    ds_read_b64 v[62:63], v3 offset:1608
    ds_read_b128 v[96:99], v5 offset:1600
    s_waitcnt lgkmcnt(15)
    v_mfma_f32_16x16x32_bf16 v[32:35], v[64:67], v[80:83], v[32:35]
    v_mfma_f32_16x16x32_bf16 v[36:39], v[64:67], v[84:87], v[36:39]
    v_mfma_f32_16x16x32_bf16 v[40:43], v[64:67], v[88:91], v[40:43]
    v_mfma_f32_16x16x32_bf16 v[44:47], v[64:67], v[92:95], v[44:47]
    ds_read_b64 v[64:65], v3 offset:2112
    ds_read_b64 v[66:67], v3 offset:2120
    ds_read_b128 v[92:95], v5 offset:2112
    s_waitcnt lgkmcnt(15)
    v_mfma_f32_16x16x32_bf16 v[36:39], v[68:71], v[80:83], v[36:39]
    v_mfma_f32_16x16x32_bf16 v[40:43], v[68:71], v[84:87], v[40:43]
    v_mfma_f32_16x16x32_bf16 v[44:47], v[68:71], v[88:91], v[44:47]
    ds_read_b64 v[68:69], v3 offset:2624
    ds_read_b64 v[70:71], v3 offset:2632
    ds_read_b128 v[88:91], v5 offset:2624
    s_waitcnt lgkmcnt(15)
    v_mfma_f32_16x16x32_bf16 v[40:43], v[72:75], v[80:83], v[40:43]
    v_mfma_f32_16x16x32_bf16 v[44:47], v[72:75], v[84:87], v[44:47]
    ds_read_b64 v[72:73], v3 offset:3136
    ds_read_b64 v[74:75], v3 offset:3144
    ds_read_b128 v[84:87], v5 offset:3136
    s_waitcnt lgkmcnt(15)
    v_mfma_f32_16x16x32_bf16 v[44:47], v[76:79], v[80:83], v[44:47]
    ds_read_b64 v[76:77], v3 offset:3648
    ds_read_b64 v[78:79], v3 offset:3656
    ds_read_b128 v[80:83], v5 offset:3648
    s_waitcnt lgkmcnt(15)
    v_mfma_f32_16x16x32_bf16 v[44:47], v[48:51], v[108:111], v[44:47]
    s_waitcnt lgkmcnt(15)
    v_mfma_f32_16x16x32_bf16 v[40:43], v[48:51], v[104:107], v[40:43]
    v_mfma_f32_16x16x32_bf16 v[44:47], v[52:55], v[104:107], v[44:47]
    s_waitcnt lgkmcnt(15)
    v_mfma_f32_16x16x32_bf16 v[36:39], v[48:51], v[100:103], v[36:39]
    v_mfma_f32_16x16x32_bf16 v[40:43], v[52:55], v[100:103], v[40:43]
    v_mfma_f32_16x16x32_bf16 v[44:47], v[56:59], v[100:103], v[44:47]
    s_waitcnt lgkmcnt(12)
    v_mfma_f32_16x16x32_bf16 v[32:35], v[48:51], v[96:99], v[32:35]
    v_mfma_f32_16x16x32_bf16 v[36:39], v[52:55], v[96:99], v[36:39]
    v_mfma_f32_16x16x32_bf16 v[40:43], v[56:59], v[96:99], v[40:43]
    v_mfma_f32_16x16x32_bf16 v[44:47], v[60:63], v[96:99], v[44:47]
    s_waitcnt lgkmcnt(9)
    v_mfma_f32_16x16x32_bf16 v[28:31], v[48:51], v[92:95], v[28:31]
    v_mfma_f32_16x16x32_bf16 v[32:35], v[52:55], v[92:95], v[32:35]
    v_mfma_f32_16x16x32_bf16 v[36:39], v[56:59], v[92:95], v[36:39]
    v_mfma_f32_16x16x32_bf16 v[40:43], v[60:63], v[92:95], v[40:43]
    v_mfma_f32_16x16x32_bf16 v[44:47], v[64:67], v[92:95], v[44:47]
    s_waitcnt lgkmcnt(6)
    v_mfma_f32_16x16x32_bf16 v[24:27], v[48:51], v[88:91], v[24:27]
    v_mfma_f32_16x16x32_bf16 v[28:31], v[52:55], v[88:91], v[28:31]
    v_mfma_f32_16x16x32_bf16 v[32:35], v[56:59], v[88:91], v[32:35]
    v_mfma_f32_16x16x32_bf16 v[36:39], v[60:63], v[88:91], v[36:39]
    v_mfma_f32_16x16x32_bf16 v[40:43], v[64:67], v[88:91], v[40:43]
    v_mfma_f32_16x16x32_bf16 v[44:47], v[68:71], v[88:91], v[44:47]
    s_waitcnt lgkmcnt(3)
    v_mfma_f32_16x16x32_bf16 v[20:23], v[48:51], v[84:87], v[20:23]
    v_mfma_f32_16x16x32_bf16 v[24:27], v[52:55], v[84:87], v[24:27]
    v_mfma_f32_16x16x32_bf16 v[28:31], v[56:59], v[84:87], v[28:31]
    v_mfma_f32_16x16x32_bf16 v[32:35], v[60:63], v[84:87], v[32:35]
    v_mfma_f32_16x16x32_bf16 v[36:39], v[64:67], v[84:87], v[36:39]
    v_mfma_f32_16x16x32_bf16 v[40:43], v[68:71], v[84:87], v[40:43]
    v_mfma_f32_16x16x32_bf16 v[44:47], v[72:75], v[84:87], v[44:47]
    s_waitcnt lgkmcnt(0)
    v_mfma_f32_16x16x32_bf16 v[16:19], v[48:51], v[80:83], v[16:19]
    v_mfma_f32_16x16x32_bf16 v[20:23], v[52:55], v[80:83], v[20:23]
    v_mfma_f32_16x16x32_bf16 v[24:27], v[56:59], v[80:83], v[24:27]
    v_mfma_f32_16x16x32_bf16 v[28:31], v[60:63], v[80:83], v[28:31]
    v_mfma_f32_16x16x32_bf16 v[32:35], v[64:67], v[80:83], v[32:35]
    v_mfma_f32_16x16x32_bf16 v[36:39], v[68:71], v[80:83], v[36:39]
    v_mfma_f32_16x16x32_bf16 v[40:43], v[72:75], v[80:83], v[40:43]
    v_mfma_f32_16x16x32_bf16 v[44:47], v[76:79], v[80:83], v[44:47]
    s_barrier
    v_lshlrev_b32 v11, 4, v2
    s_cmp_eq_u32 s12, 1
    s_cbranch_scc1 .cvw_13
    s_cmp_eq_u32 s12, 2
    s_cbranch_scc1 .cvw_14
    s_cmp_eq_u32 s12, 3
    s_cbranch_scc1 .cvw_15
.cvw_12:
    s_nop 3
    ds_write_b128 v11, v[24:27] offset:6144
    ds_write_b128 v11, v[28:31] offset:7168
    ds_write_b128 v11, v[32:35] offset:12288
    ds_write_b128 v11, v[36:39] offset:13312
    ds_write_b128 v11, v[40:43] offset:18432
    ds_write_b128 v11, v[44:47] offset:19456
    s_branch .cvj_11
.cvw_13:
    s_nop 3
    ds_write_b128 v11, v[16:19] offset:0
    ds_write_b128 v11, v[20:23] offset:1024
    ds_write_b128 v11, v[32:35] offset:14336
    ds_write_b128 v11, v[36:39] offset:15360
    ds_write_b128 v11, v[40:43] offset:20480
    ds_write_b128 v11, v[44:47] offset:21504
    v_mov_b32 v16, v24
    v_mov_b32 v17, v25
    v_mov_b32 v18, v26
    v_mov_b32 v19, v27
    v_mov_b32 v20, v28
    v_mov_b32 v21, v29
    v_mov_b32 v22, v30
    v_mov_b32 v23, v31
    s_branch .cvj_11
.cvw_14:
    s_nop 3
    ds_write_b128 v11, v[16:19] offset:2048
    ds_write_b128 v11, v[20:23] offset:3072
    ds_write_b128 v11, v[24:27] offset:8192
    ds_write_b128 v11, v[28:31] offset:9216
    ds_write_b128 v11, v[40:43] offset:22528
    ds_write_b128 v11, v[44:47] offset:23552
    v_mov_b32 v16, v32
    v_mov_b32 v17, v33
    v_mov_b32 v18, v34
    v_mov_b32 v19, v35
    v_mov_b32 v20, v36
    v_mov_b32 v21, v37
    v_mov_b32 v22, v38
    v_mov_b32 v23, v39
    s_branch .cvj_11
.cvw_15:
    s_nop 3
    ds_write_b128 v11, v[16:19] offset:4096
    ds_write_b128 v11, v[20:23] offset:5120
    ds_write_b128 v11, v[24:27] offset:10240
    ds_write_b128 v11, v[28:31] offset:11264
    ds_write_b128 v11, v[32:35] offset:16384
    ds_write_b128 v11, v[36:39] offset:17408
    v_mov_b32 v16, v40
    v_mov_b32 v17, v41
    v_mov_b32 v18, v42
    v_mov_b32 v19, v43
    v_mov_b32 v20, v44
    v_mov_b32 v21, v45
    v_mov_b32 v22, v46
    v_mov_b32 v23, v47
.cvj_11:
    s_mul_i32 s36, s12, 6144
    v_add_u32 v11, s36, v11
    s_waitcnt lgkmcnt(0)
    s_barrier
    ds_read_b128 v[48:51], v11 offset:0
    ds_read_b128 v[52:55], v11 offset:1024
    ds_read_b128 v[56:59], v11 offset:2048
    ds_read_b128 v[60:63], v11 offset:3072
    ds_read_b128 v[64:67], v11 offset:4096
    ds_read_b128 v[68:71], v11 offset:5120
    s_and_b32 s18, s3, 1
    s_lshl_b32 s18, s18, 4
    s_lshr_b32 s19, s19, s18
    s_lshl_b32 s19, s19, 16
    s_mov_b32 s37, 0xffff0000
    s_lshl_b32 s36, s12, 10
    s_add_u32 s36, s36, s16
    v_and_b32 v72, s37, v113
    v_lshlrev_b32 v73, 16, v113
    v_and_b32 v74, s37, v112
    v_lshlrev_b32 v75, 16, v112
    v_mul_f32 v72, s19, v72
    v_mul_f32 v73, s19, v73
    v_mul_f32 v74, s19, v74
    v_mul_f32 v75, s19, v75
    v_cvt_pk_bf16_f32 v72, 0, v72
    v_cvt_pk_bf16_f32 v73, 0, v73
    v_cvt_pk_bf16_f32 v74, 0, v74
    v_cvt_pk_bf16_f32 v75, 0, v75
    v_and_b32 v76, s37, v115
    v_lshlrev_b32 v77, 16, v115
    v_and_b32 v78, s37, v114
    v_lshlrev_b32 v79, 16, v114
    v_mul_f32 v76, s19, v76
    v_mul_f32 v77, s19, v77
    v_mul_f32 v78, s19, v78
    v_mul_f32 v79, s19, v79
    v_cvt_pk_bf16_f32 v76, 0, v76
    v_cvt_pk_bf16_f32 v77, 0, v77
    v_cvt_pk_bf16_f32 v78, 0, v78
    v_cvt_pk_bf16_f32 v79, 0, v79
    s_waitcnt lgkmcnt(0)
    v_add_f32 v16, v16, v48
    v_add_f32 v17, v17, v49
    v_add_f32 v18, v18, v50
    v_add_f32 v19, v19, v51
    v_add_f32 v16, v16, v56
    v_add_f32 v17, v17, v57
    v_add_f32 v18, v18, v58
    v_add_f32 v19, v19, v59
    v_add_f32 v16, v16, v64
    v_add_f32 v17, v17, v65
    v_add_f32 v18, v18, v66
    v_add_f32 v19, v19, v67
    v_cvt_pk_bf16_f32 v16, 0, v16
    v_cvt_pk_bf16_f32 v17, 0, v17
    v_cvt_pk_bf16_f32 v18, 0, v18
    v_cvt_pk_bf16_f32 v19, 0, v19
    v_add_f32 v16, v16, v72
    v_add_f32 v17, v17, v73
    v_add_f32 v18, v18, v74
    v_add_f32 v19, v19, v75
    v_cvt_pk_bf16_f32 v16, v16, v17
    v_cvt_pk_bf16_f32 v17, v18, v19
    buffer_store_dwordx2 v[16:17], v14, s[28:31], s36 offen offset:0 sc1
    v_add_f32 v20, v20, v52
    v_add_f32 v21, v21, v53
    v_add_f32 v22, v22, v54
    v_add_f32 v23, v23, v55
    v_add_f32 v20, v20, v60
    v_add_f32 v21, v21, v61
    v_add_f32 v22, v22, v62
    v_add_f32 v23, v23, v63
    v_add_f32 v20, v20, v68
    v_add_f32 v21, v21, v69
    v_add_f32 v22, v22, v70
    v_add_f32 v23, v23, v71
    v_cvt_pk_bf16_f32 v20, 0, v20
    v_cvt_pk_bf16_f32 v21, 0, v21
    v_cvt_pk_bf16_f32 v22, 0, v22
    v_cvt_pk_bf16_f32 v23, 0, v23
    v_add_f32 v20, v20, v76
    v_add_f32 v21, v21, v77
    v_add_f32 v22, v22, v78
    v_add_f32 v23, v23, v79
    v_cvt_pk_bf16_f32 v20, v20, v21
    v_cvt_pk_bf16_f32 v21, v22, v23
    buffer_store_dwordx2 v[20:21], v14, s[28:31], s36 offen offset:512 sc1
    s_endpgm
.attn_9:
    s_and_b32 s4, s2, 7
    s_lshr_b32 s5, s2, 3
    s_lshr_b32 s10, s5, 4
    s_lshl_b32 s10, s10, 3
    s_add_u32 s10, s10, s4
    s_and_b32 s11, s5, 15
    s_load_dwordx2 s[8:9], s[0:1], 88
    v_lshrrev_b32 v1, 6, v0
    v_and_b32 v2, 63, v0
    s_nop 0
    v_readfirstlane_b32 s12, v1
    s_lshl_b32 s13, s11, 7
    s_sub_u32 s14, s13, 256
    s_waitcnt lgkmcnt(0)
    s_add_u32 s20, s8, 0x280000
    s_addc_u32 s21, s9, 0
    s_mov_b32 s22, 0x500000
    s_mov_b32 s23, 0x00020000
    s_add_u32 s24, s8, 0x780000
    s_addc_u32 s25, s9, 0
    s_mov_b32 s26, 0x280000
    s_mov_b32 s27, 0x00020000
    s_add_u32 s28, s8, 0xa00000
    s_addc_u32 s29, s9, 0
    s_mov_b32 s30, 0x280000
    s_mov_b32 s31, 0x00020000
    s_mul_i32 s15, s10, 5
    s_add_u32 s16, s15, 160
    s_lshl_b32 s16, s16, 14
    s_lshl_b32 s17, s14, 3
    s_add_u32 s16, s16, s17
    v_lshlrev_b32 v3, 4, v0
    s_cmp_eq_u32 s12, 3
    s_cbranch_scc1 .atk_16
    s_add_u32 s17, s16, 0
    buffer_load_dwordx4 v[72:75], v3, s[20:23], s17 offen
    s_add_u32 s17, s16, 16384
    buffer_load_dwordx4 v[76:79], v3, s[20:23], s17 offen
    s_add_u32 s17, s16, 32768
    buffer_load_dwordx4 v[80:83], v3, s[20:23], s17 offen
    s_add_u32 s17, s16, 49152
    buffer_load_dwordx4 v[84:87], v3, s[20:23], s17 offen
    s_add_u32 s17, s16, 65536
    buffer_load_dwordx4 v[88:91], v3, s[20:23], s17 offen
.atk_16:
    v_mul_u32_u24 v4, 0x667, v0
    v_lshrrev_b32 v4, 16, v4
    v_mul_u32_u24 v5, 40, v4
    v_sub_u32 v5, v0, v5
    s_ashr_i32 s17, s14, 4
    v_add_u32 v6, s17, v4
    s_movk_i32 s18, 20480
    v_mul_lo_u32 v6, v6, s18
    s_mul_i32 s18, s10, 640
    v_lshl_add_u32 v6, v5, 4, v6
    v_add_u32 v6, s18, v6
    v_mul_u32_u24 v7, 1008, v4
    v_lshrrev_b32 v8, 1, v5
    v_mul_u32_u24 v8, 48, v8
    v_add_u32 v7, v7, v8
    v_and_b32 v8, 1, v5
    v_lshl_add_u32 v7, v8, 4, v7
    v_cmp_gt_u32 vcc, 240, v0
    s_and_saveexec_b64 s[32:33], vcc
    buffer_load_dwordx4 v[92:95], v6, s[24:27], 0 offen
    v_add_u32 v6, 122880, v6
    buffer_load_dwordx4 v[96:99], v6, s[24:27], 0 offen
    v_add_u32 v6, 122880, v6
    buffer_load_dwordx4 v[100:103], v6, s[24:27], 0 offen
    v_add_u32 v6, 122880, v6
    buffer_load_dwordx4 v[104:107], v6, s[24:27], 0 offen
    s_mov_b64 exec, s[32:33]
    v_and_b32 v8, 31, v2
    v_lshrrev_b32 v9, 5, v2
    s_lshl_b32 s17, s12, 5
    s_add_u32 s38, s17, s13
    v_add_u32 v10, s38, v8
    v_lshlrev_b32 v10, 3, v10
    v_lshl_add_u32 v11, v9, 15, v10
    s_lshl_b32 s18, s15, 14
    buffer_load_dwordx2 v[16:17], v11, s[20:23], s18 offen
    s_add_u32 s19, s18, 16384
    buffer_load_dwordx2 v[18:19], v11, s[20:23], s19 offen
    s_add_u32 s19, s18, 65536
    buffer_load_dwordx2 v[20:21], v10, s[20:23], s19 offen
    v_lshrrev_b32 v12, 1, v0
    v_mul_u32_u24 v12, 1008, v12
    v_and_b32 v13, 1, v0
    v_lshl_add_u32 v12, v13, 4, v12
    v_mov_b32 v56, 0x3f803f80
    v_mov_b32 v57, 0x3f803f80
    v_mov_b32 v58, 0x3f803f80
    v_mov_b32 v59, 0x3f803f80
    v_cmp_gt_u32 vcc, 48, v0
    s_and_saveexec_b64 s[32:33], vcc
    ds_write_b128 v12, v[56:59] offset:16320
    s_mov_b64 exec, s[32:33]
    v_lshlrev_b32 v13, 2, v9
    v_sub_u32 v13, v8, v13
    v_cmp_gt_i32 s[40:41], 0, v13
    v_cmp_gt_i32 s[42:43], 1, v13
    v_cmp_gt_i32 s[44:45], 2, v13
    v_cmp_gt_i32 s[46:47], 3, v13
    v_cmp_gt_i32 s[48:49], 8, v13
    v_cmp_gt_i32 s[50:51], 9, v13
    v_cmp_gt_i32 s[52:53], 10, v13
    v_cmp_gt_i32 s[54:55], 11, v13
    v_cmp_gt_i32 s[56:57], 16, v13
    v_cmp_gt_i32 s[58:59], 17, v13
    v_cmp_gt_i32 s[60:61], 18, v13
    v_cmp_gt_i32 s[62:63], 19, v13
    v_cmp_gt_i32 s[64:65], 24, v13
    v_cmp_gt_i32 s[66:67], 25, v13
    v_cmp_gt_i32 s[68:69], 26, v13
    v_cmp_gt_i32 s[70:71], 27, v13
    s_lshl_b32 s17, s12, 8
    v_lshl_add_u32 v14, v8, 3, s17
    v_mul_u32_u24 v15, 6144, v9
    v_add_u32 v15, v15, v14
    v_min_u32 v12, 20, v8
    v_cmp_lt_u32 vcc, 27, v8
    v_mov_b32 v13, 4
    s_nop 1
    v_cndmask_b32 v12, v12, v13, vcc
    v_mul_u32_u24 v12, 48, v12
    v_lshl_add_u32 v12, v9, 4, v12
    s_mul_i32 s17, s12, 2016
    s_add_u32 s17, s17, 15360
    v_add_u32 v12, s17, v12
    v_mov_b32 v13, 0xff800000
    v_mov_b32 v30, 0
    v_mov_b32 v31, 0
    v_mov_b32 v38, 0
    v_mov_b32 v39, 0
    v_mov_b32 v22, 0
    v_mov_b32 v23, 0
    v_cmp_eq_u32 s[34:35], 1, v9
    s_mov_b32 s36, 0x3ea52b5c
    s_mov_b32 s37, 0x3ea52b5c
    s_mov_b32 s39, 0xbea52b5c
    v_mov_b32 v52, 0xffff
    v_mov_b32 v53, 0xffff0000
    v_cndmask_b32 v120, 0, v52, s[40:41]
    v_cndmask_b32 v54, 0, v53, s[42:43]
    v_or_b32 v120, v120, v54
    v_cndmask_b32 v121, 0, v52, s[44:45]
    v_cndmask_b32 v54, 0, v53, s[46:47]
    v_or_b32 v121, v121, v54
    v_cndmask_b32 v122, 0, v52, s[48:49]
    v_cndmask_b32 v54, 0, v53, s[50:51]
    v_or_b32 v122, v122, v54
    v_cndmask_b32 v123, 0, v52, s[52:53]
    v_cndmask_b32 v54, 0, v53, s[54:55]
    v_or_b32 v123, v123, v54
    v_cndmask_b32 v124, 0, v52, s[56:57]
    v_cndmask_b32 v54, 0, v53, s[58:59]
    v_or_b32 v124, v124, v54
    v_cndmask_b32 v125, 0, v52, s[60:61]
    v_cndmask_b32 v54, 0, v53, s[62:63]
    v_or_b32 v125, v125, v54
    v_cndmask_b32 v126, 0, v52, s[64:65]
    v_cndmask_b32 v54, 0, v53, s[66:67]
    v_or_b32 v126, v126, v54
    v_cndmask_b32 v127, 0, v52, s[68:69]
    v_cndmask_b32 v54, 0, v53, s[70:71]
    v_or_b32 v127, v127, v54
    s_waitcnt vmcnt(3)
    s_cmp_eq_u32 s12, 3
    s_cbranch_scc1 .atk_17
    ds_write_b128 v3, v[72:75] offset:0
    ds_write_b128 v3, v[76:79] offset:3072
    ds_write_b128 v3, v[80:83] offset:6144
    ds_write_b128 v3, v[84:87] offset:9216
    ds_write_b128 v3, v[88:91] offset:12288
.atk_17:
    v_cmp_gt_u32 vcc, 240, v0
    s_and_saveexec_b64 s[32:33], vcc
    ds_write_b128 v7, v[92:95] offset:15360
    ds_write_b128 v7, v[96:99] offset:21408
    ds_write_b128 v7, v[100:103] offset:27456
    ds_write_b128 v7, v[104:107] offset:33504
    s_mov_b64 exec, s[32:33]
    s_waitcnt vmcnt(0)
    v_cndmask_b32 v20, v20, 0, s[34:35]
    v_cndmask_b32 v21, v21, 0, s[34:35]
    s_waitcnt lgkmcnt(0)
    s_barrier
    ds_read_b64 v[24:25], v15 offset:0
    ds_read_b64 v[26:27], v15 offset:3072
    ds_read_b64 v[28:29], v14 offset:12288
    ds_read_b64 v[32:33], v15 offset:2048
    ds_read_b64 v[34:35], v15 offset:5120
    ds_read_b64 v[36:37], v14 offset:14336
    s_waitcnt lgkmcnt(3)
    v_mfma_f32_32x32x16_bf16 v[72:87], v[24:27], v[16:19], 0
    v_mfma_f32_32x32x16_bf16 v[72:87], v[28:31], v[20:23], v[72:87]
    ds_read_b64 v[24:25], v15 offset:256
    ds_read_b64 v[26:27], v15 offset:3328
    ds_read_b64 v[28:29], v14 offset:12544
    s_waitcnt lgkmcnt(3)
    v_mfma_f32_32x32x16_bf16 v[88:103], v[32:35], v[16:19], 0
    v_mfma_f32_32x32x16_bf16 v[88:103], v[36:39], v[20:23], v[88:103]
    ds_read_b128 v[40:43], v12 offset:0
    ds_read_b128 v[44:47], v12 offset:1008
    s_waitcnt lgkmcnt(2)
    v_mfma_f32_32x32x16_bf16 v[104:119], v[24:27], v[16:19], 0
    v_mfma_f32_32x32x16_bf16 v[104:119], v[28:31], v[20:23], v[104:119]
    s_nop 11
    s_cmp_ge_u32 s38, 256
    s_cbranch_scc1 .atok_18
    v_mov_b32 v72, v13
    v_mov_b32 v73, v13
    v_mov_b32 v74, v13
    v_mov_b32 v75, v13
    v_mov_b32 v76, v13
    v_mov_b32 v77, v13
    v_mov_b32 v78, v13
    v_mov_b32 v79, v13
    v_mov_b32 v80, v13
    v_mov_b32 v81, v13
    v_mov_b32 v82, v13
    v_mov_b32 v83, v13
    v_mov_b32 v84, v13
    v_mov_b32 v85, v13
    v_mov_b32 v86, v13
    v_mov_b32 v87, v13
    s_cmp_ge_u32 s38, 224
    s_cbranch_scc1 .atok_18
    v_mov_b32 v104, v13
    v_mov_b32 v105, v13
    v_mov_b32 v106, v13
    v_mov_b32 v107, v13
    v_mov_b32 v108, v13
    v_mov_b32 v109, v13
    v_mov_b32 v110, v13
    v_mov_b32 v111, v13
    v_mov_b32 v112, v13
    v_mov_b32 v113, v13
    v_mov_b32 v114, v13
    v_mov_b32 v115, v13
    v_mov_b32 v116, v13
    v_mov_b32 v117, v13
    v_mov_b32 v118, v13
    v_mov_b32 v119, v13
.atok_18:
    v_cndmask_b32 v88, v88, v72, s[40:41]
    v_cndmask_b32 v89, v89, v73, s[42:43]
    v_cndmask_b32 v90, v90, v74, s[44:45]
    v_cndmask_b32 v91, v91, v75, s[46:47]
    v_cndmask_b32 v92, v92, v76, s[48:49]
    v_cndmask_b32 v93, v93, v77, s[50:51]
    v_cndmask_b32 v94, v94, v78, s[52:53]
    v_cndmask_b32 v95, v95, v79, s[54:55]
    v_cndmask_b32 v96, v96, v80, s[56:57]
    v_cndmask_b32 v97, v97, v81, s[58:59]
    v_cndmask_b32 v98, v98, v82, s[60:61]
    v_cndmask_b32 v99, v99, v83, s[62:63]
    v_cndmask_b32 v100, v100, v84, s[64:65]
    v_cndmask_b32 v101, v101, v85, s[66:67]
    v_cndmask_b32 v102, v102, v86, s[68:69]
    v_cndmask_b32 v103, v103, v87, s[70:71]
    v_max3_f32 v54, v88, v89, v90
    v_max3_f32 v55, v91, v92, v93
    v_max3_f32 v54, v54, v94, v95
    v_max3_f32 v55, v55, v96, v97
    v_max3_f32 v54, v54, v98, v99
    v_max3_f32 v55, v55, v100, v101
    v_max3_f32 v54, v54, v102, v103
    v_max3_f32 v55, v55, v104, v105
    v_max3_f32 v54, v54, v106, v107
    v_max3_f32 v55, v55, v108, v109
    v_max3_f32 v54, v54, v110, v111
    v_max3_f32 v55, v55, v112, v113
    v_max3_f32 v54, v54, v114, v115
    v_max3_f32 v55, v55, v116, v117
    v_max3_f32 v54, v54, v118, v119
    v_max_f32 v54, v54, v55
    v_mov_b32 v55, v54
    s_nop 1
    v_permlane32_swap_b32 v54, v55
    s_nop 1
    v_max_f32 v54, v54, v55
    v_mul_f32 v52, s39, v54
    v_min_f32 v52, 0x7f7fffff, v52
    v_mov_b32 v53, v52
    ds_read_b64 v[32:33], v15 offset:512
    ds_read_b64 v[34:35], v15 offset:3584
    ds_read_b64 v[36:37], v14 offset:12800
    v_pk_fma_f32 v[88:89], v[88:89], s[36:37], v[52:53]
    v_pk_fma_f32 v[90:91], v[90:91], s[36:37], v[52:53]
    v_pk_fma_f32 v[92:93], v[92:93], s[36:37], v[52:53]
    v_pk_fma_f32 v[94:95], v[94:95], s[36:37], v[52:53]
    v_pk_fma_f32 v[96:97], v[96:97], s[36:37], v[52:53]
    v_pk_fma_f32 v[98:99], v[98:99], s[36:37], v[52:53]
    v_pk_fma_f32 v[100:101], v[100:101], s[36:37], v[52:53]
    v_pk_fma_f32 v[102:103], v[102:103], s[36:37], v[52:53]
    v_exp_f32 v88, v88
    v_exp_f32 v89, v89
    v_exp_f32 v90, v90
    v_exp_f32 v91, v91
    v_exp_f32 v92, v92
    v_exp_f32 v93, v93
    v_exp_f32 v94, v94
    v_exp_f32 v95, v95
    v_exp_f32 v96, v96
    v_exp_f32 v97, v97
    v_exp_f32 v98, v98
    v_exp_f32 v99, v99
    v_exp_f32 v100, v100
    v_exp_f32 v101, v101
    v_exp_f32 v102, v102
    v_exp_f32 v103, v103
    s_nop 0
    v_cvt_pk_bf16_f32 v88, v88, v89
    v_cvt_pk_bf16_f32 v89, v90, v91
    v_cvt_pk_bf16_f32 v90, v92, v93
    v_cvt_pk_bf16_f32 v91, v94, v95
    v_cvt_pk_bf16_f32 v92, v96, v97
    v_cvt_pk_bf16_f32 v93, v98, v99
    v_cvt_pk_bf16_f32 v94, v100, v101
    v_cvt_pk_bf16_f32 v95, v102, v103
    v_and_b32 v72, v120, v88
    v_and_b32 v73, v121, v89
    v_and_b32 v74, v122, v90
    v_and_b32 v75, v123, v91
    v_and_b32 v76, v124, v92
    v_and_b32 v77, v125, v93
    v_and_b32 v78, v126, v94
    v_and_b32 v79, v127, v95
    v_xor_b32 v88, v72, v88
    v_xor_b32 v89, v73, v89
    v_xor_b32 v90, v74, v90
    v_xor_b32 v91, v75, v91
    v_xor_b32 v92, v76, v92
    v_xor_b32 v93, v77, v93
    v_xor_b32 v94, v78, v94
    v_xor_b32 v95, v79, v95
    ds_read_b128 v[48:51], v12 offset:16128
    s_waitcnt lgkmcnt(5)
    s_nop 0
    v_mfma_f32_32x32x16_bf16 v[56:71], v[40:43], v[72:75], 0
    ds_read_b128 v[40:43], v12 offset:17136
    s_waitcnt lgkmcnt(5)
    v_mfma_f32_32x32x16_bf16 v[56:71], v[44:47], v[76:79], v[56:71]
    ds_read_b128 v[44:47], v12 offset:2016
    s_waitcnt lgkmcnt(2)
    s_nop 0
    v_mfma_f32_32x32x16_bf16 v[56:71], v[48:51], v[88:91], v[56:71]
    ds_read_b128 v[48:51], v12 offset:3024
    s_waitcnt lgkmcnt(2)
    v_mfma_f32_32x32x16_bf16 v[56:71], v[40:43], v[92:95], v[56:71]
    v_pk_fma_f32 v[104:105], v[104:105], s[36:37], v[52:53]
    v_pk_fma_f32 v[106:107], v[106:107], s[36:37], v[52:53]
    v_pk_fma_f32 v[108:109], v[108:109], s[36:37], v[52:53]
    v_pk_fma_f32 v[110:111], v[110:111], s[36:37], v[52:53]
    v_pk_fma_f32 v[112:113], v[112:113], s[36:37], v[52:53]
    v_pk_fma_f32 v[114:115], v[114:115], s[36:37], v[52:53]
    v_pk_fma_f32 v[116:117], v[116:117], s[36:37], v[52:53]
    v_pk_fma_f32 v[118:119], v[118:119], s[36:37], v[52:53]
    v_exp_f32 v104, v104
    v_exp_f32 v105, v105
    v_exp_f32 v106, v106
    v_exp_f32 v107, v107
    v_exp_f32 v108, v108
    v_exp_f32 v109, v109
    v_exp_f32 v110, v110
    v_exp_f32 v111, v111
    v_exp_f32 v112, v112
    v_exp_f32 v113, v113
    v_exp_f32 v114, v114
    v_exp_f32 v115, v115
    v_exp_f32 v116, v116
    v_exp_f32 v117, v117
    v_exp_f32 v118, v118
    v_exp_f32 v119, v119
    s_nop 0
    v_cvt_pk_bf16_f32 v104, v104, v105
    v_cvt_pk_bf16_f32 v105, v106, v107
    v_cvt_pk_bf16_f32 v106, v108, v109
    v_cvt_pk_bf16_f32 v107, v110, v111
    v_cvt_pk_bf16_f32 v108, v112, v113
    v_cvt_pk_bf16_f32 v109, v114, v115
    v_cvt_pk_bf16_f32 v110, v116, v117
    v_cvt_pk_bf16_f32 v111, v118, v119
    s_waitcnt lgkmcnt(1)
    s_nop 0
    v_mfma_f32_32x32x16_bf16 v[56:71], v[44:47], v[104:107], v[56:71]
    s_waitcnt lgkmcnt(0)
    v_mfma_f32_32x32x16_bf16 v[56:71], v[48:51], v[108:111], v[56:71]
    ds_read_b64 v[24:25], v15 offset:768
    ds_read_b64 v[26:27], v15 offset:3840
    ds_read_b64 v[28:29], v14 offset:13056
    s_waitcnt lgkmcnt(3)
    v_mfma_f32_32x32x16_bf16 v[72:87], v[32:35], v[16:19], 0
    v_mfma_f32_32x32x16_bf16 v[72:87], v[36:39], v[20:23], v[72:87]
    ds_read_b64 v[32:33], v15 offset:1024
    ds_read_b64 v[34:35], v15 offset:4096
    ds_read_b64 v[36:37], v14 offset:13312
    s_waitcnt lgkmcnt(3)
    v_mfma_f32_32x32x16_bf16 v[88:103], v[24:27], v[16:19], 0
    v_mfma_f32_32x32x16_bf16 v[88:103], v[28:31], v[20:23], v[88:103]
    ds_read_b128 v[40:43], v12 offset:4032
    ds_read_b128 v[44:47], v12 offset:5040
    s_waitcnt lgkmcnt(2)
    v_mfma_f32_32x32x16_bf16 v[104:119], v[32:35], v[16:19], 0
    v_mfma_f32_32x32x16_bf16 v[104:119], v[36:39], v[20:23], v[104:119]
    s_nop 11
    s_cmp_ge_u32 s38, 192
    s_cbranch_scc1 .atok_19
    v_mov_b32 v72, v13
    v_mov_b32 v73, v13
    v_mov_b32 v74, v13
    v_mov_b32 v75, v13
    v_mov_b32 v76, v13
    v_mov_b32 v77, v13
    v_mov_b32 v78, v13
    v_mov_b32 v79, v13
    v_mov_b32 v80, v13
    v_mov_b32 v81, v13
    v_mov_b32 v82, v13
    v_mov_b32 v83, v13
    v_mov_b32 v84, v13
    v_mov_b32 v85, v13
    v_mov_b32 v86, v13
    v_mov_b32 v87, v13
    s_cmp_ge_u32 s38, 160
    s_cbranch_scc1 .atok_19
    v_mov_b32 v88, v13
    v_mov_b32 v89, v13
    v_mov_b32 v90, v13
    v_mov_b32 v91, v13
    v_mov_b32 v92, v13
    v_mov_b32 v93, v13
    v_mov_b32 v94, v13
    v_mov_b32 v95, v13
    v_mov_b32 v96, v13
    v_mov_b32 v97, v13
    v_mov_b32 v98, v13
    v_mov_b32 v99, v13
    v_mov_b32 v100, v13
    v_mov_b32 v101, v13
    v_mov_b32 v102, v13
    v_mov_b32 v103, v13
    s_cmp_ge_u32 s38, 128
    s_cbranch_scc1 .atok_19
    v_mov_b32 v104, v13
    v_mov_b32 v105, v13
    v_mov_b32 v106, v13
    v_mov_b32 v107, v13
    v_mov_b32 v108, v13
    v_mov_b32 v109, v13
    v_mov_b32 v110, v13
    v_mov_b32 v111, v13
    v_mov_b32 v112, v13
    v_mov_b32 v113, v13
    v_mov_b32 v114, v13
    v_mov_b32 v115, v13
    v_mov_b32 v116, v13
    v_mov_b32 v117, v13
    v_mov_b32 v118, v13
    v_mov_b32 v119, v13
.atok_19:
    v_max3_f32 v54, v72, v73, v74
    v_max3_f32 v55, v75, v76, v77
    v_max3_f32 v54, v54, v78, v79
    v_max3_f32 v55, v55, v80, v81
    v_max3_f32 v54, v54, v82, v83
    v_max3_f32 v55, v55, v84, v85
    v_max3_f32 v54, v54, v86, v87
    v_max3_f32 v55, v55, v88, v89
    v_max3_f32 v54, v54, v90, v91
    v_max3_f32 v55, v55, v92, v93
    v_max3_f32 v54, v54, v94, v95
    v_max3_f32 v55, v55, v96, v97
    v_max3_f32 v54, v54, v98, v99
    v_max3_f32 v55, v55, v100, v101
    v_max3_f32 v54, v54, v102, v103
    v_max3_f32 v55, v55, v104, v105
    v_max3_f32 v54, v54, v106, v107
    v_max3_f32 v55, v55, v108, v109
    v_max3_f32 v54, v54, v110, v111
    v_max3_f32 v55, v55, v112, v113
    v_max3_f32 v54, v54, v114, v115
    v_max3_f32 v55, v55, v116, v117
    v_max3_f32 v54, v54, v118, v119
    v_max_f32 v54, v54, v55
    v_mov_b32 v55, v54
    s_nop 1
    v_permlane32_swap_b32 v54, v55
    s_nop 1
    v_max_f32 v54, v54, v55
    v_mul_f32 v54, s39, v54
    v_min_f32 v54, v54, v52
    v_sub_f32 v55, v54, v52
    v_exp_f32 v55, v55
    v_mov_b32 v52, v54
    v_mov_b32 v53, v54
    v_mul_f32 v56, v56, v55
    v_mul_f32 v57, v57, v55
    v_mul_f32 v58, v58, v55
    v_mul_f32 v59, v59, v55
    v_mul_f32 v60, v60, v55
    v_mul_f32 v61, v61, v55
    v_mul_f32 v62, v62, v55
    v_mul_f32 v63, v63, v55
    v_mul_f32 v64, v64, v55
    v_mul_f32 v65, v65, v55
    v_mul_f32 v66, v66, v55
    v_mul_f32 v67, v67, v55
    v_mul_f32 v68, v68, v55
    v_mul_f32 v69, v69, v55
    v_mul_f32 v70, v70, v55
    v_mul_f32 v71, v71, v55
    ds_read_b64 v[24:25], v15 offset:1280
    ds_read_b64 v[26:27], v15 offset:4352
    ds_read_b64 v[28:29], v14 offset:13568
    v_pk_fma_f32 v[72:73], v[72:73], s[36:37], v[52:53]
    v_pk_fma_f32 v[74:75], v[74:75], s[36:37], v[52:53]
    v_pk_fma_f32 v[76:77], v[76:77], s[36:37], v[52:53]
    v_pk_fma_f32 v[78:79], v[78:79], s[36:37], v[52:53]
    v_pk_fma_f32 v[80:81], v[80:81], s[36:37], v[52:53]
    v_pk_fma_f32 v[82:83], v[82:83], s[36:37], v[52:53]
    v_pk_fma_f32 v[84:85], v[84:85], s[36:37], v[52:53]
    v_pk_fma_f32 v[86:87], v[86:87], s[36:37], v[52:53]
    v_exp_f32 v72, v72
    v_exp_f32 v73, v73
    v_exp_f32 v74, v74
    v_exp_f32 v75, v75
    v_exp_f32 v76, v76
    v_exp_f32 v77, v77
    v_exp_f32 v78, v78
    v_exp_f32 v79, v79
    v_exp_f32 v80, v80
    v_exp_f32 v81, v81
    v_exp_f32 v82, v82
    v_exp_f32 v83, v83
    v_exp_f32 v84, v84
    v_exp_f32 v85, v85
    v_exp_f32 v86, v86
    v_exp_f32 v87, v87
    s_nop 0
    v_cvt_pk_bf16_f32 v72, v72, v73
    v_cvt_pk_bf16_f32 v73, v74, v75
    v_cvt_pk_bf16_f32 v74, v76, v77
    v_cvt_pk_bf16_f32 v75, v78, v79
    v_cvt_pk_bf16_f32 v76, v80, v81
    v_cvt_pk_bf16_f32 v77, v82, v83
    v_cvt_pk_bf16_f32 v78, v84, v85
    v_cvt_pk_bf16_f32 v79, v86, v87
    ds_read_b128 v[48:51], v12 offset:6048
    s_waitcnt lgkmcnt(5)
    s_nop 0
    v_mfma_f32_32x32x16_bf16 v[56:71], v[40:43], v[72:75], v[56:71]
    ds_read_b128 v[40:43], v12 offset:7056
    s_waitcnt lgkmcnt(5)
    v_mfma_f32_32x32x16_bf16 v[56:71], v[44:47], v[76:79], v[56:71]
    v_pk_fma_f32 v[88:89], v[88:89], s[36:37], v[52:53]
    v_pk_fma_f32 v[90:91], v[90:91], s[36:37], v[52:53]
    v_pk_fma_f32 v[92:93], v[92:93], s[36:37], v[52:53]
    v_pk_fma_f32 v[94:95], v[94:95], s[36:37], v[52:53]
    v_pk_fma_f32 v[96:97], v[96:97], s[36:37], v[52:53]
    v_pk_fma_f32 v[98:99], v[98:99], s[36:37], v[52:53]
    v_pk_fma_f32 v[100:101], v[100:101], s[36:37], v[52:53]
    v_pk_fma_f32 v[102:103], v[102:103], s[36:37], v[52:53]
    v_exp_f32 v88, v88
    v_exp_f32 v89, v89
    v_exp_f32 v90, v90
    v_exp_f32 v91, v91
    v_exp_f32 v92, v92
    v_exp_f32 v93, v93
    v_exp_f32 v94, v94
    v_exp_f32 v95, v95
    v_exp_f32 v96, v96
    v_exp_f32 v97, v97
    v_exp_f32 v98, v98
    v_exp_f32 v99, v99
    v_exp_f32 v100, v100
    v_exp_f32 v101, v101
    v_exp_f32 v102, v102
    v_exp_f32 v103, v103
    s_nop 0
    v_cvt_pk_bf16_f32 v88, v88, v89
    v_cvt_pk_bf16_f32 v89, v90, v91
    v_cvt_pk_bf16_f32 v90, v92, v93
    v_cvt_pk_bf16_f32 v91, v94, v95
    v_cvt_pk_bf16_f32 v92, v96, v97
    v_cvt_pk_bf16_f32 v93, v98, v99
    v_cvt_pk_bf16_f32 v94, v100, v101
    v_cvt_pk_bf16_f32 v95, v102, v103
    ds_read_b128 v[44:47], v12 offset:8064
    s_waitcnt lgkmcnt(2)
    s_nop 0
    v_mfma_f32_32x32x16_bf16 v[56:71], v[48:51], v[88:91], v[56:71]
    ds_read_b128 v[48:51], v12 offset:9072
    s_waitcnt lgkmcnt(2)
    v_mfma_f32_32x32x16_bf16 v[56:71], v[40:43], v[92:95], v[56:71]
    v_pk_fma_f32 v[104:105], v[104:105], s[36:37], v[52:53]
    v_pk_fma_f32 v[106:107], v[106:107], s[36:37], v[52:53]
    v_pk_fma_f32 v[108:109], v[108:109], s[36:37], v[52:53]
    v_pk_fma_f32 v[110:111], v[110:111], s[36:37], v[52:53]
    v_pk_fma_f32 v[112:113], v[112:113], s[36:37], v[52:53]
    v_pk_fma_f32 v[114:115], v[114:115], s[36:37], v[52:53]
    v_pk_fma_f32 v[116:117], v[116:117], s[36:37], v[52:53]
    v_pk_fma_f32 v[118:119], v[118:119], s[36:37], v[52:53]
    v_exp_f32 v104, v104
    v_exp_f32 v105, v105
    v_exp_f32 v106, v106
    v_exp_f32 v107, v107
    v_exp_f32 v108, v108
    v_exp_f32 v109, v109
    v_exp_f32 v110, v110
    v_exp_f32 v111, v111
    v_exp_f32 v112, v112
    v_exp_f32 v113, v113
    v_exp_f32 v114, v114
    v_exp_f32 v115, v115
    v_exp_f32 v116, v116
    v_exp_f32 v117, v117
    v_exp_f32 v118, v118
    v_exp_f32 v119, v119
    s_nop 0
    v_cvt_pk_bf16_f32 v104, v104, v105
    v_cvt_pk_bf16_f32 v105, v106, v107
    v_cvt_pk_bf16_f32 v106, v108, v109
    v_cvt_pk_bf16_f32 v107, v110, v111
    v_cvt_pk_bf16_f32 v108, v112, v113
    v_cvt_pk_bf16_f32 v109, v114, v115
    v_cvt_pk_bf16_f32 v110, v116, v117
    v_cvt_pk_bf16_f32 v111, v118, v119
    s_waitcnt lgkmcnt(1)
    s_nop 0
    v_mfma_f32_32x32x16_bf16 v[56:71], v[44:47], v[104:107], v[56:71]
    s_waitcnt lgkmcnt(0)
    v_mfma_f32_32x32x16_bf16 v[56:71], v[48:51], v[108:111], v[56:71]
    ds_read_b64 v[32:33], v15 offset:1536
    ds_read_b64 v[34:35], v15 offset:4608
    ds_read_b64 v[36:37], v14 offset:13824
    s_waitcnt lgkmcnt(3)
    v_mfma_f32_32x32x16_bf16 v[72:87], v[24:27], v[16:19], 0
    v_mfma_f32_32x32x16_bf16 v[72:87], v[28:31], v[20:23], v[72:87]
    ds_read_b64 v[24:25], v15 offset:1792
    ds_read_b64 v[26:27], v15 offset:4864
    ds_read_b64 v[28:29], v14 offset:14080
    s_waitcnt lgkmcnt(3)
    v_mfma_f32_32x32x16_bf16 v[88:103], v[32:35], v[16:19], 0
    v_mfma_f32_32x32x16_bf16 v[88:103], v[36:39], v[20:23], v[88:103]
    ds_read_b128 v[40:43], v12 offset:10080
    ds_read_b128 v[44:47], v12 offset:11088
    s_waitcnt lgkmcnt(2)
    v_mfma_f32_32x32x16_bf16 v[104:119], v[24:27], v[16:19], 0
    v_mfma_f32_32x32x16_bf16 v[104:119], v[28:31], v[20:23], v[104:119]
    s_nop 11
    s_cmp_ge_u32 s38, 96
    s_cbranch_scc1 .atok_20
    v_mov_b32 v72, v13
    v_mov_b32 v73, v13
    v_mov_b32 v74, v13
    v_mov_b32 v75, v13
    v_mov_b32 v76, v13
    v_mov_b32 v77, v13
    v_mov_b32 v78, v13
    v_mov_b32 v79, v13
    v_mov_b32 v80, v13
    v_mov_b32 v81, v13
    v_mov_b32 v82, v13
    v_mov_b32 v83, v13
    v_mov_b32 v84, v13
    v_mov_b32 v85, v13
    v_mov_b32 v86, v13
    v_mov_b32 v87, v13
    s_cmp_ge_u32 s38, 64
    s_cbranch_scc1 .atok_20
    v_mov_b32 v88, v13
    v_mov_b32 v89, v13
    v_mov_b32 v90, v13
    v_mov_b32 v91, v13
    v_mov_b32 v92, v13
    v_mov_b32 v93, v13
    v_mov_b32 v94, v13
    v_mov_b32 v95, v13
    v_mov_b32 v96, v13
    v_mov_b32 v97, v13
    v_mov_b32 v98, v13
    v_mov_b32 v99, v13
    v_mov_b32 v100, v13
    v_mov_b32 v101, v13
    v_mov_b32 v102, v13
    v_mov_b32 v103, v13
    s_cmp_ge_u32 s38, 32
    s_cbranch_scc1 .atok_20
    v_mov_b32 v104, v13
    v_mov_b32 v105, v13
    v_mov_b32 v106, v13
    v_mov_b32 v107, v13
    v_mov_b32 v108, v13
    v_mov_b32 v109, v13
    v_mov_b32 v110, v13
    v_mov_b32 v111, v13
    v_mov_b32 v112, v13
    v_mov_b32 v113, v13
    v_mov_b32 v114, v13
    v_mov_b32 v115, v13
    v_mov_b32 v116, v13
    v_mov_b32 v117, v13
    v_mov_b32 v118, v13
    v_mov_b32 v119, v13
.atok_20:
    v_max3_f32 v54, v72, v73, v74
    v_max3_f32 v55, v75, v76, v77
    v_max3_f32 v54, v54, v78, v79
    v_max3_f32 v55, v55, v80, v81
    v_max3_f32 v54, v54, v82, v83
    v_max3_f32 v55, v55, v84, v85
    v_max3_f32 v54, v54, v86, v87
    v_max3_f32 v55, v55, v88, v89
    v_max3_f32 v54, v54, v90, v91
    v_max3_f32 v55, v55, v92, v93
    v_max3_f32 v54, v54, v94, v95
    v_max3_f32 v55, v55, v96, v97
    v_max3_f32 v54, v54, v98, v99
    v_max3_f32 v55, v55, v100, v101
    v_max3_f32 v54, v54, v102, v103
    v_max3_f32 v55, v55, v104, v105
    v_max3_f32 v54, v54, v106, v107
    v_max3_f32 v55, v55, v108, v109
    v_max3_f32 v54, v54, v110, v111
    v_max3_f32 v55, v55, v112, v113
    v_max3_f32 v54, v54, v114, v115
    v_max3_f32 v55, v55, v116, v117
    v_max3_f32 v54, v54, v118, v119
    v_max_f32 v54, v54, v55
    v_mov_b32 v55, v54
    s_nop 1
    v_permlane32_swap_b32 v54, v55
    s_nop 1
    v_max_f32 v54, v54, v55
    v_mul_f32 v54, s39, v54
    v_min_f32 v54, v54, v52
    v_sub_f32 v55, v54, v52
    v_exp_f32 v55, v55
    v_mov_b32 v52, v54
    v_mov_b32 v53, v54
    v_mul_f32 v56, v56, v55
    v_mul_f32 v57, v57, v55
    v_mul_f32 v58, v58, v55
    v_mul_f32 v59, v59, v55
    v_mul_f32 v60, v60, v55
    v_mul_f32 v61, v61, v55
    v_mul_f32 v62, v62, v55
    v_mul_f32 v63, v63, v55
    v_mul_f32 v64, v64, v55
    v_mul_f32 v65, v65, v55
    v_mul_f32 v66, v66, v55
    v_mul_f32 v67, v67, v55
    v_mul_f32 v68, v68, v55
    v_mul_f32 v69, v69, v55
    v_mul_f32 v70, v70, v55
    v_mul_f32 v71, v71, v55
    v_pk_fma_f32 v[72:73], v[72:73], s[36:37], v[52:53]
    v_pk_fma_f32 v[74:75], v[74:75], s[36:37], v[52:53]
    v_pk_fma_f32 v[76:77], v[76:77], s[36:37], v[52:53]
    v_pk_fma_f32 v[78:79], v[78:79], s[36:37], v[52:53]
    v_pk_fma_f32 v[80:81], v[80:81], s[36:37], v[52:53]
    v_pk_fma_f32 v[82:83], v[82:83], s[36:37], v[52:53]
    v_pk_fma_f32 v[84:85], v[84:85], s[36:37], v[52:53]
    v_pk_fma_f32 v[86:87], v[86:87], s[36:37], v[52:53]
    v_exp_f32 v72, v72
    v_exp_f32 v73, v73
    v_exp_f32 v74, v74
    v_exp_f32 v75, v75
    v_exp_f32 v76, v76
    v_exp_f32 v77, v77
    v_exp_f32 v78, v78
    v_exp_f32 v79, v79
    v_exp_f32 v80, v80
    v_exp_f32 v81, v81
    v_exp_f32 v82, v82
    v_exp_f32 v83, v83
    v_exp_f32 v84, v84
    v_exp_f32 v85, v85
    v_exp_f32 v86, v86
    v_exp_f32 v87, v87
    s_nop 0
    v_cvt_pk_bf16_f32 v72, v72, v73
    v_cvt_pk_bf16_f32 v73, v74, v75
    v_cvt_pk_bf16_f32 v74, v76, v77
    v_cvt_pk_bf16_f32 v75, v78, v79
    v_cvt_pk_bf16_f32 v76, v80, v81
    v_cvt_pk_bf16_f32 v77, v82, v83
    v_cvt_pk_bf16_f32 v78, v84, v85
    v_cvt_pk_bf16_f32 v79, v86, v87
    ds_read_b128 v[48:51], v12 offset:12096
    s_waitcnt lgkmcnt(2)
    s_nop 0
    v_mfma_f32_32x32x16_bf16 v[56:71], v[40:43], v[72:75], v[56:71]
    ds_read_b128 v[40:43], v12 offset:13104
    s_waitcnt lgkmcnt(2)
    v_mfma_f32_32x32x16_bf16 v[56:71], v[44:47], v[76:79], v[56:71]
    v_pk_fma_f32 v[88:89], v[88:89], s[36:37], v[52:53]
    v_pk_fma_f32 v[90:91], v[90:91], s[36:37], v[52:53]
    v_pk_fma_f32 v[92:93], v[92:93], s[36:37], v[52:53]
    v_pk_fma_f32 v[94:95], v[94:95], s[36:37], v[52:53]
    v_pk_fma_f32 v[96:97], v[96:97], s[36:37], v[52:53]
    v_pk_fma_f32 v[98:99], v[98:99], s[36:37], v[52:53]
    v_pk_fma_f32 v[100:101], v[100:101], s[36:37], v[52:53]
    v_pk_fma_f32 v[102:103], v[102:103], s[36:37], v[52:53]
    v_exp_f32 v88, v88
    v_exp_f32 v89, v89
    v_exp_f32 v90, v90
    v_exp_f32 v91, v91
    v_exp_f32 v92, v92
    v_exp_f32 v93, v93
    v_exp_f32 v94, v94
    v_exp_f32 v95, v95
    v_exp_f32 v96, v96
    v_exp_f32 v97, v97
    v_exp_f32 v98, v98
    v_exp_f32 v99, v99
    v_exp_f32 v100, v100
    v_exp_f32 v101, v101
    v_exp_f32 v102, v102
    v_exp_f32 v103, v103
    s_nop 0
    v_cvt_pk_bf16_f32 v88, v88, v89
    v_cvt_pk_bf16_f32 v89, v90, v91
    v_cvt_pk_bf16_f32 v90, v92, v93
    v_cvt_pk_bf16_f32 v91, v94, v95
    v_cvt_pk_bf16_f32 v92, v96, v97
    v_cvt_pk_bf16_f32 v93, v98, v99
    v_cvt_pk_bf16_f32 v94, v100, v101
    v_cvt_pk_bf16_f32 v95, v102, v103
    ds_read_b128 v[44:47], v12 offset:14112
    s_waitcnt lgkmcnt(2)
    s_nop 0
    v_mfma_f32_32x32x16_bf16 v[56:71], v[48:51], v[88:91], v[56:71]
    ds_read_b128 v[48:51], v12 offset:15120
    s_waitcnt lgkmcnt(2)
    v_mfma_f32_32x32x16_bf16 v[56:71], v[40:43], v[92:95], v[56:71]
    v_pk_fma_f32 v[104:105], v[104:105], s[36:37], v[52:53]
    v_pk_fma_f32 v[106:107], v[106:107], s[36:37], v[52:53]
    v_pk_fma_f32 v[108:109], v[108:109], s[36:37], v[52:53]
    v_pk_fma_f32 v[110:111], v[110:111], s[36:37], v[52:53]
    v_pk_fma_f32 v[112:113], v[112:113], s[36:37], v[52:53]
    v_pk_fma_f32 v[114:115], v[114:115], s[36:37], v[52:53]
    v_pk_fma_f32 v[116:117], v[116:117], s[36:37], v[52:53]
    v_pk_fma_f32 v[118:119], v[118:119], s[36:37], v[52:53]
    v_exp_f32 v104, v104
    v_exp_f32 v105, v105
    v_exp_f32 v106, v106
    v_exp_f32 v107, v107
    v_exp_f32 v108, v108
    v_exp_f32 v109, v109
    v_exp_f32 v110, v110
    v_exp_f32 v111, v111
    v_exp_f32 v112, v112
    v_exp_f32 v113, v113
    v_exp_f32 v114, v114
    v_exp_f32 v115, v115
    v_exp_f32 v116, v116
    v_exp_f32 v117, v117
    v_exp_f32 v118, v118
    v_exp_f32 v119, v119
    s_nop 0
    v_cvt_pk_bf16_f32 v104, v104, v105
    v_cvt_pk_bf16_f32 v105, v106, v107
    v_cvt_pk_bf16_f32 v106, v108, v109
    v_cvt_pk_bf16_f32 v107, v110, v111
    v_cvt_pk_bf16_f32 v108, v112, v113
    v_cvt_pk_bf16_f32 v109, v114, v115
    v_cvt_pk_bf16_f32 v110, v116, v117
    v_cvt_pk_bf16_f32 v111, v118, v119
    s_waitcnt lgkmcnt(1)
    s_nop 0
    v_mfma_f32_32x32x16_bf16 v[56:71], v[44:47], v[104:107], v[56:71]
    s_waitcnt lgkmcnt(0)
    v_mfma_f32_32x32x16_bf16 v[56:71], v[48:51], v[108:111], v[56:71]
    s_nop 13
    v_cndmask_b32 v52, v68, v64, s[34:35]
    v_rcp_f32 v52, v52
    v_lshl_add_u32 v11, v9, 14, v10
    v_mul_f32 v56, v56, v52
    v_mul_f32 v57, v57, v52
    v_mul_f32 v58, v58, v52
    v_mul_f32 v59, v59, v52
    v_mul_f32 v60, v60, v52
    v_mul_f32 v61, v61, v52
    v_mul_f32 v62, v62, v52
    v_mul_f32 v63, v63, v52
    v_mul_f32 v64, v64, v52
    v_mul_f32 v65, v65, v52
    v_mul_f32 v66, v66, v52
    v_mul_f32 v67, v67, v52
    v_cvt_pk_bf16_f32 v72, v56, v57
    v_cvt_pk_bf16_f32 v73, v58, v59
    v_cvt_pk_bf16_f32 v74, v60, v61
    v_cvt_pk_bf16_f32 v75, v62, v63
    v_cvt_pk_bf16_f32 v76, v64, v65
    v_cvt_pk_bf16_f32 v77, v66, v67
    s_add_u32 s19, s18, 0
    buffer_store_dwordx2 v[72:73], v11, s[28:31], s19 offen sc1
    s_add_u32 s19, s18, 32768
    buffer_store_dwordx2 v[74:75], v11, s[28:31], s19 offen sc1
    s_add_u32 s19, s18, 65536
    s_andn2_b64 exec, exec, s[34:35]
    buffer_store_dwordx2 v[76:77], v11, s[28:31], s19 offen sc1
    s_endpgm
.end_10:
    s_endpgm
.globl k3_kernel
.p2align 8
.type k3_kernel,@function
k3_kernel:
    s_cmp_ge_u32 s2, 160
    s_cbranch_scc1 .a3_21
    s_load_dwordx4 s[4:7], s[0:1], 64
    s_load_dwordx2 s[8:9], s[0:1], 88
    s_and_b32 s10, s2, 7
    s_lshr_b32 s11, s2, 3
    s_and_b32 s12, s11, 1
    s_lshl_b32 s10, s10, 1
    s_add_u32 s10, s10, s12
    s_lshr_b32 s11, s11, 1
    v_lshrrev_b32 v1, 6, v0
    v_and_b32 v2, 63, v0
    s_nop 0
    v_readfirstlane_b32 s12, v1
    v_lshlrev_b32 v3, 4, v2
    s_lshl_b32 s14, s12, 15
    v_add_u32 v3, s14, v3
    v_lshrrev_b32 v4, 3, v2
    s_movk_i32 s13, 1280
    v_mul_lo_u32 v7, v4, s13
    v_bfe_u32 v5, v2, 2, 1
    v_bfe_u32 v6, v2, 4, 1
    v_xor_b32 v5, v5, v6
    v_lshl_add_u32 v7, v5, 6, v7
    v_and_b32 v5, 3, v2
    v_lshl_add_u32 v7, v5, 4, v7
    s_mul_i32 s14, s12, 10240
    v_add_u32 v7, s14, v7
    s_lshr_b32 s15, s12, 1
    s_and_b32 s16, s12, 1
    v_and_b32 v8, 31, v2
    v_lshrrev_b32 v9, 5, v2
    s_lshl_b32 s17, s15, 9
    v_lshl_add_u32 v11, v8, 3, s17
    v_lshl_add_u32 v11, v9, 11, v11
    v_bfe_u32 v13, v2, 2, 2
    v_lshl_add_u32 v14, v9, 3, v13
    v_lshlrev_b32 v14, 7, v14
    v_bfe_u32 v15, v2, 4, 1
    v_lshl_add_u32 v14, v15, 5, v14
    v_lshl_add_u32 v14, v5, 3, v14
    v_add_u32 v14, 8192, v14
    v_lshrrev_b32 v15, 1, v13
    v_xor_b32 v15, s16, v15
    v_lshl_add_u32 v15, v15, 6, v14
    s_waitcnt lgkmcnt(0)
    s_add_u32 s20, s8, 0xa00000
    s_addc_u32 s21, s9, 0
    s_mov_b32 s22, 0x280000
    s_mov_b32 s23, 0x00020000
    s_mov_b32 s24, s4
    s_mov_b32 s25, s5
    s_mov_b32 s26, 0xc8000
    s_mov_b32 s27, 0x00020000
    s_lshl_b32 s28, s10, 10
    s_add_u32 s29, s28, 16384
    s_lshl_b32 s30, s11, 7
    s_lshl_b32 s32, s12, 11
    s_lshl_b32 s33, s12, 10
    s_lshl_b32 s34, s11, 1
    s_mul_i32 s35, s10, 7
    s_add_u32 s34, s34, s35
    s_mul_hi_u32 s35, s34, 0xccccccd
    s_mul_i32 s35, s35, 20
    s_sub_u32 s34, s34, s35
    s_lshl_b32 s35, s34, 17
    s_add_u32 s28, s28, s35
    s_add_u32 s29, s29, s35
    s_mul_i32 s35, s34, 40960
    s_add_u32 s30, s30, s35
    s_mov_b32 s37, 131072
    s_mov_b32 s31, 40960
    s_add_u32 s34, s34, 1
    s_cmp_eq_u32 s34, 20
    s_cselect_b32 s35, 0xffda0000, s37
    s_cselect_b32 s36, 0xfff42000, s31
    s_cselect_b32 s34, 0, s34
    s_add_u32 m0, s32, 0
    s_nop 0
    buffer_load_dwordx4 v3, s[20:23], s28 offen lds
    s_add_u32 s28, s28, s35
    s_add_u32 m0, s32, 1024
    s_nop 0
    buffer_load_dwordx4 v3, s[20:23], s29 offen lds
    s_add_u32 s29, s29, s35
    s_add_u32 m0, s33, 8192
    s_nop 0
    buffer_load_dwordx4 v7, s[24:27], s30 offen lds
    s_add_u32 s30, s30, s36
    s_add_u32 s34, s34, 1
    s_cmp_eq_u32 s34, 20
    s_cselect_b32 s35, 0xffda0000, s37
    s_cselect_b32 s36, 0xfff42000, s31
    s_cselect_b32 s34, 0, s34
    s_add_u32 m0, s32, 12288
    s_nop 0
    buffer_load_dwordx4 v3, s[20:23], s28 offen lds
    s_add_u32 s28, s28, s35
    s_add_u32 m0, s32, 13312
    s_nop 0
    buffer_load_dwordx4 v3, s[20:23], s29 offen lds
    s_add_u32 s29, s29, s35
    s_add_u32 m0, s33, 20480
    s_nop 0
    buffer_load_dwordx4 v7, s[24:27], s30 offen lds
    s_add_u32 s30, s30, s36
    s_add_u32 s34, s34, 1
    s_cmp_eq_u32 s34, 20
    s_cselect_b32 s35, 0xffda0000, s37
    s_cselect_b32 s36, 0xfff42000, s31
    s_cselect_b32 s34, 0, s34
    s_add_u32 m0, s32, 24576
    s_nop 0
    buffer_load_dwordx4 v3, s[20:23], s28 offen lds
    s_add_u32 s28, s28, s35
    s_add_u32 m0, s32, 25600
    s_nop 0
    buffer_load_dwordx4 v3, s[20:23], s29 offen lds
    s_add_u32 s29, s29, s35
    s_add_u32 m0, s33, 32768
    s_nop 0
    buffer_load_dwordx4 v7, s[24:27], s30 offen lds
    s_add_u32 s30, s30, s36
    s_add_u32 s34, s34, 1
    s_cmp_eq_u32 s34, 20
    s_cselect_b32 s35, 0xffda0000, s37
    s_cselect_b32 s36, 0xfff42000, s31
    s_cselect_b32 s34, 0, s34
    s_add_u32 m0, s32, 36864
    s_nop 0
    buffer_load_dwordx4 v3, s[20:23], s28 offen lds
    s_add_u32 s28, s28, s35
    s_add_u32 m0, s32, 37888
    s_nop 0
    buffer_load_dwordx4 v3, s[20:23], s29 offen lds
    s_add_u32 s29, s29, s35
    s_add_u32 m0, s33, 45056
    s_nop 0
    buffer_load_dwordx4 v7, s[24:27], s30 offen lds
    s_add_u32 s30, s30, s36
    s_waitcnt vmcnt(9) lgkmcnt(0)
    s_barrier
    ds_read_b64_tr_b16 v[72:73], v15 offset:0
    ds_read_b64_tr_b16 v[74:75], v15 offset:512
    ds_read_b64 v[64:65], v11 offset:0
    ds_read_b64 v[66:67], v11 offset:1024
    ds_read_b64 v[68:69], v11 offset:256
    ds_read_b64 v[70:71], v11 offset:1280
    s_add_u32 s34, s34, 1
    s_cmp_eq_u32 s34, 20
    s_cselect_b32 s35, 0xffda0000, s37
    s_cselect_b32 s36, 0xfff42000, s31
    s_cselect_b32 s34, 0, s34
    s_add_u32 m0, s32, 49152
    s_nop 0
    buffer_load_dwordx4 v3, s[20:23], s28 offen lds
    s_add_u32 s28, s28, s35
    s_waitcnt lgkmcnt(0)
    v_mfma_f32_32x32x16_bf16 v[32:47], v[72:75], v[64:67], 0
    ds_read_b64_tr_b16 v[84:85], v15 offset:2048
    ds_read_b64_tr_b16 v[86:87], v15 offset:2560
    ds_read_b64 v[76:77], v11 offset:4096
    s_add_u32 m0, s32, 50176
    s_nop 0
    buffer_load_dwordx4 v3, s[20:23], s29 offen lds
    s_add_u32 s29, s29, s35
    v_mfma_f32_32x32x16_bf16 v[48:63], v[72:75], v[68:71], 0
    ds_read_b64 v[78:79], v11 offset:5120
    ds_read_b64 v[80:81], v11 offset:4352
    ds_read_b64 v[82:83], v11 offset:5376
    s_add_u32 m0, s33, 57344
    s_nop 0
    buffer_load_dwordx4 v7, s[24:27], s30 offen lds
    s_add_u32 s30, s30, s36
    s_waitcnt vmcnt(9) lgkmcnt(0)
    s_barrier
    v_mfma_f32_32x32x16_bf16 v[32:47], v[84:87], v[76:79], v[32:47]
    ds_read_b64_tr_b16 v[72:73], v15 offset:12288
    ds_read_b64_tr_b16 v[74:75], v15 offset:12800
    ds_read_b64 v[64:65], v11 offset:12288
    v_mfma_f32_32x32x16_bf16 v[48:63], v[84:87], v[80:83], v[48:63]
    ds_read_b64 v[66:67], v11 offset:13312
    ds_read_b64 v[68:69], v11 offset:12544
    ds_read_b64 v[70:71], v11 offset:13568
    s_add_u32 s34, s34, 1
    s_cmp_eq_u32 s34, 20
    s_cselect_b32 s35, 0xffda0000, s37
    s_cselect_b32 s36, 0xfff42000, s31
    s_cselect_b32 s34, 0, s34
    s_add_u32 m0, s32, 0
    s_nop 0
    buffer_load_dwordx4 v3, s[20:23], s28 offen lds
    s_add_u32 s28, s28, s35
    s_waitcnt lgkmcnt(0)
    v_mfma_f32_32x32x16_bf16 v[32:47], v[72:75], v[64:67], v[32:47]
    ds_read_b64_tr_b16 v[84:85], v15 offset:14336
    ds_read_b64_tr_b16 v[86:87], v15 offset:14848
    ds_read_b64 v[76:77], v11 offset:16384
    s_add_u32 m0, s32, 1024
    s_nop 0
    buffer_load_dwordx4 v3, s[20:23], s29 offen lds
    s_add_u32 s29, s29, s35
    v_mfma_f32_32x32x16_bf16 v[48:63], v[72:75], v[68:71], v[48:63]
    ds_read_b64 v[78:79], v11 offset:17408
    ds_read_b64 v[80:81], v11 offset:16640
    ds_read_b64 v[82:83], v11 offset:17664
    s_add_u32 m0, s33, 8192
    s_nop 0
    buffer_load_dwordx4 v7, s[24:27], s30 offen lds
    s_add_u32 s30, s30, s36
    s_waitcnt vmcnt(9) lgkmcnt(0)
    s_barrier
    v_mfma_f32_32x32x16_bf16 v[32:47], v[84:87], v[76:79], v[32:47]
    ds_read_b64_tr_b16 v[72:73], v15 offset:24576
    ds_read_b64_tr_b16 v[74:75], v15 offset:25088
    ds_read_b64 v[64:65], v11 offset:24576
    v_mfma_f32_32x32x16_bf16 v[48:63], v[84:87], v[80:83], v[48:63]
    ds_read_b64 v[66:67], v11 offset:25600
    ds_read_b64 v[68:69], v11 offset:24832
    ds_read_b64 v[70:71], v11 offset:25856
    s_add_u32 s34, s34, 1
    s_cmp_eq_u32 s34, 20
    s_cselect_b32 s35, 0xffda0000, s37
    s_cselect_b32 s36, 0xfff42000, s31
    s_cselect_b32 s34, 0, s34
    s_add_u32 m0, s32, 12288
    s_nop 0
    buffer_load_dwordx4 v3, s[20:23], s28 offen lds
    s_add_u32 s28, s28, s35
    s_waitcnt lgkmcnt(0)
    v_mfma_f32_32x32x16_bf16 v[32:47], v[72:75], v[64:67], v[32:47]
    ds_read_b64_tr_b16 v[84:85], v15 offset:26624
    ds_read_b64_tr_b16 v[86:87], v15 offset:27136
    ds_read_b64 v[76:77], v11 offset:28672
    s_add_u32 m0, s32, 13312
    s_nop 0
    buffer_load_dwordx4 v3, s[20:23], s29 offen lds
    s_add_u32 s29, s29, s35
    v_mfma_f32_32x32x16_bf16 v[48:63], v[72:75], v[68:71], v[48:63]
    ds_read_b64 v[78:79], v11 offset:29696
    ds_read_b64 v[80:81], v11 offset:28928
    ds_read_b64 v[82:83], v11 offset:29952
    s_add_u32 m0, s33, 20480
    s_nop 0
    buffer_load_dwordx4 v7, s[24:27], s30 offen lds
    s_add_u32 s30, s30, s36
    s_waitcnt vmcnt(9) lgkmcnt(0)
    s_barrier
    v_mfma_f32_32x32x16_bf16 v[32:47], v[84:87], v[76:79], v[32:47]
    ds_read_b64_tr_b16 v[72:73], v15 offset:36864
    ds_read_b64_tr_b16 v[74:75], v15 offset:37376
    ds_read_b64 v[64:65], v11 offset:36864
    v_mfma_f32_32x32x16_bf16 v[48:63], v[84:87], v[80:83], v[48:63]
    ds_read_b64 v[66:67], v11 offset:37888
    ds_read_b64 v[68:69], v11 offset:37120
    ds_read_b64 v[70:71], v11 offset:38144
    s_add_u32 s34, s34, 1
    s_cmp_eq_u32 s34, 20
    s_cselect_b32 s35, 0xffda0000, s37
    s_cselect_b32 s36, 0xfff42000, s31
    s_cselect_b32 s34, 0, s34
    s_add_u32 m0, s32, 24576
    s_nop 0
    buffer_load_dwordx4 v3, s[20:23], s28 offen lds
    s_add_u32 s28, s28, s35
    s_waitcnt lgkmcnt(0)
    v_mfma_f32_32x32x16_bf16 v[32:47], v[72:75], v[64:67], v[32:47]
    ds_read_b64_tr_b16 v[84:85], v15 offset:38912
    ds_read_b64_tr_b16 v[86:87], v15 offset:39424
    ds_read_b64 v[76:77], v11 offset:40960
    s_add_u32 m0, s32, 25600
    s_nop 0
    buffer_load_dwordx4 v3, s[20:23], s29 offen lds
    s_add_u32 s29, s29, s35
    v_mfma_f32_32x32x16_bf16 v[48:63], v[72:75], v[68:71], v[48:63]
    ds_read_b64 v[78:79], v11 offset:41984
    ds_read_b64 v[80:81], v11 offset:41216
    ds_read_b64 v[82:83], v11 offset:42240
    s_add_u32 m0, s33, 32768
    s_nop 0
    buffer_load_dwordx4 v7, s[24:27], s30 offen lds
    s_add_u32 s30, s30, s36
    s_waitcnt vmcnt(9) lgkmcnt(0)
    s_barrier
    v_mfma_f32_32x32x16_bf16 v[32:47], v[84:87], v[76:79], v[32:47]
    ds_read_b64_tr_b16 v[72:73], v15 offset:49152
    ds_read_b64_tr_b16 v[74:75], v15 offset:49664
    ds_read_b64 v[64:65], v11 offset:49152
    v_mfma_f32_32x32x16_bf16 v[48:63], v[84:87], v[80:83], v[48:63]
    ds_read_b64 v[66:67], v11 offset:50176
    ds_read_b64 v[68:69], v11 offset:49408
    ds_read_b64 v[70:71], v11 offset:50432
    s_add_u32 s34, s34, 1
    s_cmp_eq_u32 s34, 20
    s_cselect_b32 s35, 0xffda0000, s37
    s_cselect_b32 s36, 0xfff42000, s31
    s_cselect_b32 s34, 0, s34
    s_add_u32 m0, s32, 36864
    s_nop 0
    buffer_load_dwordx4 v3, s[20:23], s28 offen lds
    s_add_u32 s28, s28, s35
    s_waitcnt lgkmcnt(0)
    v_mfma_f32_32x32x16_bf16 v[32:47], v[72:75], v[64:67], v[32:47]
    ds_read_b64_tr_b16 v[84:85], v15 offset:51200
    ds_read_b64_tr_b16 v[86:87], v15 offset:51712
    ds_read_b64 v[76:77], v11 offset:53248
    s_add_u32 m0, s32, 37888
    s_nop 0
    buffer_load_dwordx4 v3, s[20:23], s29 offen lds
    s_add_u32 s29, s29, s35
    v_mfma_f32_32x32x16_bf16 v[48:63], v[72:75], v[68:71], v[48:63]
    ds_read_b64 v[78:79], v11 offset:54272
    ds_read_b64 v[80:81], v11 offset:53504
    ds_read_b64 v[82:83], v11 offset:54528
    s_add_u32 m0, s33, 45056
    s_nop 0
    buffer_load_dwordx4 v7, s[24:27], s30 offen lds
    s_add_u32 s30, s30, s36
    s_waitcnt vmcnt(9) lgkmcnt(0)
    s_barrier
    v_mfma_f32_32x32x16_bf16 v[32:47], v[84:87], v[76:79], v[32:47]
    ds_read_b64_tr_b16 v[72:73], v15 offset:0
    ds_read_b64_tr_b16 v[74:75], v15 offset:512
    ds_read_b64 v[64:65], v11 offset:0
    v_mfma_f32_32x32x16_bf16 v[48:63], v[84:87], v[80:83], v[48:63]
    ds_read_b64 v[66:67], v11 offset:1024
    ds_read_b64 v[68:69], v11 offset:256
    ds_read_b64 v[70:71], v11 offset:1280
    s_add_u32 s34, s34, 1
    s_cmp_eq_u32 s34, 20
    s_cselect_b32 s35, 0xffda0000, s37
    s_cselect_b32 s36, 0xfff42000, s31
    s_cselect_b32 s34, 0, s34
    s_add_u32 m0, s32, 49152
    s_nop 0
    buffer_load_dwordx4 v3, s[20:23], s28 offen lds
    s_add_u32 s28, s28, s35
    s_waitcnt lgkmcnt(0)
    v_mfma_f32_32x32x16_bf16 v[32:47], v[72:75], v[64:67], v[32:47]
    ds_read_b64_tr_b16 v[84:85], v15 offset:2048
    ds_read_b64_tr_b16 v[86:87], v15 offset:2560
    ds_read_b64 v[76:77], v11 offset:4096
    s_add_u32 m0, s32, 50176
    s_nop 0
    buffer_load_dwordx4 v3, s[20:23], s29 offen lds
    s_add_u32 s29, s29, s35
    v_mfma_f32_32x32x16_bf16 v[48:63], v[72:75], v[68:71], v[48:63]
    ds_read_b64 v[78:79], v11 offset:5120
    ds_read_b64 v[80:81], v11 offset:4352
    ds_read_b64 v[82:83], v11 offset:5376
    s_add_u32 m0, s33, 57344
    s_nop 0
    buffer_load_dwordx4 v7, s[24:27], s30 offen lds
    s_add_u32 s30, s30, s36
    s_waitcnt vmcnt(9) lgkmcnt(0)
    s_barrier
    v_mfma_f32_32x32x16_bf16 v[32:47], v[84:87], v[76:79], v[32:47]
    ds_read_b64_tr_b16 v[72:73], v15 offset:12288
    ds_read_b64_tr_b16 v[74:75], v15 offset:12800
    ds_read_b64 v[64:65], v11 offset:12288
    v_mfma_f32_32x32x16_bf16 v[48:63], v[84:87], v[80:83], v[48:63]
    ds_read_b64 v[66:67], v11 offset:13312
    ds_read_b64 v[68:69], v11 offset:12544
    ds_read_b64 v[70:71], v11 offset:13568
    s_add_u32 s34, s34, 1
    s_cmp_eq_u32 s34, 20
    s_cselect_b32 s35, 0xffda0000, s37
    s_cselect_b32 s36, 0xfff42000, s31
    s_cselect_b32 s34, 0, s34
    s_add_u32 m0, s32, 0
    s_nop 0
    buffer_load_dwordx4 v3, s[20:23], s28 offen lds
    s_add_u32 s28, s28, s35
    s_waitcnt lgkmcnt(0)
    v_mfma_f32_32x32x16_bf16 v[32:47], v[72:75], v[64:67], v[32:47]
    ds_read_b64_tr_b16 v[84:85], v15 offset:14336
    ds_read_b64_tr_b16 v[86:87], v15 offset:14848
    ds_read_b64 v[76:77], v11 offset:16384
    s_add_u32 m0, s32, 1024
    s_nop 0
    buffer_load_dwordx4 v3, s[20:23], s29 offen lds
    s_add_u32 s29, s29, s35
    v_mfma_f32_32x32x16_bf16 v[48:63], v[72:75], v[68:71], v[48:63]
    ds_read_b64 v[78:79], v11 offset:17408
    ds_read_b64 v[80:81], v11 offset:16640
    ds_read_b64 v[82:83], v11 offset:17664
    s_add_u32 m0, s33, 8192
    s_nop 0
    buffer_load_dwordx4 v7, s[24:27], s30 offen lds
    s_add_u32 s30, s30, s36
    s_waitcnt vmcnt(9) lgkmcnt(0)
    s_barrier
    v_mfma_f32_32x32x16_bf16 v[32:47], v[84:87], v[76:79], v[32:47]
    ds_read_b64_tr_b16 v[72:73], v15 offset:24576
    ds_read_b64_tr_b16 v[74:75], v15 offset:25088
    ds_read_b64 v[64:65], v11 offset:24576
    v_mfma_f32_32x32x16_bf16 v[48:63], v[84:87], v[80:83], v[48:63]
    ds_read_b64 v[66:67], v11 offset:25600
    ds_read_b64 v[68:69], v11 offset:24832
    ds_read_b64 v[70:71], v11 offset:25856
    s_add_u32 s34, s34, 1
    s_cmp_eq_u32 s34, 20
    s_cselect_b32 s35, 0xffda0000, s37
    s_cselect_b32 s36, 0xfff42000, s31
    s_cselect_b32 s34, 0, s34
    s_add_u32 m0, s32, 12288
    s_nop 0
    buffer_load_dwordx4 v3, s[20:23], s28 offen lds
    s_add_u32 s28, s28, s35
    s_waitcnt lgkmcnt(0)
    v_mfma_f32_32x32x16_bf16 v[32:47], v[72:75], v[64:67], v[32:47]
    ds_read_b64_tr_b16 v[84:85], v15 offset:26624
    ds_read_b64_tr_b16 v[86:87], v15 offset:27136
    ds_read_b64 v[76:77], v11 offset:28672
    s_add_u32 m0, s32, 13312
    s_nop 0
    buffer_load_dwordx4 v3, s[20:23], s29 offen lds
    s_add_u32 s29, s29, s35
    v_mfma_f32_32x32x16_bf16 v[48:63], v[72:75], v[68:71], v[48:63]
    ds_read_b64 v[78:79], v11 offset:29696
    ds_read_b64 v[80:81], v11 offset:28928
    ds_read_b64 v[82:83], v11 offset:29952
    s_add_u32 m0, s33, 20480
    s_nop 0
    buffer_load_dwordx4 v7, s[24:27], s30 offen lds
    s_add_u32 s30, s30, s36
    s_waitcnt vmcnt(9) lgkmcnt(0)
    s_barrier
    v_mfma_f32_32x32x16_bf16 v[32:47], v[84:87], v[76:79], v[32:47]
    ds_read_b64_tr_b16 v[72:73], v15 offset:36864
    ds_read_b64_tr_b16 v[74:75], v15 offset:37376
    ds_read_b64 v[64:65], v11 offset:36864
    v_mfma_f32_32x32x16_bf16 v[48:63], v[84:87], v[80:83], v[48:63]
    ds_read_b64 v[66:67], v11 offset:37888
    ds_read_b64 v[68:69], v11 offset:37120
    ds_read_b64 v[70:71], v11 offset:38144
    s_add_u32 s34, s34, 1
    s_cmp_eq_u32 s34, 20
    s_cselect_b32 s35, 0xffda0000, s37
    s_cselect_b32 s36, 0xfff42000, s31
    s_cselect_b32 s34, 0, s34
    s_add_u32 m0, s32, 24576
    s_nop 0
    buffer_load_dwordx4 v3, s[20:23], s28 offen lds
    s_add_u32 s28, s28, s35
    s_waitcnt lgkmcnt(0)
    v_mfma_f32_32x32x16_bf16 v[32:47], v[72:75], v[64:67], v[32:47]
    ds_read_b64_tr_b16 v[84:85], v15 offset:38912
    ds_read_b64_tr_b16 v[86:87], v15 offset:39424
    ds_read_b64 v[76:77], v11 offset:40960
    s_add_u32 m0, s32, 25600
    s_nop 0
    buffer_load_dwordx4 v3, s[20:23], s29 offen lds
    s_add_u32 s29, s29, s35
    v_mfma_f32_32x32x16_bf16 v[48:63], v[72:75], v[68:71], v[48:63]
    ds_read_b64 v[78:79], v11 offset:41984
    ds_read_b64 v[80:81], v11 offset:41216
    ds_read_b64 v[82:83], v11 offset:42240
    s_add_u32 m0, s33, 32768
    s_nop 0
    buffer_load_dwordx4 v7, s[24:27], s30 offen lds
    s_add_u32 s30, s30, s36
    s_waitcnt vmcnt(9) lgkmcnt(0)
    s_barrier
    v_mfma_f32_32x32x16_bf16 v[32:47], v[84:87], v[76:79], v[32:47]
    ds_read_b64_tr_b16 v[72:73], v15 offset:49152
    ds_read_b64_tr_b16 v[74:75], v15 offset:49664
    ds_read_b64 v[64:65], v11 offset:49152
    v_mfma_f32_32x32x16_bf16 v[48:63], v[84:87], v[80:83], v[48:63]
    ds_read_b64 v[66:67], v11 offset:50176
    ds_read_b64 v[68:69], v11 offset:49408
    ds_read_b64 v[70:71], v11 offset:50432
    s_add_u32 s34, s34, 1
    s_cmp_eq_u32 s34, 20
    s_cselect_b32 s35, 0xffda0000, s37
    s_cselect_b32 s36, 0xfff42000, s31
    s_cselect_b32 s34, 0, s34
    s_add_u32 m0, s32, 36864
    s_nop 0
    buffer_load_dwordx4 v3, s[20:23], s28 offen lds
    s_add_u32 s28, s28, s35
    s_waitcnt lgkmcnt(0)
    v_mfma_f32_32x32x16_bf16 v[32:47], v[72:75], v[64:67], v[32:47]
    ds_read_b64_tr_b16 v[84:85], v15 offset:51200
    ds_read_b64_tr_b16 v[86:87], v15 offset:51712
    ds_read_b64 v[76:77], v11 offset:53248
    s_add_u32 m0, s32, 37888
    s_nop 0
    buffer_load_dwordx4 v3, s[20:23], s29 offen lds
    s_add_u32 s29, s29, s35
    v_mfma_f32_32x32x16_bf16 v[48:63], v[72:75], v[68:71], v[48:63]
    ds_read_b64 v[78:79], v11 offset:54272
    ds_read_b64 v[80:81], v11 offset:53504
    ds_read_b64 v[82:83], v11 offset:54528
    s_add_u32 m0, s33, 45056
    s_nop 0
    buffer_load_dwordx4 v7, s[24:27], s30 offen lds
    s_add_u32 s30, s30, s36
    s_waitcnt vmcnt(9) lgkmcnt(0)
    s_barrier
    v_mfma_f32_32x32x16_bf16 v[32:47], v[84:87], v[76:79], v[32:47]
    ds_read_b64_tr_b16 v[72:73], v15 offset:0
    ds_read_b64_tr_b16 v[74:75], v15 offset:512
    ds_read_b64 v[64:65], v11 offset:0
    v_mfma_f32_32x32x16_bf16 v[48:63], v[84:87], v[80:83], v[48:63]
    ds_read_b64 v[66:67], v11 offset:1024
    ds_read_b64 v[68:69], v11 offset:256
    ds_read_b64 v[70:71], v11 offset:1280
    s_add_u32 s34, s34, 1
    s_cmp_eq_u32 s34, 20
    s_cselect_b32 s35, 0xffda0000, s37
    s_cselect_b32 s36, 0xfff42000, s31
    s_cselect_b32 s34, 0, s34
    s_add_u32 m0, s32, 49152
    s_nop 0
    buffer_load_dwordx4 v3, s[20:23], s28 offen lds
    s_add_u32 s28, s28, s35
    s_waitcnt lgkmcnt(0)
    v_mfma_f32_32x32x16_bf16 v[32:47], v[72:75], v[64:67], v[32:47]
    ds_read_b64_tr_b16 v[84:85], v15 offset:2048
    ds_read_b64_tr_b16 v[86:87], v15 offset:2560
    ds_read_b64 v[76:77], v11 offset:4096
    s_add_u32 m0, s32, 50176
    s_nop 0
    buffer_load_dwordx4 v3, s[20:23], s29 offen lds
    s_add_u32 s29, s29, s35
    v_mfma_f32_32x32x16_bf16 v[48:63], v[72:75], v[68:71], v[48:63]
    ds_read_b64 v[78:79], v11 offset:5120
    ds_read_b64 v[80:81], v11 offset:4352
    ds_read_b64 v[82:83], v11 offset:5376
    s_add_u32 m0, s33, 57344
    s_nop 0
    buffer_load_dwordx4 v7, s[24:27], s30 offen lds
    s_add_u32 s30, s30, s36
    s_waitcnt vmcnt(9) lgkmcnt(0)
    s_barrier
    v_mfma_f32_32x32x16_bf16 v[32:47], v[84:87], v[76:79], v[32:47]
    ds_read_b64_tr_b16 v[72:73], v15 offset:12288
    ds_read_b64_tr_b16 v[74:75], v15 offset:12800
    ds_read_b64 v[64:65], v11 offset:12288
    v_mfma_f32_32x32x16_bf16 v[48:63], v[84:87], v[80:83], v[48:63]
    ds_read_b64 v[66:67], v11 offset:13312
    ds_read_b64 v[68:69], v11 offset:12544
    ds_read_b64 v[70:71], v11 offset:13568
    s_add_u32 s34, s34, 1
    s_cmp_eq_u32 s34, 20
    s_cselect_b32 s35, 0xffda0000, s37
    s_cselect_b32 s36, 0xfff42000, s31
    s_cselect_b32 s34, 0, s34
    s_add_u32 m0, s32, 0
    s_nop 0
    buffer_load_dwordx4 v3, s[20:23], s28 offen lds
    s_add_u32 s28, s28, s35
    s_waitcnt lgkmcnt(0)
    v_mfma_f32_32x32x16_bf16 v[32:47], v[72:75], v[64:67], v[32:47]
    ds_read_b64_tr_b16 v[84:85], v15 offset:14336
    ds_read_b64_tr_b16 v[86:87], v15 offset:14848
    ds_read_b64 v[76:77], v11 offset:16384
    s_add_u32 m0, s32, 1024
    s_nop 0
    buffer_load_dwordx4 v3, s[20:23], s29 offen lds
    s_add_u32 s29, s29, s35
    v_mfma_f32_32x32x16_bf16 v[48:63], v[72:75], v[68:71], v[48:63]
    ds_read_b64 v[78:79], v11 offset:17408
    ds_read_b64 v[80:81], v11 offset:16640
    ds_read_b64 v[82:83], v11 offset:17664
    s_add_u32 m0, s33, 8192
    s_nop 0
    buffer_load_dwordx4 v7, s[24:27], s30 offen lds
    s_add_u32 s30, s30, s36
    s_waitcnt vmcnt(9) lgkmcnt(0)
    s_barrier
    v_mfma_f32_32x32x16_bf16 v[32:47], v[84:87], v[76:79], v[32:47]
    ds_read_b64_tr_b16 v[72:73], v15 offset:24576
    ds_read_b64_tr_b16 v[74:75], v15 offset:25088
    ds_read_b64 v[64:65], v11 offset:24576
    v_mfma_f32_32x32x16_bf16 v[48:63], v[84:87], v[80:83], v[48:63]
    ds_read_b64 v[66:67], v11 offset:25600
    ds_read_b64 v[68:69], v11 offset:24832
    ds_read_b64 v[70:71], v11 offset:25856
    s_add_u32 s34, s34, 1
    s_cmp_eq_u32 s34, 20
    s_cselect_b32 s35, 0xffda0000, s37
    s_cselect_b32 s36, 0xfff42000, s31
    s_cselect_b32 s34, 0, s34
    s_add_u32 m0, s32, 12288
    s_nop 0
    buffer_load_dwordx4 v3, s[20:23], s28 offen lds
    s_add_u32 s28, s28, s35
    s_waitcnt lgkmcnt(0)
    v_mfma_f32_32x32x16_bf16 v[32:47], v[72:75], v[64:67], v[32:47]
    ds_read_b64_tr_b16 v[84:85], v15 offset:26624
    ds_read_b64_tr_b16 v[86:87], v15 offset:27136
    ds_read_b64 v[76:77], v11 offset:28672
    s_add_u32 m0, s32, 13312
    s_nop 0
    buffer_load_dwordx4 v3, s[20:23], s29 offen lds
    s_add_u32 s29, s29, s35
    v_mfma_f32_32x32x16_bf16 v[48:63], v[72:75], v[68:71], v[48:63]
    ds_read_b64 v[78:79], v11 offset:29696
    ds_read_b64 v[80:81], v11 offset:28928
    ds_read_b64 v[82:83], v11 offset:29952
    s_add_u32 m0, s33, 20480
    s_nop 0
    buffer_load_dwordx4 v7, s[24:27], s30 offen lds
    s_add_u32 s30, s30, s36
    s_waitcnt vmcnt(9) lgkmcnt(0)
    s_barrier
    v_mfma_f32_32x32x16_bf16 v[32:47], v[84:87], v[76:79], v[32:47]
    ds_read_b64_tr_b16 v[72:73], v15 offset:36864
    ds_read_b64_tr_b16 v[74:75], v15 offset:37376
    ds_read_b64 v[64:65], v11 offset:36864
    v_mfma_f32_32x32x16_bf16 v[48:63], v[84:87], v[80:83], v[48:63]
    ds_read_b64 v[66:67], v11 offset:37888
    ds_read_b64 v[68:69], v11 offset:37120
    ds_read_b64 v[70:71], v11 offset:38144
    s_add_u32 s34, s34, 1
    s_cmp_eq_u32 s34, 20
    s_cselect_b32 s35, 0xffda0000, s37
    s_cselect_b32 s36, 0xfff42000, s31
    s_cselect_b32 s34, 0, s34
    s_add_u32 m0, s32, 24576
    s_nop 0
    buffer_load_dwordx4 v3, s[20:23], s28 offen lds
    s_add_u32 s28, s28, s35
    s_waitcnt lgkmcnt(0)
    v_mfma_f32_32x32x16_bf16 v[32:47], v[72:75], v[64:67], v[32:47]
    ds_read_b64_tr_b16 v[84:85], v15 offset:38912
    ds_read_b64_tr_b16 v[86:87], v15 offset:39424
    ds_read_b64 v[76:77], v11 offset:40960
    s_add_u32 m0, s32, 25600
    s_nop 0
    buffer_load_dwordx4 v3, s[20:23], s29 offen lds
    s_add_u32 s29, s29, s35
    v_mfma_f32_32x32x16_bf16 v[48:63], v[72:75], v[68:71], v[48:63]
    ds_read_b64 v[78:79], v11 offset:41984
    ds_read_b64 v[80:81], v11 offset:41216
    ds_read_b64 v[82:83], v11 offset:42240
    s_add_u32 m0, s33, 32768
    s_nop 0
    buffer_load_dwordx4 v7, s[24:27], s30 offen lds
    s_add_u32 s30, s30, s36
    s_waitcnt vmcnt(9) lgkmcnt(0)
    s_barrier
    v_mfma_f32_32x32x16_bf16 v[32:47], v[84:87], v[76:79], v[32:47]
    ds_read_b64_tr_b16 v[72:73], v15 offset:49152
    ds_read_b64_tr_b16 v[74:75], v15 offset:49664
    ds_read_b64 v[64:65], v11 offset:49152
    v_mfma_f32_32x32x16_bf16 v[48:63], v[84:87], v[80:83], v[48:63]
    ds_read_b64 v[66:67], v11 offset:50176
    ds_read_b64 v[68:69], v11 offset:49408
    ds_read_b64 v[70:71], v11 offset:50432
    s_add_u32 s34, s34, 1
    s_cmp_eq_u32 s34, 20
    s_cselect_b32 s35, 0xffda0000, s37
    s_cselect_b32 s36, 0xfff42000, s31
    s_cselect_b32 s34, 0, s34
    s_add_u32 m0, s32, 36864
    s_nop 0
    buffer_load_dwordx4 v3, s[20:23], s28 offen lds
    s_add_u32 s28, s28, s35
    s_waitcnt lgkmcnt(0)
    v_mfma_f32_32x32x16_bf16 v[32:47], v[72:75], v[64:67], v[32:47]
    ds_read_b64_tr_b16 v[84:85], v15 offset:51200
    ds_read_b64_tr_b16 v[86:87], v15 offset:51712
    ds_read_b64 v[76:77], v11 offset:53248
    s_add_u32 m0, s32, 37888
    s_nop 0
    buffer_load_dwordx4 v3, s[20:23], s29 offen lds
    s_add_u32 s29, s29, s35
    v_mfma_f32_32x32x16_bf16 v[48:63], v[72:75], v[68:71], v[48:63]
    ds_read_b64 v[78:79], v11 offset:54272
    ds_read_b64 v[80:81], v11 offset:53504
    ds_read_b64 v[82:83], v11 offset:54528
    s_add_u32 m0, s33, 45056
    s_nop 0
    buffer_load_dwordx4 v7, s[24:27], s30 offen lds
    s_add_u32 s30, s30, s36
    s_waitcnt vmcnt(9) lgkmcnt(0)
    s_barrier
    v_mfma_f32_32x32x16_bf16 v[32:47], v[84:87], v[76:79], v[32:47]
    ds_read_b64_tr_b16 v[72:73], v15 offset:0
    ds_read_b64_tr_b16 v[74:75], v15 offset:512
    ds_read_b64 v[64:65], v11 offset:0
    v_mfma_f32_32x32x16_bf16 v[48:63], v[84:87], v[80:83], v[48:63]
    ds_read_b64 v[66:67], v11 offset:1024
    ds_read_b64 v[68:69], v11 offset:256
    ds_read_b64 v[70:71], v11 offset:1280
    s_add_u32 s34, s34, 1
    s_cmp_eq_u32 s34, 20
    s_cselect_b32 s35, 0xffda0000, s37
    s_cselect_b32 s36, 0xfff42000, s31
    s_cselect_b32 s34, 0, s34
    s_add_u32 m0, s32, 49152
    s_nop 0
    buffer_load_dwordx4 v3, s[20:23], s28 offen lds
    s_add_u32 s28, s28, s35
    s_waitcnt lgkmcnt(0)
    v_mfma_f32_32x32x16_bf16 v[32:47], v[72:75], v[64:67], v[32:47]
    ds_read_b64_tr_b16 v[84:85], v15 offset:2048
    ds_read_b64_tr_b16 v[86:87], v15 offset:2560
    ds_read_b64 v[76:77], v11 offset:4096
    s_add_u32 m0, s32, 50176
    s_nop 0
    buffer_load_dwordx4 v3, s[20:23], s29 offen lds
    s_add_u32 s29, s29, s35
    v_mfma_f32_32x32x16_bf16 v[48:63], v[72:75], v[68:71], v[48:63]
    ds_read_b64 v[78:79], v11 offset:5120
    ds_read_b64 v[80:81], v11 offset:4352
    ds_read_b64 v[82:83], v11 offset:5376
    s_add_u32 m0, s33, 57344
    s_nop 0
    buffer_load_dwordx4 v7, s[24:27], s30 offen lds
    s_add_u32 s30, s30, s36
    s_waitcnt vmcnt(9) lgkmcnt(0)
    s_barrier
    v_mfma_f32_32x32x16_bf16 v[32:47], v[84:87], v[76:79], v[32:47]
    ds_read_b64_tr_b16 v[72:73], v15 offset:12288
    ds_read_b64_tr_b16 v[74:75], v15 offset:12800
    ds_read_b64 v[64:65], v11 offset:12288
    v_mfma_f32_32x32x16_bf16 v[48:63], v[84:87], v[80:83], v[48:63]
    ds_read_b64 v[66:67], v11 offset:13312
    ds_read_b64 v[68:69], v11 offset:12544
    ds_read_b64 v[70:71], v11 offset:13568
    s_waitcnt lgkmcnt(0)
    v_mfma_f32_32x32x16_bf16 v[32:47], v[72:75], v[64:67], v[32:47]
    ds_read_b64_tr_b16 v[84:85], v15 offset:14336
    ds_read_b64_tr_b16 v[86:87], v15 offset:14848
    ds_read_b64 v[76:77], v11 offset:16384
    v_mfma_f32_32x32x16_bf16 v[48:63], v[72:75], v[68:71], v[48:63]
    ds_read_b64 v[78:79], v11 offset:17408
    ds_read_b64 v[80:81], v11 offset:16640
    ds_read_b64 v[82:83], v11 offset:17664
    s_waitcnt vmcnt(6) lgkmcnt(0)
    s_barrier
    v_mfma_f32_32x32x16_bf16 v[32:47], v[84:87], v[76:79], v[32:47]
    ds_read_b64_tr_b16 v[72:73], v15 offset:24576
    ds_read_b64_tr_b16 v[74:75], v15 offset:25088
    ds_read_b64 v[64:65], v11 offset:24576
    v_mfma_f32_32x32x16_bf16 v[48:63], v[84:87], v[80:83], v[48:63]
    ds_read_b64 v[66:67], v11 offset:25600
    ds_read_b64 v[68:69], v11 offset:24832
    ds_read_b64 v[70:71], v11 offset:25856
    s_waitcnt lgkmcnt(0)
    v_mfma_f32_32x32x16_bf16 v[32:47], v[72:75], v[64:67], v[32:47]
    ds_read_b64_tr_b16 v[84:85], v15 offset:26624
    ds_read_b64_tr_b16 v[86:87], v15 offset:27136
    ds_read_b64 v[76:77], v11 offset:28672
    v_mfma_f32_32x32x16_bf16 v[48:63], v[72:75], v[68:71], v[48:63]
    ds_read_b64 v[78:79], v11 offset:29696
    ds_read_b64 v[80:81], v11 offset:28928
    ds_read_b64 v[82:83], v11 offset:29952
    s_waitcnt vmcnt(3) lgkmcnt(0)
    s_barrier
    v_mfma_f32_32x32x16_bf16 v[32:47], v[84:87], v[76:79], v[32:47]
    ds_read_b64_tr_b16 v[72:73], v15 offset:36864
    ds_read_b64_tr_b16 v[74:75], v15 offset:37376
    ds_read_b64 v[64:65], v11 offset:36864
    v_mfma_f32_32x32x16_bf16 v[48:63], v[84:87], v[80:83], v[48:63]
    ds_read_b64 v[66:67], v11 offset:37888
    ds_read_b64 v[68:69], v11 offset:37120
    ds_read_b64 v[70:71], v11 offset:38144
    s_waitcnt lgkmcnt(0)
    v_mfma_f32_32x32x16_bf16 v[32:47], v[72:75], v[64:67], v[32:47]
    ds_read_b64_tr_b16 v[84:85], v15 offset:38912
    ds_read_b64_tr_b16 v[86:87], v15 offset:39424
    ds_read_b64 v[76:77], v11 offset:40960
    v_mfma_f32_32x32x16_bf16 v[48:63], v[72:75], v[68:71], v[48:63]
    ds_read_b64 v[78:79], v11 offset:41984
    ds_read_b64 v[80:81], v11 offset:41216
    ds_read_b64 v[82:83], v11 offset:42240
    s_waitcnt vmcnt(0) lgkmcnt(0)
    s_barrier
    v_mfma_f32_32x32x16_bf16 v[32:47], v[84:87], v[76:79], v[32:47]
    ds_read_b64_tr_b16 v[72:73], v15 offset:49152
    ds_read_b64_tr_b16 v[74:75], v15 offset:49664
    ds_read_b64 v[64:65], v11 offset:49152
    v_mfma_f32_32x32x16_bf16 v[48:63], v[84:87], v[80:83], v[48:63]
    ds_read_b64 v[66:67], v11 offset:50176
    ds_read_b64 v[68:69], v11 offset:49408
    ds_read_b64 v[70:71], v11 offset:50432
    s_waitcnt lgkmcnt(0)
    v_mfma_f32_32x32x16_bf16 v[32:47], v[72:75], v[64:67], v[32:47]
    ds_read_b64_tr_b16 v[84:85], v15 offset:51200
    ds_read_b64_tr_b16 v[86:87], v15 offset:51712
    ds_read_b64 v[76:77], v11 offset:53248
    v_mfma_f32_32x32x16_bf16 v[48:63], v[72:75], v[68:71], v[48:63]
    ds_read_b64 v[78:79], v11 offset:54272
    ds_read_b64 v[80:81], v11 offset:53504
    ds_read_b64 v[82:83], v11 offset:54528
    s_waitcnt lgkmcnt(0)
    v_mfma_f32_32x32x16_bf16 v[32:47], v[84:87], v[76:79], v[32:47]
    v_mfma_f32_32x32x16_bf16 v[48:63], v[84:87], v[80:83], v[48:63]
    s_barrier
    s_mul_i32 s17, s15, 9216
    s_lshl_b32 s18, s16, 6
    s_add_u32 s17, s17, s18
    v_mul_u32_u24 v16, 144, v8
    v_lshl_add_u32 v16, v9, 3, v16
    v_add_u32 v16, s17, v16
    s_nop 9
    v_cvt_pk_bf16_f32 v64, v32, v33
    v_cvt_pk_bf16_f32 v65, v34, v35
    ds_write_b64 v16, v[64:65] offset:0
    v_cvt_pk_bf16_f32 v66, v36, v37
    v_cvt_pk_bf16_f32 v67, v38, v39
    ds_write_b64 v16, v[66:67] offset:16
    v_cvt_pk_bf16_f32 v68, v40, v41
    v_cvt_pk_bf16_f32 v69, v42, v43
    ds_write_b64 v16, v[68:69] offset:32
    v_cvt_pk_bf16_f32 v70, v44, v45
    v_cvt_pk_bf16_f32 v71, v46, v47
    ds_write_b64 v16, v[70:71] offset:48
    v_cvt_pk_bf16_f32 v72, v48, v49
    v_cvt_pk_bf16_f32 v73, v50, v51
    ds_write_b64 v16, v[72:73] offset:4608
    v_cvt_pk_bf16_f32 v74, v52, v53
    v_cvt_pk_bf16_f32 v75, v54, v55
    ds_write_b64 v16, v[74:75] offset:4624
    v_cvt_pk_bf16_f32 v76, v56, v57
    v_cvt_pk_bf16_f32 v77, v58, v59
    ds_write_b64 v16, v[76:77] offset:4640
    v_cvt_pk_bf16_f32 v78, v60, v61
    v_cvt_pk_bf16_f32 v79, v62, v63
    ds_write_b64 v16, v[78:79] offset:4656
    s_mov_b32 s36, s6
    s_mov_b32 s37, s7
    s_mov_b32 s38, 0x500000
    s_mov_b32 s39, 0x00020000
    v_lshrrev_b32 v17, 3, v0
    v_and_b32 v18, 7, v0
    v_mul_u32_u24 v19, 144, v17
    v_lshl_add_u32 v19, v18, 4, v19
    s_movk_i32 s13, 2560
    v_mul_lo_u32 v20, v17, s13
    v_lshl_add_u32 v20, v18, 4, v20
    s_mul_i32 s40, s10, 327680
    s_lshl_b32 s41, s11, 7
    s_add_u32 s40, s40, s41
    s_add_u32 s40, s40, 1280
    s_waitcnt lgkmcnt(0)
    s_barrier
    ds_read_b128 v[32:35], v19 offset:0
    ds_read_b128 v[36:39], v19 offset:4608
    ds_read_b128 v[40:43], v19 offset:9216
    ds_read_b128 v[44:47], v19 offset:13824
    s_waitcnt lgkmcnt(3)
    buffer_store_dwordx4 v[32:35], v20, s[36:39], s40 offen sc1
    s_add_u32 s40, s40, 81920
    s_waitcnt lgkmcnt(2)
    buffer_store_dwordx4 v[36:39], v20, s[36:39], s40 offen sc1
    s_add_u32 s40, s40, 81920
    s_waitcnt lgkmcnt(1)
    buffer_store_dwordx4 v[40:43], v20, s[36:39], s40 offen sc1
    s_add_u32 s40, s40, 81920
    s_waitcnt lgkmcnt(0)
    buffer_store_dwordx4 v[44:47], v20, s[36:39], s40 offen sc1
    s_add_u32 s40, s40, 81920
    s_endpgm
.a3_21:
    s_cmp_ge_u32 s2, 240
    s_cbranch_scc1 .end_22
    v_lshrrev_b32 v1, 6, v0
    s_sub_u32 s3, s2, 160
    s_lshl_b32 s3, s3, 2
    v_readfirstlane_b32 s19, v1
    s_nop 3
    s_add_u32 s3, s3, s19
    s_load_dwordx2 s[4:5], s[0:1], 0
    s_load_dwordx2 s[6:7], s[0:1], 72
    s_load_dwordx2 s[10:11], s[0:1], 88
    s_mul_hi_u32 s12, s3, 0x1999999a
    s_mul_i32 s13, s12, 10
    s_sub_u32 s13, s3, s13
    v_and_b32 v1, 63, v0
    v_and_b32 v2, 7, v1
    v_lshrrev_b32 v3, 3, v1
    s_lshl_b32 s14, s12, 6
    v_lshl_add_u32 v4, v3, 3, s14
    s_lshl_b32 s15, s13, 6
    v_lshl_add_u32 v5, v2, 3, s15
    s_movk_i32 s16, 1280
    v_mul_lo_u32 v6, v4, s16
    v_lshl_add_u32 v7, v5, 1, v6
    v_add_u32 v8, 5120, v7
    v_lshlrev_b32 v6, 1, v6
    v_lshl_add_u32 v9, v5, 1, v6
    v_lshlrev_b32 v10, 12, v5
    v_lshl_add_u32 v10, v4, 1, v10
    s_waitcnt lgkmcnt(0)
    s_mov_b32 s20, s4
    s_mov_b32 s21, s5
    s_mov_b32 s22, 0x280000
    s_mov_b32 s23, 0x00020000
    s_mov_b32 s24, s6
    s_mov_b32 s25, s7
    s_mov_b32 s26, 0x500000
    s_mov_b32 s27, 0x00020000
    s_add_u32 s28, s10, 0xc80000
    s_addc_u32 s29, s11, 0
    s_mov_b32 s30, 0x280000
    s_mov_b32 s31, 0x00020000
    buffer_load_dwordx4 v[16:19], v7, s[20:23], 0 offen offset:0
    buffer_load_dwordx4 v[20:23], v7, s[20:23], 0 offen offset:1280
    buffer_load_dwordx4 v[24:27], v7, s[20:23], 0 offen offset:2560
    buffer_load_dwordx4 v[28:31], v7, s[20:23], 0 offen offset:3840
    buffer_load_dwordx4 v[32:35], v8, s[20:23], 0 offen offset:0
    buffer_load_dwordx4 v[36:39], v8, s[20:23], 0 offen offset:1280
    buffer_load_dwordx4 v[40:43], v8, s[20:23], 0 offen offset:2560
    buffer_load_dwordx4 v[44:47], v8, s[20:23], 0 offen offset:3840
    s_mov_b32 s18, 0
    buffer_load_dwordx4 v[48:51], v10, s[28:31], s18 offen
    s_mov_b32 s18, 4096
    buffer_load_dwordx4 v[52:55], v10, s[28:31], s18 offen
    s_mov_b32 s18, 8192
    buffer_load_dwordx4 v[56:59], v10, s[28:31], s18 offen
    s_mov_b32 s18, 12288
    buffer_load_dwordx4 v[60:63], v10, s[28:31], s18 offen
    s_mov_b32 s18, 16384
    buffer_load_dwordx4 v[64:67], v10, s[28:31], s18 offen
    s_mov_b32 s18, 20480
    buffer_load_dwordx4 v[68:71], v10, s[28:31], s18 offen
    s_mov_b32 s18, 24576
    buffer_load_dwordx4 v[72:75], v10, s[28:31], s18 offen
    s_mov_b32 s18, 28672
    buffer_load_dwordx4 v[76:79], v10, s[28:31], s18 offen
    s_mov_b32 s17, 0xffff0000
    s_waitcnt vmcnt(0)
    v_lshlrev_b32 v80, 16, v16
    v_and_b32 v81, s17, v16
    v_lshlrev_b32 v82, 16, v48
    v_lshlrev_b32 v83, 16, v52
    v_mul_f32 v80, v80, v82
    v_mul_f32 v81, v81, v83
    v_cvt_pk_bf16_f32 v96, v80, v81
    v_lshlrev_b32 v84, 16, v17
    v_and_b32 v85, s17, v17
    v_lshlrev_b32 v86, 16, v56
    v_lshlrev_b32 v87, 16, v60
    v_mul_f32 v84, v84, v86
    v_mul_f32 v85, v85, v87
    v_cvt_pk_bf16_f32 v97, v84, v85
    v_lshlrev_b32 v80, 16, v18
    v_and_b32 v81, s17, v18
    v_lshlrev_b32 v82, 16, v64
    v_lshlrev_b32 v83, 16, v68
    v_mul_f32 v80, v80, v82
    v_mul_f32 v81, v81, v83
    v_cvt_pk_bf16_f32 v98, v80, v81
    v_lshlrev_b32 v84, 16, v19
    v_and_b32 v85, s17, v19
    v_lshlrev_b32 v86, 16, v72
    v_lshlrev_b32 v87, 16, v76
    v_mul_f32 v84, v84, v86
    v_mul_f32 v85, v85, v87
    v_cvt_pk_bf16_f32 v99, v84, v85
    v_lshlrev_b32 v80, 16, v20
    v_and_b32 v81, s17, v20
    v_and_b32 v82, s17, v48
    v_and_b32 v83, s17, v52
    v_mul_f32 v80, v80, v82
    v_mul_f32 v81, v81, v83
    v_cvt_pk_bf16_f32 v100, v80, v81
    v_lshlrev_b32 v84, 16, v21
    v_and_b32 v85, s17, v21
    v_and_b32 v86, s17, v56
    v_and_b32 v87, s17, v60
    v_mul_f32 v84, v84, v86
    v_mul_f32 v85, v85, v87
    v_cvt_pk_bf16_f32 v101, v84, v85
    v_lshlrev_b32 v80, 16, v22
    v_and_b32 v81, s17, v22
    v_and_b32 v82, s17, v64
    v_and_b32 v83, s17, v68
    v_mul_f32 v80, v80, v82
    v_mul_f32 v81, v81, v83
    v_cvt_pk_bf16_f32 v102, v80, v81
    v_lshlrev_b32 v84, 16, v23
    v_and_b32 v85, s17, v23
    v_and_b32 v86, s17, v72
    v_and_b32 v87, s17, v76
    v_mul_f32 v84, v84, v86
    v_mul_f32 v85, v85, v87
    v_cvt_pk_bf16_f32 v103, v84, v85
    v_lshlrev_b32 v80, 16, v24
    v_and_b32 v81, s17, v24
    v_lshlrev_b32 v82, 16, v49
    v_lshlrev_b32 v83, 16, v53
    v_mul_f32 v80, v80, v82
    v_mul_f32 v81, v81, v83
    v_cvt_pk_bf16_f32 v104, v80, v81
    v_lshlrev_b32 v84, 16, v25
    v_and_b32 v85, s17, v25
    v_lshlrev_b32 v86, 16, v57
    v_lshlrev_b32 v87, 16, v61
    v_mul_f32 v84, v84, v86
    v_mul_f32 v85, v85, v87
    v_cvt_pk_bf16_f32 v105, v84, v85
    v_lshlrev_b32 v80, 16, v26
    v_and_b32 v81, s17, v26
    v_lshlrev_b32 v82, 16, v65
    v_lshlrev_b32 v83, 16, v69
    v_mul_f32 v80, v80, v82
    v_mul_f32 v81, v81, v83
    v_cvt_pk_bf16_f32 v106, v80, v81
    v_lshlrev_b32 v84, 16, v27
    v_and_b32 v85, s17, v27
    v_lshlrev_b32 v86, 16, v73
    v_lshlrev_b32 v87, 16, v77
    v_mul_f32 v84, v84, v86
    v_mul_f32 v85, v85, v87
    v_cvt_pk_bf16_f32 v107, v84, v85
    v_lshlrev_b32 v80, 16, v28
    v_and_b32 v81, s17, v28
    v_and_b32 v82, s17, v49
    v_and_b32 v83, s17, v53
    v_mul_f32 v80, v80, v82
    v_mul_f32 v81, v81, v83
    v_cvt_pk_bf16_f32 v108, v80, v81
    v_lshlrev_b32 v84, 16, v29
    v_and_b32 v85, s17, v29
    v_and_b32 v86, s17, v57
    v_and_b32 v87, s17, v61
    v_mul_f32 v84, v84, v86
    v_mul_f32 v85, v85, v87
    v_cvt_pk_bf16_f32 v109, v84, v85
    v_lshlrev_b32 v80, 16, v30
    v_and_b32 v81, s17, v30
    v_and_b32 v82, s17, v65
    v_and_b32 v83, s17, v69
    v_mul_f32 v80, v80, v82
    v_mul_f32 v81, v81, v83
    v_cvt_pk_bf16_f32 v110, v80, v81
    v_lshlrev_b32 v84, 16, v31
    v_and_b32 v85, s17, v31
    v_and_b32 v86, s17, v73
    v_and_b32 v87, s17, v77
    v_mul_f32 v84, v84, v86
    v_mul_f32 v85, v85, v87
    v_cvt_pk_bf16_f32 v111, v84, v85
    v_lshlrev_b32 v80, 16, v32
    v_and_b32 v81, s17, v32
    v_lshlrev_b32 v82, 16, v50
    v_lshlrev_b32 v83, 16, v54
    v_mul_f32 v80, v80, v82
    v_mul_f32 v81, v81, v83
    v_cvt_pk_bf16_f32 v112, v80, v81
    v_lshlrev_b32 v84, 16, v33
    v_and_b32 v85, s17, v33
    v_lshlrev_b32 v86, 16, v58
    v_lshlrev_b32 v87, 16, v62
    v_mul_f32 v84, v84, v86
    v_mul_f32 v85, v85, v87
    v_cvt_pk_bf16_f32 v113, v84, v85
    v_lshlrev_b32 v80, 16, v34
    v_and_b32 v81, s17, v34
    v_lshlrev_b32 v82, 16, v66
    v_lshlrev_b32 v83, 16, v70
    v_mul_f32 v80, v80, v82
    v_mul_f32 v81, v81, v83
    v_cvt_pk_bf16_f32 v114, v80, v81
    v_lshlrev_b32 v84, 16, v35
    v_and_b32 v85, s17, v35
    v_lshlrev_b32 v86, 16, v74
    v_lshlrev_b32 v87, 16, v78
    v_mul_f32 v84, v84, v86
    v_mul_f32 v85, v85, v87
    v_cvt_pk_bf16_f32 v115, v84, v85
    v_lshlrev_b32 v80, 16, v36
    v_and_b32 v81, s17, v36
    v_and_b32 v82, s17, v50
    v_and_b32 v83, s17, v54
    v_mul_f32 v80, v80, v82
    v_mul_f32 v81, v81, v83
    v_cvt_pk_bf16_f32 v116, v80, v81
    v_lshlrev_b32 v84, 16, v37
    v_and_b32 v85, s17, v37
    v_and_b32 v86, s17, v58
    v_and_b32 v87, s17, v62
    v_mul_f32 v84, v84, v86
    v_mul_f32 v85, v85, v87
    v_cvt_pk_bf16_f32 v117, v84, v85
    v_lshlrev_b32 v80, 16, v38
    v_and_b32 v81, s17, v38
    v_and_b32 v82, s17, v66
    v_and_b32 v83, s17, v70
    v_mul_f32 v80, v80, v82
    v_mul_f32 v81, v81, v83
    v_cvt_pk_bf16_f32 v118, v80, v81
    v_lshlrev_b32 v84, 16, v39
    v_and_b32 v85, s17, v39
    v_and_b32 v86, s17, v74
    v_and_b32 v87, s17, v78
    v_mul_f32 v84, v84, v86
    v_mul_f32 v85, v85, v87
    v_cvt_pk_bf16_f32 v119, v84, v85
    v_lshlrev_b32 v80, 16, v40
    v_and_b32 v81, s17, v40
    v_lshlrev_b32 v82, 16, v51
    v_lshlrev_b32 v83, 16, v55
    v_mul_f32 v80, v80, v82
    v_mul_f32 v81, v81, v83
    v_cvt_pk_bf16_f32 v120, v80, v81
    v_lshlrev_b32 v84, 16, v41
    v_and_b32 v85, s17, v41
    v_lshlrev_b32 v86, 16, v59
    v_lshlrev_b32 v87, 16, v63
    v_mul_f32 v84, v84, v86
    v_mul_f32 v85, v85, v87
    v_cvt_pk_bf16_f32 v121, v84, v85
    v_lshlrev_b32 v80, 16, v42
    v_and_b32 v81, s17, v42
    v_lshlrev_b32 v82, 16, v67
    v_lshlrev_b32 v83, 16, v71
    v_mul_f32 v80, v80, v82
    v_mul_f32 v81, v81, v83
    v_cvt_pk_bf16_f32 v122, v80, v81
    v_lshlrev_b32 v84, 16, v43
    v_and_b32 v85, s17, v43
    v_lshlrev_b32 v86, 16, v75
    v_lshlrev_b32 v87, 16, v79
    v_mul_f32 v84, v84, v86
    v_mul_f32 v85, v85, v87
    v_cvt_pk_bf16_f32 v123, v84, v85
    v_lshlrev_b32 v80, 16, v44
    v_and_b32 v81, s17, v44
    v_and_b32 v82, s17, v51
    v_and_b32 v83, s17, v55
    v_mul_f32 v80, v80, v82
    v_mul_f32 v81, v81, v83
    v_cvt_pk_bf16_f32 v124, v80, v81
    v_lshlrev_b32 v84, 16, v45
    v_and_b32 v85, s17, v45
    v_and_b32 v86, s17, v59
    v_and_b32 v87, s17, v63
    v_mul_f32 v84, v84, v86
    v_mul_f32 v85, v85, v87
    v_cvt_pk_bf16_f32 v125, v84, v85
    v_lshlrev_b32 v80, 16, v46
    v_and_b32 v81, s17, v46
    v_and_b32 v82, s17, v67
    v_and_b32 v83, s17, v71
    v_mul_f32 v80, v80, v82
    v_mul_f32 v81, v81, v83
    v_cvt_pk_bf16_f32 v126, v80, v81
    v_lshlrev_b32 v84, 16, v47
    v_and_b32 v85, s17, v47
    v_and_b32 v86, s17, v75
    v_and_b32 v87, s17, v79
    v_mul_f32 v84, v84, v86
    v_mul_f32 v85, v85, v87
    v_cvt_pk_bf16_f32 v127, v84, v85
    s_mov_b32 s18, 0
    buffer_store_dwordx4 v[96:99], v9, s[24:27], s18 offen sc1
    s_mov_b32 s18, 2560
    buffer_store_dwordx4 v[100:103], v9, s[24:27], s18 offen sc1
    s_mov_b32 s18, 5120
    buffer_store_dwordx4 v[104:107], v9, s[24:27], s18 offen sc1
    s_mov_b32 s18, 7680
    buffer_store_dwordx4 v[108:111], v9, s[24:27], s18 offen sc1
    s_mov_b32 s18, 10240
    buffer_store_dwordx4 v[112:115], v9, s[24:27], s18 offen sc1
    s_mov_b32 s18, 12800
    buffer_store_dwordx4 v[116:119], v9, s[24:27], s18 offen sc1
    s_mov_b32 s18, 15360
    buffer_store_dwordx4 v[120:123], v9, s[24:27], s18 offen sc1
    s_mov_b32 s18, 17920
    buffer_store_dwordx4 v[124:127], v9, s[24:27], s18 offen sc1
    s_endpgm
.end_22:
    s_endpgm
.section .rodata,"a"
.p2align 6
.amdhsa_kernel k1_kernel
  .amdhsa_next_free_vgpr 256
  .amdhsa_next_free_sgpr 102
  .amdhsa_accum_offset 256
  .amdhsa_group_segment_fixed_size 0
  .amdhsa_kernarg_size 96
  .amdhsa_user_sgpr_count 2
  .amdhsa_user_sgpr_kernarg_segment_ptr 1
  .amdhsa_system_sgpr_workgroup_id_x 1
  .amdhsa_float_denorm_mode_32 3
.end_amdhsa_kernel
.p2align 6
.amdhsa_kernel k2_kernel
  .amdhsa_next_free_vgpr 128
  .amdhsa_next_free_sgpr 102
  .amdhsa_accum_offset 128
  .amdhsa_group_segment_fixed_size 0
  .amdhsa_kernarg_size 96
  .amdhsa_user_sgpr_count 2
  .amdhsa_user_sgpr_kernarg_segment_ptr 1
  .amdhsa_system_sgpr_workgroup_id_x 1
  .amdhsa_float_denorm_mode_32 3
.end_amdhsa_kernel
.p2align 6
.amdhsa_kernel k3_kernel
  .amdhsa_next_free_vgpr 128
  .amdhsa_next_free_sgpr 102
  .amdhsa_accum_offset 128
  .amdhsa_group_segment_fixed_size 0
  .amdhsa_kernarg_size 96
  .amdhsa_user_sgpr_count 2
  .amdhsa_user_sgpr_kernarg_segment_ptr 1
  .amdhsa_system_sgpr_workgroup_id_x 1
  .amdhsa_float_denorm_mode_32 3
.end_amdhsa_kernel
```
